```python
import torch

def _softmax(x, axis=-1):
    return torch.softmax(x, dim=axis)

def _gelu(x):
    return torch.nn.functional.gelu(x, approximate='tanh')

def _silu(x):
    return torch.nn.functional.silu(x)

def _sigmoid(x):
    return torch.sigmoid(x)

def _layernorm(x, axis=-1, eps=1e-05):
    m = x.mean(dim=axis, keepdim=True)
    v = x.var(dim=axis, keepdim=True, unbiased=False)
    return (x - m) / torch.sqrt(v + eps)

def _scatter_add(tgt, idx, src, axis=0):
    return tgt.clone().index_add_(axis, idx, src)

def _segment_sum(src, seg, n):
    out = torch.zeros((n,) + src.shape[1:], dtype=src.dtype)
    return out.index_add_(0, seg, src)

def _pad(x, pw):
    flat = tuple((v for pair in reversed(pw) for v in pair))
    return torch.nn.functional.pad(x, flat)
kernel_name = 'standalone__conformer_family_zipformer__speech'

def setup_inputs():

    _w = lambda a: (lambda t: t.to(torch.bfloat16) if t.is_floating_point() else t)(torch.as_tensor(a))
    B, T, D, K, H = (2, 4000, 256, 31, 4)
    sc = 0.1
    return {'x': _w((lambda *s: torch.randn(*s, dtype=torch.bfloat16) * 0.8)(B, T, D)), 'w_ff1a': _w((lambda *s: torch.randn(*s, dtype=torch.bfloat16) * 0.8)(D, 4 * D) * sc), 'w_ff1b': _w((lambda *s: torch.randn(*s, dtype=torch.bfloat16) * 0.8)(4 * D, D) * sc), 'w_qkv': _w((lambda *s: torch.randn(*s, dtype=torch.bfloat16) * 0.8)(D, 3 * D) * sc), 'w_o': _w((lambda *s: torch.randn(*s, dtype=torch.bfloat16) * 1.6)(D, D) * sc), 'w_pw1': _w((lambda *s: torch.randn(*s, dtype=torch.bfloat16) * 1.6)(D, 2 * D) * sc), 'dw': _w((lambda *s: torch.randn(*s, dtype=torch.bfloat16) * 0.4)(K, D)), 'w_pw2': _w((lambda *s: torch.randn(*s, dtype=torch.bfloat16) * 0.4)(D, D) * sc), 'w_ff2a': _w((lambda *s: torch.randn(*s, dtype=torch.bfloat16) * 0.8)(D, 4 * D) * sc), 'w_ff2b': _w((lambda *s: torch.randn(*s, dtype=torch.bfloat16) * 0.8)(4 * D, D) * sc)}

def reference(x, w_ff1a, w_ff1b, w_qkv, w_o, w_pw1, dw, w_pw2, w_ff2a, w_ff2b):
    B, T, D = x.shape
    K = dw.shape[0]
    H = 4
    Dh = D // H
    h = _layernorm(x, axis=-1)
    h = _silu(h @ w_ff1a) @ w_ff1b
    x = x + 0.5 * h
    h = _layernorm(x, axis=-1)
    qkv = h @ w_qkv
    q = (lambda x, *d: x.permute(*d))(qkv[..., :D].reshape(B, T, H, Dh), 0, 2, 1, 3)
    k = (lambda x, *d: x.permute(*d))(qkv[..., D:2 * D].reshape(B, T, H, Dh), 0, 2, 1, 3)
    v = (lambda x, *d: x.permute(*d))(qkv[..., 2 * D:].reshape(B, T, H, Dh), 0, 2, 1, 3)
    scale = Dh ** (-0.5)
    scores = torch.einsum('bhqd,bhkd->bhqk', q, k) * scale
    p = _softmax(scores, axis=-1)
    att = torch.einsum('bhqk,bhkd->bhqd', p, v)
    att = (lambda x, *d: x.permute(*d))(att, 0, 2, 1, 3).reshape(B, T, D)
    x = x + att @ w_o
    h = _layernorm(x, axis=-1)
    h = h @ w_pw1
    a, b = (h[..., :D].clone(), h[..., D:].clone())
    h = a * _sigmoid(b)
    pad = K // 2
    hp = _pad(h, ((0, 0), (pad, pad), (0, 0)))
    c = torch.zeros_like(h)
    for i in range(K):
        c = c + hp[:, i:i + T, :] * dw[i][None, None, :]
    x = x + _silu(c) @ w_pw2
    h = _layernorm(x, axis=-1)
    h = _silu(h @ w_ff2a) @ w_ff2b
    x = x + 0.5 * h
    return _layernorm(x, axis=-1)
```

```asm
; @launch grid=(256,1,1) block=(256,1,1) lds=163840
.amdgcn_target "amdgcn-amd-amdhsa--gfx950"
.text
.globl standalone__conformer_family_zipformer__speech_kernel
.p2align 8
.type standalone__conformer_family_zipformer__speech_kernel,@function
standalone__conformer_family_zipformer__speech_kernel:
    s_cmp_ge_u32 s2, 256
    s_cbranch_scc1 standalone__conformer_family_zipformer__speech_kernel_end
    s_load_dwordx4 s[44:47], s[0:1], 0
    s_load_dwordx4 s[48:51], s[0:1], 16
    s_load_dwordx4 s[52:55], s[0:1], 88
    s_load_dwordx2 s[76:77], s[0:1], 80
    v_and_b32 v1, 63, v0
    v_lshrrev_b32 v2, 6, v0
    s_nop 0
    v_readfirstlane_b32 s3, v2
    s_and_b32 s67, s2, 7
    s_lshl_b32 s67, s67, 4
    s_lshr_b32 s68, s2, 4
    s_add_u32 s67, s67, s68
    s_bfe_u32 s68, s2, 0x10003
    s_lshl_b32 s66, s67, 1
    s_add_u32 s66, s66, s68
    v_lshlrev_b32 v30, 4, v1
    s_lshr_b32 s4, s2, 3
    s_lshl_b32 s4, s4, 2
    s_add_u32 s4, s4, s3
    s_min_u32 s4, s4, 124
    s_lshl_b32 s4, s4, 1
    s_bfe_u32 s5, s2, 0x10002
    s_mul_i32 s5, s5, 250
    s_add_u32 s4, s4, s5
    s_lshl_b32 s88, s4, 13
    s_and_b32 s5, s2, 3
    s_lshl_b32 s5, s5, 11
    s_add_u32 s88, s88, s5
    s_add_u32 s88, s88, 17825792
    s_add_u32 s89, s88, 8192
    v_mov_b32 v248, -1
    v_mov_b32 v249, -1
    v_mov_b32 v250, -1
    v_mov_b32 v251, -1
    s_and_b32 s94, s2, 7
    s_lshl_b32 s94, s94, 7
    s_lshr_b32 s4, s2, 3
    s_lshl_b32 s4, s4, 2
    s_add_u32 s94, s94, s4
    s_add_u32 s94, s94, s3
    s_lshl_b32 s94, s94, 7
    s_add_u32 s94, s94, 27262976
    s_cmp_ge_u32 s67, 125
    s_cbranch_scc1 standalone__conformer_family_zipformer__speech_kernel_swz
    v_lshrrev_b32 v7, 5, v1
    v_and_b32 v8, 31, v1
    v_xor_b32 v8, v8, v7
    v_lshlrev_b32 v8, 4, v8
    v_lshl_add_u32 v128, v7, 9, v8
    v_xor_b32 v129, 32, v128
    v_xor_b32 v130, 64, v128
    v_xor_b32 v131, 96, v128
    v_xor_b32 v132, 128, v128
    v_xor_b32 v133, 160, v128
    v_xor_b32 v134, 192, v128
    v_xor_b32 v135, 224, v128
    s_lshl_b32 s38, s3, 7
    s_lshl_b32 s6, s66, 1
    s_xor_b32 s6, s6, s3
    s_lshl_b32 s6, s6, 13
    s_add_u32 s7, s6, 4096
    s_lshl_b32 s4, s3, 13
    s_add_u32 s4, s4, 98304
    s_lshl_b32 s29, s68, 10
    s_add_u32 s30, s38, s29
    s_add_u32 s31, s30, 512
    s_lshl_b32 s33, s3, 15
    s_add_u32 s33, s33, 30408704
    s_lshl_b32 s29, s68, 18
    s_add_u32 s32, s33, s29
    s_cmp_ge_u32 s66, 125
    s_cselect_b32 s56, 375, 0
    s_add_u32 s56, s56, s66
    s_mul_i32 s57, s3, 125
    s_add_u32 s57, s57, s56
    s_lshl_b32 s70, s66, 14
    s_lshl_b32 s29, s3, 12
    s_add_u32 s70, s70, s29
    s_xor_b32 s69, s70, 16384
    s_cmp_ge_u32 s66, 125
    s_cselect_b32 s87, 387, 0
    s_add_u32 s87, s87, s66
    s_lshl_b32 s29, s3, 7
    s_add_u32 s87, s87, s29
    s_lshl_b32 s87, s87, 7
    s_add_u32 s87, s87, 28311552
    s_min_u32 s37, s66, 223
    s_and_b32 s35, s37, 7
    s_bfe_u32 s39, s37, 0x20003
    s_lshl_b32 s39, s39, 7
    s_lshl_b32 s40, s3, 5
    s_add_u32 s39, s39, s40
    s_lshr_b32 s40, s37, 5
    s_lshl_b32 s41, s40, 17
    s_sub_u32 s42, s40, 4
    s_lshl_b32 s42, s42, 9
    s_movk_i32 s34, 1536
    s_cmp_lt_u32 s37, 128
    s_cselect_b32 s34, 512, s34
    s_cselect_b32 s41, s41, s42
    s_mul_i32 s35, s35, s34
    s_lshl_b32 s35, s35, 5
    s_add_u32 s35, s35, s41
    s_add_u32 s35, s35, s39
    s_lshl_b32 s36, s37, 12
    s_lshl_b32 s40, s3, 10
    s_add_u32 s36, s36, s40
    s_andn2_b32 s41, s37, 7
    s_lshl_b32 s41, s41, 12
    s_and_b32 s42, s37, 7
    s_lshl_b32 s42, s42, 11
    s_add_u32 s41, s41, s42
    s_lshr_b32 s42, s3, 1
    s_mul_i32 s42, s42, 14336
    s_add_u32 s41, s41, s42
    s_add_u32 s41, s41, s40
    s_cmp_lt_u32 s37, 128
    s_cselect_b32 s36, s36, s41
    s_add_u32 s36, s36, 30408704
    s_cmp_ge_u32 s66, 224
    s_cselect_b32 s36, 0x7fff0000, s36
    v_lshrrev_b32 v8, 1, v1
    v_mul_u32_u24 v8, s34, v8
    v_and_b32 v9, 1, v1
    v_lshl_add_u32 v8, v9, 4, v8
    s_mul_i32 s40, s3, 24576
    s_add_u32 s40, s40, 20480
    v_lshlrev_b32 v9, 3, v1
    v_add_u32 v9, s40, v9
    s_waitcnt lgkmcnt(0)
    s_mov_b32 s8, s44
    s_and_b32 s9, s45, 0xffff
    s_mov_b32 s10, 0x3e8000
    s_mov_b32 s11, 0x20000
    s_add_u32 m0, s4, 0
    s_nop 0
    buffer_load_dwordx4 v128, s[8:11], s6 offen offset:0 lds
    buffer_load_dwordx4 v129, s[8:11], s6 offen offset:1024 lds
    buffer_load_dwordx4 v130, s[8:11], s6 offen offset:2048 lds
    buffer_load_dwordx4 v131, s[8:11], s6 offen offset:3072 lds
    s_add_u32 m0, s4, 4096
    s_nop 0
    buffer_load_dwordx4 v132, s[8:11], s7 offen offset:0 lds
    buffer_load_dwordx4 v133, s[8:11], s7 offen offset:1024 lds
    buffer_load_dwordx4 v134, s[8:11], s7 offen offset:2048 lds
    buffer_load_dwordx4 v135, s[8:11], s7 offen offset:3072 lds
    s_mov_b32 s18, 393216
    s_cmp_lt_u32 s37, 128
    s_cselect_b32 s16, s48, s50
    s_cselect_b32 s17, s49, s51
    s_cselect_b32 s18, 0x80000, s18
    s_and_b32 s17, s17, 0xffff
    s_mov_b32 s19, 0x20000
    s_mov_b32 m0, s40
    s_nop 0
    buffer_load_dwordx4 v8, s[16:19], s35 offen lds
    s_mov_b32 s24, s54
    s_and_b32 s25, s55, 0xffff
    s_mov_b32 s26, 0x10000000
    s_mov_b32 s27, 0x20000
    s_mov_b32 s76, s76
    s_and_b32 s77, s77, 0xffff
    s_mov_b32 s78, 0x3e8000
    s_mov_b32 s79, 0x20000
    s_lshl_b32 s80, s2, 2
    s_add_u32 s80, s80, s3
    s_lshl_b32 s80, s80, 7
    s_xor_b32 s81, s80, 4096
    s_add_u32 s80, s80, 26214400
    s_add_u32 s81, s81, 26214400
    s_getreg_b32 s82, hwreg(HW_REG_XCC_ID, 0, 4)
    s_or_b32 s82, s82, 0x80
    v_mov_b32 v243, 0
    s_mov_b32 s12, s46
    s_and_b32 s13, s47, 0xffff
    s_mov_b32 s14, 0x80000
    s_mov_b32 s15, 0x20000
    s_mov_b32 s72, s52
    s_and_b32 s73, s53, 0xffff
    s_mov_b32 s74, 0x100
    s_mov_b32 s75, 0x20000
    v_lshrrev_b32 v2, 3, v1
    v_lshrrev_b32 v3, 4, v1
    v_lshlrev_b32 v3, 1, v3
    v_and_b32 v4, 7, v1
    v_xor_b32 v4, v4, v3
    v_lshlrev_b32 v4, 4, v4
    v_mul_u32_u24 v10, 2048, v2
    v_add_u32 v10, v10, v4
    v_add_u32 v11, 15360, v10
    v_add_u32 v12, 30720, v10
    v_add_u32 v13, 46080, v10
    s_mul_i32 s28, s3, 24576
    v_lshrrev_b32 v2, 2, v1
    v_lshrrev_b32 v3, 1, v2
    v_and_b32 v3, 3, v3
    v_and_b32 v4, 3, v1
    v_lshlrev_b32 v4, 3, v4
    v_lshlrev_b32 v5, 7, v2
    v_add_u32 v5, v5, v4
    v_add_u32 v5, s28, v5
    v_xor_b32 v6, 0, v3
    v_lshlrev_b32 v6, 5, v6
    v_add_u32 v22, v5, v6
    v_xor_b32 v6, 1, v3
    v_lshlrev_b32 v6, 5, v6
    v_add_u32 v23, v5, v6
    v_xor_b32 v6, 2, v3
    v_lshlrev_b32 v6, 5, v6
    v_add_u32 v24, v5, v6
    v_xor_b32 v6, 3, v3
    v_lshlrev_b32 v6, 5, v6
    v_add_u32 v25, v5, v6
    s_lshr_b32 s64, s2, 3
    s_and_b32 s64, s64, 31
    s_lshl_b32 s64, s64, 3
    v_and_b32 v2, 7, v1
    v_add_u32 v2, s64, v2
    s_and_b32 s64, s64, 0xf0
    v_and_b32 v3, 15, v1
    v_add_u32 v3, s64, v3
    v_mul_u32_u24 v240, 2048, v3
    buffer_load_dword v247, v240, s[12:15], s30 offen
    buffer_load_dword v247, v240, s[12:15], s31 offen
    s_add_u32 m0, s28, 0
    s_add_u32 s29, s30, 0
    buffer_load_dwordx4 v10, s[12:15], s29 offen offset:0 lds
    buffer_load_dwordx4 v11, s[12:15], s29 offen offset:1024 lds
    buffer_load_dwordx4 v12, s[12:15], s29 offen offset:2048 lds
    buffer_load_dwordx4 v13, s[12:15], s29 offen offset:3072 lds
    buffer_store_dword v243, v243, s[24:27], s80 offen sc1
    buffer_store_dword v243, v243, s[24:27], s87 offen sc1
    buffer_store_dword v243, v243, s[24:27], s94 offen sc1
    v_add_u32 v26, 98304, v30
    s_mul_i32 s29, s3, 8192
    v_add_u32 v27, s29, v26
    s_mul_i32 s29, s3, 4096
    v_add_u32 v245, s29, v26
    s_lshl_b32 s29, s3, 2
    s_add_u32 s29, s29, 114688
    v_add_u32 v28, s29, v30
    v_and_b32 v2, 15, v1
    v_lshlrev_b32 v2, 4, v2
    v_add_u32 v29, 114688, v2
    s_lshl_b32 s58, s57, 12
    s_add_u32 s58, s58, 4194304
    s_lshl_b32 s59, s57, 13
    s_add_u32 s59, s59, 8388608
    s_add_u32 s60, s59, 4096
    s_lshl_b32 s61, s57, 7
    s_add_u32 s61, s61, 16777216
    v_lshrrev_b32 v31, 5, v1
    v_and_b32 v2, 15, v1
    v_lshl_add_u32 v31, v2, 1, v31
    v_lshlrev_b32 v31, 2, v31
    s_lshl_b32 s29, s3, 10
    v_add_u32 v246, s29, v26
    v_lshlrev_b32 v241, 2, v1
    v_and_b32 v2, 15, v1
    v_lshrrev_b32 v3, 5, v1
    v_xor_b32 v3, v3, v2
    v_bfe_u32 v4, v1, 4, 1
    v_lshlrev_b32 v4, 3, v4
    v_lshl_add_u32 v4, v2, 9, v4
    v_lshl_add_u32 v4, v3, 4, v4
    v_add_u32 v5, s4, v4
    v_xor_b32 v208, 0, v5
    v_xor_b32 v209, 32, v5
    v_xor_b32 v210, 64, v5
    v_xor_b32 v211, 96, v5
    v_xor_b32 v212, 128, v5
    v_xor_b32 v213, 160, v5
    v_xor_b32 v214, 192, v5
    v_xor_b32 v215, 224, v5
    v_xor_b32 v4, s38, v4
    v_add_u32 v4, 98304, v4
    v_xor_b32 v216, 0, v4
    v_xor_b32 v217, 32, v4
    v_xor_b32 v218, 64, v4
    v_xor_b32 v219, 96, v4
    s_waitcnt vmcnt(10)
    s_mov_b32 s43, 0xffff0000
    ds_read_b64 v[64:65], v208 offset:0
    ds_read_b64 v[66:67], v209 offset:0
    ds_read_b64 v[68:69], v210 offset:0
    ds_read_b64 v[70:71], v211 offset:0
    ds_read_b64 v[72:73], v212 offset:0
    ds_read_b64 v[74:75], v213 offset:0
    ds_read_b64 v[76:77], v214 offset:0
    ds_read_b64 v[78:79], v215 offset:0
    ds_read_b64 v[80:81], v208 offset:256
    ds_read_b64 v[82:83], v209 offset:256
    ds_read_b64 v[84:85], v210 offset:256
    ds_read_b64 v[86:87], v211 offset:256
    ds_read_b64 v[88:89], v212 offset:256
    ds_read_b64 v[90:91], v213 offset:256
    ds_read_b64 v[92:93], v214 offset:256
    ds_read_b64 v[94:95], v215 offset:256
    s_waitcnt lgkmcnt(15)
    v_lshlrev_b32 v128, 16, v64
    v_and_b32 v129, s43, v64
    v_lshlrev_b32 v130, 16, v65
    v_and_b32 v131, s43, v65
    s_waitcnt lgkmcnt(14)
    v_lshlrev_b32 v132, 16, v66
    v_and_b32 v133, s43, v66
    v_lshlrev_b32 v134, 16, v67
    v_and_b32 v135, s43, v67
    s_waitcnt lgkmcnt(13)
    v_lshlrev_b32 v136, 16, v68
    v_and_b32 v137, s43, v68
    v_lshlrev_b32 v138, 16, v69
    v_and_b32 v139, s43, v69
    s_waitcnt lgkmcnt(12)
    v_lshlrev_b32 v140, 16, v70
    v_and_b32 v141, s43, v70
    v_lshlrev_b32 v142, 16, v71
    v_and_b32 v143, s43, v71
    s_waitcnt lgkmcnt(11)
    v_lshlrev_b32 v144, 16, v72
    v_and_b32 v145, s43, v72
    v_lshlrev_b32 v146, 16, v73
    v_and_b32 v147, s43, v73
    s_waitcnt lgkmcnt(10)
    v_lshlrev_b32 v148, 16, v74
    v_and_b32 v149, s43, v74
    v_lshlrev_b32 v150, 16, v75
    v_and_b32 v151, s43, v75
    s_waitcnt lgkmcnt(9)
    v_lshlrev_b32 v152, 16, v76
    v_and_b32 v153, s43, v76
    v_lshlrev_b32 v154, 16, v77
    v_and_b32 v155, s43, v77
    s_waitcnt lgkmcnt(8)
    v_lshlrev_b32 v156, 16, v78
    v_and_b32 v157, s43, v78
    v_lshlrev_b32 v158, 16, v79
    v_and_b32 v159, s43, v79
    s_waitcnt lgkmcnt(7)
    v_lshlrev_b32 v160, 16, v80
    v_and_b32 v161, s43, v80
    v_lshlrev_b32 v162, 16, v81
    v_and_b32 v163, s43, v81
    s_waitcnt lgkmcnt(6)
    v_lshlrev_b32 v164, 16, v82
    v_and_b32 v165, s43, v82
    v_lshlrev_b32 v166, 16, v83
    v_and_b32 v167, s43, v83
    s_waitcnt lgkmcnt(5)
    v_lshlrev_b32 v168, 16, v84
    v_and_b32 v169, s43, v84
    v_lshlrev_b32 v170, 16, v85
    v_and_b32 v171, s43, v85
    s_waitcnt lgkmcnt(4)
    v_lshlrev_b32 v172, 16, v86
    v_and_b32 v173, s43, v86
    v_lshlrev_b32 v174, 16, v87
    v_and_b32 v175, s43, v87
    s_waitcnt lgkmcnt(3)
    v_lshlrev_b32 v176, 16, v88
    v_and_b32 v177, s43, v88
    v_lshlrev_b32 v178, 16, v89
    v_and_b32 v179, s43, v89
    s_waitcnt lgkmcnt(2)
    v_lshlrev_b32 v180, 16, v90
    v_and_b32 v181, s43, v90
    v_lshlrev_b32 v182, 16, v91
    v_and_b32 v183, s43, v91
    s_waitcnt lgkmcnt(1)
    v_lshlrev_b32 v184, 16, v92
    v_and_b32 v185, s43, v92
    v_lshlrev_b32 v186, 16, v93
    v_and_b32 v187, s43, v93
    s_waitcnt lgkmcnt(0)
    v_lshlrev_b32 v188, 16, v94
    v_and_b32 v189, s43, v94
    v_lshlrev_b32 v190, 16, v95
    v_and_b32 v191, s43, v95
    s_waitcnt vmcnt(9)
    ds_read_b64_tr_b16 v[220:221], v9
    ds_read_b64_tr_b16 v[222:223], v9 offset:512
    v_pk_add_f32 v[192:193], v[128:129], v[130:131]
    v_pk_mul_f32 v[194:195], v[128:129], v[128:129]
    v_pk_fma_f32 v[194:195], v[130:131], v[130:131], v[194:195]
    v_pk_add_f32 v[196:197], v[160:161], v[162:163]
    v_pk_mul_f32 v[198:199], v[160:161], v[160:161]
    v_pk_fma_f32 v[198:199], v[162:163], v[162:163], v[198:199]
    v_pk_add_f32 v[192:193], v[192:193], v[132:133]
    v_pk_fma_f32 v[194:195], v[132:133], v[132:133], v[194:195]
    v_pk_add_f32 v[196:197], v[196:197], v[164:165]
    v_pk_fma_f32 v[198:199], v[164:165], v[164:165], v[198:199]
    v_pk_add_f32 v[192:193], v[192:193], v[134:135]
    v_pk_fma_f32 v[194:195], v[134:135], v[134:135], v[194:195]
    v_pk_add_f32 v[196:197], v[196:197], v[166:167]
    v_pk_fma_f32 v[198:199], v[166:167], v[166:167], v[198:199]
    v_pk_add_f32 v[192:193], v[192:193], v[136:137]
    v_pk_fma_f32 v[194:195], v[136:137], v[136:137], v[194:195]
    v_pk_add_f32 v[196:197], v[196:197], v[168:169]
    v_pk_fma_f32 v[198:199], v[168:169], v[168:169], v[198:199]
    v_pk_add_f32 v[192:193], v[192:193], v[138:139]
    v_pk_fma_f32 v[194:195], v[138:139], v[138:139], v[194:195]
    v_pk_add_f32 v[196:197], v[196:197], v[170:171]
    v_pk_fma_f32 v[198:199], v[170:171], v[170:171], v[198:199]
    v_pk_add_f32 v[192:193], v[192:193], v[140:141]
    v_pk_fma_f32 v[194:195], v[140:141], v[140:141], v[194:195]
    v_pk_add_f32 v[196:197], v[196:197], v[172:173]
    v_pk_fma_f32 v[198:199], v[172:173], v[172:173], v[198:199]
    v_pk_add_f32 v[192:193], v[192:193], v[142:143]
    v_pk_fma_f32 v[194:195], v[142:143], v[142:143], v[194:195]
    v_pk_add_f32 v[196:197], v[196:197], v[174:175]
    v_pk_fma_f32 v[198:199], v[174:175], v[174:175], v[198:199]
    v_pk_add_f32 v[192:193], v[192:193], v[144:145]
    v_pk_fma_f32 v[194:195], v[144:145], v[144:145], v[194:195]
    v_pk_add_f32 v[196:197], v[196:197], v[176:177]
    v_pk_fma_f32 v[198:199], v[176:177], v[176:177], v[198:199]
    v_pk_add_f32 v[192:193], v[192:193], v[146:147]
    v_pk_fma_f32 v[194:195], v[146:147], v[146:147], v[194:195]
    v_pk_add_f32 v[196:197], v[196:197], v[178:179]
    v_pk_fma_f32 v[198:199], v[178:179], v[178:179], v[198:199]
    v_pk_add_f32 v[192:193], v[192:193], v[148:149]
    v_pk_fma_f32 v[194:195], v[148:149], v[148:149], v[194:195]
    v_pk_add_f32 v[196:197], v[196:197], v[180:181]
    v_pk_fma_f32 v[198:199], v[180:181], v[180:181], v[198:199]
    v_pk_add_f32 v[192:193], v[192:193], v[150:151]
    v_pk_fma_f32 v[194:195], v[150:151], v[150:151], v[194:195]
    v_pk_add_f32 v[196:197], v[196:197], v[182:183]
    v_pk_fma_f32 v[198:199], v[182:183], v[182:183], v[198:199]
    v_pk_add_f32 v[192:193], v[192:193], v[152:153]
    v_pk_fma_f32 v[194:195], v[152:153], v[152:153], v[194:195]
    v_pk_add_f32 v[196:197], v[196:197], v[184:185]
    v_pk_fma_f32 v[198:199], v[184:185], v[184:185], v[198:199]
    v_pk_add_f32 v[192:193], v[192:193], v[154:155]
    v_pk_fma_f32 v[194:195], v[154:155], v[154:155], v[194:195]
    v_pk_add_f32 v[196:197], v[196:197], v[186:187]
    v_pk_fma_f32 v[198:199], v[186:187], v[186:187], v[198:199]
    v_pk_add_f32 v[192:193], v[192:193], v[156:157]
    v_pk_fma_f32 v[194:195], v[156:157], v[156:157], v[194:195]
    v_pk_add_f32 v[196:197], v[196:197], v[188:189]
    v_pk_fma_f32 v[198:199], v[188:189], v[188:189], v[198:199]
    v_pk_add_f32 v[192:193], v[192:193], v[158:159]
    v_pk_fma_f32 v[194:195], v[158:159], v[158:159], v[194:195]
    v_pk_add_f32 v[196:197], v[196:197], v[190:191]
    v_pk_fma_f32 v[198:199], v[190:191], v[190:191], v[198:199]
    s_waitcnt lgkmcnt(0)
    buffer_store_dwordx4 v[220:223], v30, s[24:27], s36 offen sc1
    v_pk_add_f32 v[192:193], v[192:193], v[196:197]
    v_pk_add_f32 v[194:195], v[194:195], v[198:199]
    v_add_f32 v192, v192, v193
    v_add_f32 v194, v194, v195
    s_nop 1
    v_permlane32_swap_b32 v192, v194
    v_add_f32 v192, v192, v194
    v_mov_b32 v193, v192
    s_nop 1
    v_permlane16_swap_b32 v192, v193
    v_add_f32 v192, v192, v193
    v_mul_f32 v192, 0x3b800000, v192
    v_mov_b32 v194, v192
    s_nop 1
    v_permlane32_swap_b32 v192, v194
    v_fma_f32 v194, -v192, v192, v194
    v_max_f32 v194, 0, v194
    v_add_f32 v194, 0x3727c5ac, v194
    v_rsq_f32 v194, v194
    s_nop 0
    v_mul_f32 v194, 0xbfb8aa3b, v194
    v_mul_f32 v196, -v192, v194
    v_pk_fma_f32 v[128:129], v[128:129], v[194:195], v[196:197] op_sel_hi:[1,0,0]
    v_pk_fma_f32 v[130:131], v[130:131], v[194:195], v[196:197] op_sel_hi:[1,0,0]
    v_pk_fma_f32 v[132:133], v[132:133], v[194:195], v[196:197] op_sel_hi:[1,0,0]
    v_pk_fma_f32 v[134:135], v[134:135], v[194:195], v[196:197] op_sel_hi:[1,0,0]
    v_cvt_pk_bf16_f32 v64, v128, v129
    v_cvt_pk_bf16_f32 v65, v130, v131
    v_cvt_pk_bf16_f32 v66, v132, v133
    v_cvt_pk_bf16_f32 v67, v134, v135
    v_pk_fma_f32 v[136:137], v[136:137], v[194:195], v[196:197] op_sel_hi:[1,0,0]
    v_pk_fma_f32 v[138:139], v[138:139], v[194:195], v[196:197] op_sel_hi:[1,0,0]
    v_pk_fma_f32 v[140:141], v[140:141], v[194:195], v[196:197] op_sel_hi:[1,0,0]
    v_pk_fma_f32 v[142:143], v[142:143], v[194:195], v[196:197] op_sel_hi:[1,0,0]
    v_cvt_pk_bf16_f32 v68, v136, v137
    v_cvt_pk_bf16_f32 v69, v138, v139
    v_cvt_pk_bf16_f32 v70, v140, v141
    v_cvt_pk_bf16_f32 v71, v142, v143
    ds_write_b128 v246, v[64:67] offset:32768
    ds_write_b128 v246, v[68:71] offset:36864
    v_pk_fma_f32 v[144:145], v[144:145], v[194:195], v[196:197] op_sel_hi:[1,0,0]
    v_pk_fma_f32 v[146:147], v[146:147], v[194:195], v[196:197] op_sel_hi:[1,0,0]
    v_pk_fma_f32 v[148:149], v[148:149], v[194:195], v[196:197] op_sel_hi:[1,0,0]
    v_pk_fma_f32 v[150:151], v[150:151], v[194:195], v[196:197] op_sel_hi:[1,0,0]
    v_cvt_pk_bf16_f32 v72, v144, v145
    v_cvt_pk_bf16_f32 v73, v146, v147
    v_cvt_pk_bf16_f32 v74, v148, v149
    v_cvt_pk_bf16_f32 v75, v150, v151
    v_pk_fma_f32 v[152:153], v[152:153], v[194:195], v[196:197] op_sel_hi:[1,0,0]
    v_pk_fma_f32 v[154:155], v[154:155], v[194:195], v[196:197] op_sel_hi:[1,0,0]
    v_pk_fma_f32 v[156:157], v[156:157], v[194:195], v[196:197] op_sel_hi:[1,0,0]
    v_pk_fma_f32 v[158:159], v[158:159], v[194:195], v[196:197] op_sel_hi:[1,0,0]
    v_cvt_pk_bf16_f32 v76, v152, v153
    v_cvt_pk_bf16_f32 v77, v154, v155
    v_cvt_pk_bf16_f32 v78, v156, v157
    v_cvt_pk_bf16_f32 v79, v158, v159
    ds_write_b128 v246, v[72:75] offset:40960
    ds_write_b128 v246, v[76:79] offset:45056
    v_pk_fma_f32 v[160:161], v[160:161], v[194:195], v[196:197] op_sel_hi:[1,0,0]
    v_pk_fma_f32 v[162:163], v[162:163], v[194:195], v[196:197] op_sel_hi:[1,0,0]
    v_pk_fma_f32 v[164:165], v[164:165], v[194:195], v[196:197] op_sel_hi:[1,0,0]
    v_pk_fma_f32 v[166:167], v[166:167], v[194:195], v[196:197] op_sel_hi:[1,0,0]
    v_cvt_pk_bf16_f32 v80, v160, v161
    v_cvt_pk_bf16_f32 v81, v162, v163
    v_cvt_pk_bf16_f32 v82, v164, v165
    v_cvt_pk_bf16_f32 v83, v166, v167
    v_pk_fma_f32 v[168:169], v[168:169], v[194:195], v[196:197] op_sel_hi:[1,0,0]
    v_pk_fma_f32 v[170:171], v[170:171], v[194:195], v[196:197] op_sel_hi:[1,0,0]
    v_pk_fma_f32 v[172:173], v[172:173], v[194:195], v[196:197] op_sel_hi:[1,0,0]
    v_pk_fma_f32 v[174:175], v[174:175], v[194:195], v[196:197] op_sel_hi:[1,0,0]
    v_cvt_pk_bf16_f32 v84, v168, v169
    v_cvt_pk_bf16_f32 v85, v170, v171
    v_cvt_pk_bf16_f32 v86, v172, v173
    v_cvt_pk_bf16_f32 v87, v174, v175
    ds_write_b128 v246, v[80:83] offset:49152
    ds_write_b128 v246, v[84:87] offset:53248
    v_pk_fma_f32 v[176:177], v[176:177], v[194:195], v[196:197] op_sel_hi:[1,0,0]
    v_pk_fma_f32 v[178:179], v[178:179], v[194:195], v[196:197] op_sel_hi:[1,0,0]
    v_pk_fma_f32 v[180:181], v[180:181], v[194:195], v[196:197] op_sel_hi:[1,0,0]
    v_pk_fma_f32 v[182:183], v[182:183], v[194:195], v[196:197] op_sel_hi:[1,0,0]
    v_cvt_pk_bf16_f32 v88, v176, v177
    v_cvt_pk_bf16_f32 v89, v178, v179
    v_cvt_pk_bf16_f32 v90, v180, v181
    v_cvt_pk_bf16_f32 v91, v182, v183
    v_pk_fma_f32 v[184:185], v[184:185], v[194:195], v[196:197] op_sel_hi:[1,0,0]
    v_pk_fma_f32 v[186:187], v[186:187], v[194:195], v[196:197] op_sel_hi:[1,0,0]
    v_pk_fma_f32 v[188:189], v[188:189], v[194:195], v[196:197] op_sel_hi:[1,0,0]
    v_pk_fma_f32 v[190:191], v[190:191], v[194:195], v[196:197] op_sel_hi:[1,0,0]
    v_cvt_pk_bf16_f32 v92, v184, v185
    v_cvt_pk_bf16_f32 v93, v186, v187
    v_cvt_pk_bf16_f32 v94, v188, v189
    v_cvt_pk_bf16_f32 v95, v190, v191
    ds_write_b128 v246, v[88:91] offset:57344
    ds_write_b128 v246, v[92:95] offset:61440
    s_waitcnt vmcnt(4)
    ds_read_b64_tr_b16 a[128:129], v22 offset:0
    ds_read_b64_tr_b16 a[130:131], v22 offset:2048
    ds_read_b64_tr_b16 a[132:133], v23 offset:0
    ds_read_b64_tr_b16 a[134:135], v23 offset:2048
    ds_read_b64_tr_b16 a[136:137], v24 offset:0
    ds_read_b64_tr_b16 a[138:139], v24 offset:2048
    ds_read_b64_tr_b16 a[140:141], v25 offset:0
    ds_read_b64_tr_b16 a[142:143], v25 offset:2048
    s_add_u32 m0, s28, 4096
    s_add_u32 s29, s30, 65536
    buffer_load_dwordx4 v10, s[12:15], s29 offen offset:0 lds
    buffer_load_dwordx4 v11, s[12:15], s29 offen offset:1024 lds
    buffer_load_dwordx4 v12, s[12:15], s29 offen offset:2048 lds
    buffer_load_dwordx4 v13, s[12:15], s29 offen offset:3072 lds
    s_add_u32 m0, s28, 8192
    s_add_u32 s29, s30, 131072
    buffer_load_dwordx4 v10, s[12:15], s29 offen offset:0 lds
    buffer_load_dwordx4 v11, s[12:15], s29 offen offset:1024 lds
    buffer_load_dwordx4 v12, s[12:15], s29 offen offset:2048 lds
    buffer_load_dwordx4 v13, s[12:15], s29 offen offset:3072 lds
    s_waitcnt lgkmcnt(0)
    s_barrier
    ds_read_b128 a[0:3], v26 offset:32768
    ds_read_b128 a[4:7], v26 offset:33792
    ds_read_b128 a[8:11], v26 offset:34816
    ds_read_b128 a[12:15], v26 offset:35840
    s_waitcnt lgkmcnt(3)
    v_mfma_f32_16x16x32_bf16 v[64:67], a[128:131], a[0:3], 0
    s_add_u32 m0, s28, 12288
    s_add_u32 s29, s30, 196608
    s_waitcnt vmcnt(4)
    ds_read_b64_tr_b16 a[144:145], v22 offset:4096
    s_waitcnt lgkmcnt(3)
    v_mfma_f32_16x16x32_bf16 v[68:71], a[128:131], a[4:7], 0
    ds_read_b64_tr_b16 a[146:147], v22 offset:6144
    buffer_load_dwordx4 v10, s[12:15], s29 offen offset:0 lds
    s_waitcnt lgkmcnt(3)
    v_mfma_f32_16x16x32_bf16 v[72:75], a[128:131], a[8:11], 0
    ds_read_b128 a[16:19], v26 offset:36864
    s_waitcnt lgkmcnt(3)
    v_mfma_f32_16x16x32_bf16 v[76:79], a[128:131], a[12:15], 0
    ds_read_b128 a[20:23], v26 offset:37888
    v_mfma_f32_16x16x32_bf16 v[80:83], a[132:135], a[0:3], 0
    ds_read_b128 a[24:27], v26 offset:38912
    buffer_load_dwordx4 v11, s[12:15], s29 offen offset:1024 lds
    ds_read_b64 v[224:225], v216 offset:0
    v_mfma_f32_16x16x32_bf16 v[84:87], a[132:135], a[4:7], 0
    ds_read_b128 a[28:31], v26 offset:39936
    v_mfma_f32_16x16x32_bf16 v[88:91], a[132:135], a[8:11], 0
    ds_read_b64_tr_b16 a[148:149], v23 offset:4096
    buffer_load_dwordx4 v12, s[12:15], s29 offen offset:2048 lds
    v_mfma_f32_16x16x32_bf16 v[92:95], a[132:135], a[12:15], 0
    ds_read_b64_tr_b16 a[150:151], v23 offset:6144
    v_mfma_f32_16x16x32_bf16 v[96:99], a[136:139], a[0:3], 0
    ds_read_b64_tr_b16 a[152:153], v24 offset:4096
    ds_read_b64 v[226:227], v216 offset:8192
    v_mfma_f32_16x16x32_bf16 v[100:103], a[136:139], a[4:7], 0
    ds_read_b64_tr_b16 a[154:155], v24 offset:6144
    buffer_load_dwordx4 v13, s[12:15], s29 offen offset:3072 lds
    v_mfma_f32_16x16x32_bf16 v[104:107], a[136:139], a[8:11], 0
    ds_read_b64_tr_b16 a[156:157], v25 offset:4096
    v_mfma_f32_16x16x32_bf16 v[108:111], a[136:139], a[12:15], 0
    ds_read_b64_tr_b16 a[158:159], v25 offset:6144
    v_mfma_f32_16x16x32_bf16 v[112:115], a[140:143], a[0:3], 0
    s_add_u32 m0, s28, 16384
    s_add_u32 s29, s30, 262144
    buffer_load_dwordx4 v10, s[12:15], s29 offen offset:0 lds
    ds_read_b64 v[228:229], v217 offset:0
    v_mfma_f32_16x16x32_bf16 v[116:119], a[140:143], a[4:7], 0
    v_mfma_f32_16x16x32_bf16 v[120:123], a[140:143], a[8:11], 0
    buffer_load_dwordx4 v11, s[12:15], s29 offen offset:1024 lds
    v_mfma_f32_16x16x32_bf16 v[124:127], a[140:143], a[12:15], 0
    ds_read_b64 v[230:231], v217 offset:8192
    s_waitcnt lgkmcnt(2)
    v_mfma_f32_16x16x32_bf16 v[64:67], a[144:147], a[16:19], v[64:67]
    s_waitcnt vmcnt(6)
    ds_read_b64_tr_b16 a[128:129], v22 offset:8192
    v_mfma_f32_16x16x32_bf16 v[68:71], a[144:147], a[20:23], v[68:71]
    ds_read_b64_tr_b16 a[130:131], v22 offset:10240
    buffer_load_dwordx4 v12, s[12:15], s29 offen offset:2048 lds
    v_mfma_f32_16x16x32_bf16 v[72:75], a[144:147], a[24:27], v[72:75]
    ds_read_b128 a[32:35], v26 offset:40960
    v_mfma_f32_16x16x32_bf16 v[76:79], a[144:147], a[28:31], v[76:79]
    ds_read_b128 a[36:39], v26 offset:41984
    v_mfma_f32_16x16x32_bf16 v[80:83], a[148:151], a[16:19], v[80:83]
    ds_read_b128 a[40:43], v26 offset:43008
    buffer_load_dwordx4 v13, s[12:15], s29 offen offset:3072 lds
    ds_read_b64 v[232:233], v218 offset:0
    v_mfma_f32_16x16x32_bf16 v[84:87], a[148:151], a[20:23], v[84:87]
    ds_read_b128 a[44:47], v26 offset:44032
    v_mfma_f32_16x16x32_bf16 v[88:91], a[148:151], a[24:27], v[88:91]
    s_add_u32 m0, s28, 20480
    s_add_u32 s29, s30, 327680
    ds_read_b64_tr_b16 a[132:133], v23 offset:8192
    buffer_load_dwordx4 v10, s[12:15], s29 offen offset:0 lds
    v_mfma_f32_16x16x32_bf16 v[92:95], a[148:151], a[28:31], v[92:95]
    ds_read_b64_tr_b16 a[134:135], v23 offset:10240
    v_mfma_f32_16x16x32_bf16 v[96:99], a[152:155], a[16:19], v[96:99]
    ds_read_b64_tr_b16 a[136:137], v24 offset:8192
    ds_read_b64 v[234:235], v218 offset:8192
    v_mfma_f32_16x16x32_bf16 v[100:103], a[152:155], a[20:23], v[100:103]
    ds_read_b64_tr_b16 a[138:139], v24 offset:10240
    buffer_load_dwordx4 v11, s[12:15], s29 offen offset:1024 lds
    v_mfma_f32_16x16x32_bf16 v[104:107], a[152:155], a[24:27], v[104:107]
    ds_read_b64_tr_b16 a[140:141], v25 offset:8192
    v_mfma_f32_16x16x32_bf16 v[108:111], a[152:155], a[28:31], v[108:111]
    ds_read_b64_tr_b16 a[142:143], v25 offset:10240
    v_mfma_f32_16x16x32_bf16 v[112:115], a[156:159], a[16:19], v[112:115]
    buffer_load_dwordx4 v12, s[12:15], s29 offen offset:2048 lds
    ds_read_b64 v[236:237], v219 offset:0
    v_mfma_f32_16x16x32_bf16 v[116:119], a[156:159], a[20:23], v[116:119]
    v_mfma_f32_16x16x32_bf16 v[120:123], a[156:159], a[24:27], v[120:123]
    buffer_load_dwordx4 v13, s[12:15], s29 offen offset:3072 lds
    v_mfma_f32_16x16x32_bf16 v[124:127], a[156:159], a[28:31], v[124:127]
    ds_read_b64 v[238:239], v219 offset:8192
    s_waitcnt lgkmcnt(0)
    s_barrier
    s_cmp_lg_u32 s3, 0
    s_cbranch_scc1 standalone__conformer_family_zipformer__speech_kernel_ann01
    s_and_b32 s84, s2, 3
    s_lshl_b32 s84, s84, 3
    s_lshl_b32 s84, s82, s84
    v_mov_b32 v244, s84
    s_and_b32 s85, s2, 0xfc
    s_mov_b64 exec, 1
    buffer_atomic_or v244, v243, s[72:75], s85 offen sc1
    s_mov_b64 exec, -1
standalone__conformer_family_zipformer__speech_kernel_ann01:
    v_mfma_f32_16x16x32_bf16 v[64:67], a[128:131], a[32:35], v[64:67]
    s_add_u32 m0, s28, 0
    s_add_u32 s29, s30, 393216
    s_waitcnt vmcnt(8)
    ds_read_b64_tr_b16 a[144:145], v22 offset:12288
    v_mfma_f32_16x16x32_bf16 v[68:71], a[128:131], a[36:39], v[68:71]
    ds_read_b64_tr_b16 a[146:147], v22 offset:14336
    buffer_load_dwordx4 v10, s[12:15], s29 offen offset:0 lds
    v_mfma_f32_16x16x32_bf16 v[72:75], a[128:131], a[40:43], v[72:75]
    ds_read_b128 a[48:51], v26 offset:45056
    v_mfma_f32_16x16x32_bf16 v[76:79], a[128:131], a[44:47], v[76:79]
    ds_read_b128 a[52:55], v26 offset:46080
    v_mfma_f32_16x16x32_bf16 v[80:83], a[132:135], a[32:35], v[80:83]
    ds_read_b128 a[56:59], v26 offset:47104
    buffer_load_dwordx4 v11, s[12:15], s29 offen offset:1024 lds
    v_mfma_f32_16x16x32_bf16 v[84:87], a[132:135], a[36:39], v[84:87]
    ds_read_b128 a[60:63], v26 offset:48128
    v_mfma_f32_16x16x32_bf16 v[88:91], a[132:135], a[40:43], v[88:91]
    ds_read_b64_tr_b16 a[148:149], v23 offset:12288
    buffer_load_dwordx4 v12, s[12:15], s29 offen offset:2048 lds
    v_mfma_f32_16x16x32_bf16 v[92:95], a[132:135], a[44:47], v[92:95]
    ds_read_b64_tr_b16 a[150:151], v23 offset:14336
    v_mfma_f32_16x16x32_bf16 v[96:99], a[136:139], a[32:35], v[96:99]
    ds_read_b64_tr_b16 a[152:153], v24 offset:12288
    v_mfma_f32_16x16x32_bf16 v[100:103], a[136:139], a[36:39], v[100:103]
    ds_read_b64_tr_b16 a[154:155], v24 offset:14336
    buffer_load_dwordx4 v13, s[12:15], s29 offen offset:3072 lds
    v_mfma_f32_16x16x32_bf16 v[104:107], a[136:139], a[40:43], v[104:107]
    ds_read_b64_tr_b16 a[156:157], v25 offset:12288
    v_mfma_f32_16x16x32_bf16 v[108:111], a[136:139], a[44:47], v[108:111]
    ds_read_b64_tr_b16 a[158:159], v25 offset:14336
    v_mfma_f32_16x16x32_bf16 v[112:115], a[140:143], a[32:35], v[112:115]
    s_add_u32 m0, s28, 4096
    s_add_u32 s29, s30, 458752
    buffer_load_dwordx4 v10, s[12:15], s29 offen offset:0 lds
    v_mfma_f32_16x16x32_bf16 v[116:119], a[140:143], a[36:39], v[116:119]
    v_mfma_f32_16x16x32_bf16 v[120:123], a[140:143], a[40:43], v[120:123]
    buffer_load_dwordx4 v11, s[12:15], s29 offen offset:1024 lds
    v_mfma_f32_16x16x32_bf16 v[124:127], a[140:143], a[44:47], v[124:127]
    s_waitcnt lgkmcnt(0)
    v_mfma_f32_16x16x32_bf16 v[64:67], a[144:147], a[48:51], v[64:67]
    s_waitcnt vmcnt(10)
    ds_read_b64_tr_b16 a[128:129], v22 offset:16384
    v_mfma_f32_16x16x32_bf16 v[68:71], a[144:147], a[52:55], v[68:71]
    ds_read_b64_tr_b16 a[130:131], v22 offset:18432
    buffer_load_dwordx4 v12, s[12:15], s29 offen offset:2048 lds
    v_mfma_f32_16x16x32_bf16 v[72:75], a[144:147], a[56:59], v[72:75]
    ds_read_b128 a[64:67], v26 offset:49152
    v_mfma_f32_16x16x32_bf16 v[76:79], a[144:147], a[60:63], v[76:79]
    ds_read_b128 a[68:71], v26 offset:50176
    v_mfma_f32_16x16x32_bf16 v[80:83], a[148:151], a[48:51], v[80:83]
    ds_read_b128 a[72:75], v26 offset:51200
    buffer_load_dwordx4 v13, s[12:15], s29 offen offset:3072 lds
    v_mfma_f32_16x16x32_bf16 v[84:87], a[148:151], a[52:55], v[84:87]
    ds_read_b128 a[76:79], v26 offset:52224
    v_mfma_f32_16x16x32_bf16 v[88:91], a[148:151], a[56:59], v[88:91]
    s_add_u32 m0, s28, 8192
    s_add_u32 s29, s31, 0
    ds_read_b64_tr_b16 a[132:133], v23 offset:16384
    buffer_load_dwordx4 v10, s[12:15], s29 offen offset:0 lds
    v_mfma_f32_16x16x32_bf16 v[92:95], a[148:151], a[60:63], v[92:95]
    ds_read_b64_tr_b16 a[134:135], v23 offset:18432
    v_mfma_f32_16x16x32_bf16 v[96:99], a[152:155], a[48:51], v[96:99]
    ds_read_b64_tr_b16 a[136:137], v24 offset:16384
    v_mfma_f32_16x16x32_bf16 v[100:103], a[152:155], a[52:55], v[100:103]
    ds_read_b64_tr_b16 a[138:139], v24 offset:18432
    buffer_load_dwordx4 v11, s[12:15], s29 offen offset:1024 lds
    v_mfma_f32_16x16x32_bf16 v[104:107], a[152:155], a[56:59], v[104:107]
    ds_read_b64_tr_b16 a[140:141], v25 offset:16384
    v_mfma_f32_16x16x32_bf16 v[108:111], a[152:155], a[60:63], v[108:111]
    ds_read_b64_tr_b16 a[142:143], v25 offset:18432
    v_mfma_f32_16x16x32_bf16 v[112:115], a[156:159], a[48:51], v[112:115]
    buffer_load_dwordx4 v12, s[12:15], s29 offen offset:2048 lds
    v_mfma_f32_16x16x32_bf16 v[116:119], a[156:159], a[52:55], v[116:119]
    v_mfma_f32_16x16x32_bf16 v[120:123], a[156:159], a[56:59], v[120:123]
    buffer_load_dwordx4 v13, s[12:15], s29 offen offset:3072 lds
    v_mfma_f32_16x16x32_bf16 v[124:127], a[156:159], a[60:63], v[124:127]
    s_waitcnt lgkmcnt(0)
    v_mfma_f32_16x16x32_bf16 v[64:67], a[128:131], a[64:67], v[64:67]
    s_add_u32 m0, s28, 12288
    s_add_u32 s29, s31, 65536
    s_waitcnt vmcnt(12)
    ds_read_b64_tr_b16 a[144:145], v22 offset:20480
    v_mfma_f32_16x16x32_bf16 v[68:71], a[128:131], a[68:71], v[68:71]
    ds_read_b64_tr_b16 a[146:147], v22 offset:22528
    buffer_load_dwordx4 v10, s[12:15], s29 offen offset:0 lds
    v_mfma_f32_16x16x32_bf16 v[72:75], a[128:131], a[72:75], v[72:75]
    ds_read_b128 a[80:83], v26 offset:53248
    v_mfma_f32_16x16x32_bf16 v[76:79], a[128:131], a[76:79], v[76:79]
    ds_read_b128 a[84:87], v26 offset:54272
    v_mfma_f32_16x16x32_bf16 v[80:83], a[132:135], a[64:67], v[80:83]
    ds_read_b128 a[88:91], v26 offset:55296
    buffer_load_dwordx4 v11, s[12:15], s29 offen offset:1024 lds
    v_mfma_f32_16x16x32_bf16 v[84:87], a[132:135], a[68:71], v[84:87]
    ds_read_b128 a[92:95], v26 offset:56320
    v_lshlrev_b32 v32, 16, v224
    v_mfma_f32_16x16x32_bf16 v[88:91], a[132:135], a[72:75], v[88:91]
    ds_read_b64_tr_b16 a[148:149], v23 offset:20480
    v_and_b32 v33, s43, v224
    v_mfma_f32_16x16x32_bf16 v[92:95], a[132:135], a[76:79], v[92:95]
    ds_read_b64_tr_b16 a[150:151], v23 offset:22528
    v_lshlrev_b32 v34, 16, v225
    v_mfma_f32_16x16x32_bf16 v[96:99], a[136:139], a[64:67], v[96:99]
    ds_read_b64_tr_b16 a[152:153], v24 offset:20480
    buffer_load_dwordx4 v12, s[12:15], s29 offen offset:2048 lds
    v_mfma_f32_16x16x32_bf16 v[100:103], a[136:139], a[68:71], v[100:103]
    ds_read_b64_tr_b16 a[154:155], v24 offset:22528
    v_mfma_f32_16x16x32_bf16 v[104:107], a[136:139], a[72:75], v[104:107]
    ds_read_b64_tr_b16 a[156:157], v25 offset:20480
    v_and_b32 v35, s43, v225
    v_mfma_f32_16x16x32_bf16 v[108:111], a[136:139], a[76:79], v[108:111]
    ds_read_b64_tr_b16 a[158:159], v25 offset:22528
    buffer_load_dwordx4 v13, s[12:15], s29 offen offset:3072 lds
    v_mfma_f32_16x16x32_bf16 v[112:115], a[140:143], a[64:67], v[112:115]
    v_lshlrev_b32 v36, 16, v226
    v_and_b32 v37, s43, v226
    v_mfma_f32_16x16x32_bf16 v[116:119], a[140:143], a[68:71], v[116:119]
    v_lshlrev_b32 v38, 16, v227
    v_mfma_f32_16x16x32_bf16 v[120:123], a[140:143], a[72:75], v[120:123]
    s_add_u32 m0, s28, 16384
    s_add_u32 s29, s31, 131072
    buffer_load_dwordx4 v10, s[12:15], s29 offen offset:0 lds
    v_mfma_f32_16x16x32_bf16 v[124:127], a[140:143], a[76:79], v[124:127]
    s_waitcnt lgkmcnt(0)
    v_and_b32 v39, s43, v227
    v_mfma_f32_16x16x32_bf16 v[64:67], a[144:147], a[80:83], v[64:67]
    s_waitcnt vmcnt(13)
    ds_read_b64_tr_b16 a[128:129], v22 offset:0
    v_lshlrev_b32 v40, 16, v228
    v_mfma_f32_16x16x32_bf16 v[68:71], a[144:147], a[84:87], v[68:71]
    ds_read_b64_tr_b16 a[130:131], v22 offset:2048
    buffer_load_dwordx4 v11, s[12:15], s29 offen offset:1024 lds
    v_mfma_f32_16x16x32_bf16 v[72:75], a[144:147], a[88:91], v[72:75]
    ds_read_b128 a[96:99], v26 offset:57344
    v_mfma_f32_16x16x32_bf16 v[76:79], a[144:147], a[92:95], v[76:79]
    ds_read_b128 a[100:103], v26 offset:58368
    v_and_b32 v41, s43, v228
    v_mfma_f32_16x16x32_bf16 v[80:83], a[148:151], a[80:83], v[80:83]
    ds_read_b128 a[104:107], v26 offset:59392
    buffer_load_dwordx4 v12, s[12:15], s29 offen offset:2048 lds
    v_mfma_f32_16x16x32_bf16 v[84:87], a[148:151], a[84:87], v[84:87]
    ds_read_b128 a[108:111], v26 offset:60416
    v_mfma_f32_16x16x32_bf16 v[88:91], a[148:151], a[88:91], v[88:91]
    ds_read_b64_tr_b16 a[132:133], v23 offset:0
    v_lshlrev_b32 v42, 16, v229
    v_mfma_f32_16x16x32_bf16 v[92:95], a[148:151], a[92:95], v[92:95]
    ds_read_b64_tr_b16 a[134:135], v23 offset:2048
    v_and_b32 v43, s43, v229
    v_mfma_f32_16x16x32_bf16 v[96:99], a[152:155], a[80:83], v[96:99]
    ds_read_b64_tr_b16 a[136:137], v24 offset:0
    buffer_load_dwordx4 v13, s[12:15], s29 offen offset:3072 lds
    v_mfma_f32_16x16x32_bf16 v[100:103], a[152:155], a[84:87], v[100:103]
    ds_read_b64_tr_b16 a[138:139], v24 offset:2048
    v_mfma_f32_16x16x32_bf16 v[104:107], a[152:155], a[88:91], v[104:107]
    ds_read_b64_tr_b16 a[140:141], v25 offset:0
    v_lshlrev_b32 v44, 16, v230
    v_mfma_f32_16x16x32_bf16 v[108:111], a[152:155], a[92:95], v[108:111]
    s_add_u32 m0, s28, 20480
    s_add_u32 s29, s31, 196608
    ds_read_b64_tr_b16 a[142:143], v25 offset:2048
    buffer_load_dwordx4 v10, s[12:15], s29 offen offset:0 lds
    v_mfma_f32_16x16x32_bf16 v[112:115], a[156:159], a[80:83], v[112:115]
    v_mfma_f32_16x16x32_bf16 v[116:119], a[156:159], a[84:87], v[116:119]
    v_and_b32 v45, s43, v230
    v_mfma_f32_16x16x32_bf16 v[120:123], a[156:159], a[88:91], v[120:123]
    buffer_load_dwordx4 v11, s[12:15], s29 offen offset:1024 lds
    v_mfma_f32_16x16x32_bf16 v[124:127], a[156:159], a[92:95], v[124:127]
    s_waitcnt lgkmcnt(0)
    v_lshlrev_b32 v46, 16, v231
    v_and_b32 v47, s43, v231
    v_mfma_f32_16x16x32_bf16 v[64:67], a[128:131], a[96:99], v[64:67]
    s_waitcnt vmcnt(14)
    ds_read_b64_tr_b16 a[144:145], v22 offset:4096
    v_lshlrev_b32 v48, 16, v232
    v_mfma_f32_16x16x32_bf16 v[68:71], a[128:131], a[100:103], v[68:71]
    ds_read_b64_tr_b16 a[146:147], v22 offset:6144
    buffer_load_dwordx4 v12, s[12:15], s29 offen offset:2048 lds
    v_mfma_f32_16x16x32_bf16 v[72:75], a[128:131], a[104:107], v[72:75]
    ds_read_b128 a[112:115], v26 offset:61440
    v_mfma_f32_16x16x32_bf16 v[76:79], a[128:131], a[108:111], v[76:79]
    ds_read_b128 a[116:119], v26 offset:62464
    v_and_b32 v49, s43, v232
    v_mfma_f32_16x16x32_bf16 v[80:83], a[132:135], a[96:99], v[80:83]
    ds_read_b128 a[120:123], v26 offset:63488
    buffer_load_dwordx4 v13, s[12:15], s29 offen offset:3072 lds
    v_mfma_f32_16x16x32_bf16 v[84:87], a[132:135], a[100:103], v[84:87]
    ds_read_b128 a[124:127], v26 offset:64512
    v_mfma_f32_16x16x32_bf16 v[88:91], a[132:135], a[104:107], v[88:91]
    ds_read_b64_tr_b16 a[148:149], v23 offset:4096
    v_lshlrev_b32 v50, 16, v233
    v_mfma_f32_16x16x32_bf16 v[92:95], a[132:135], a[108:111], v[92:95]
    ds_read_b64_tr_b16 a[150:151], v23 offset:6144
    v_and_b32 v51, s43, v233
    v_mfma_f32_16x16x32_bf16 v[96:99], a[136:139], a[96:99], v[96:99]
    s_add_u32 m0, s28, 0
    s_add_u32 s29, s31, 262144
    ds_read_b64_tr_b16 a[152:153], v24 offset:4096
    buffer_load_dwordx4 v10, s[12:15], s29 offen offset:0 lds
    v_mfma_f32_16x16x32_bf16 v[100:103], a[136:139], a[100:103], v[100:103]
    ds_read_b64_tr_b16 a[154:155], v24 offset:6144
    v_mfma_f32_16x16x32_bf16 v[104:107], a[136:139], a[104:107], v[104:107]
    ds_read_b64_tr_b16 a[156:157], v25 offset:4096
    v_mfma_f32_16x16x32_bf16 v[108:111], a[136:139], a[108:111], v[108:111]
    ds_read_b64_tr_b16 a[158:159], v25 offset:6144
    buffer_load_dwordx4 v11, s[12:15], s29 offen offset:1024 lds
    v_mfma_f32_16x16x32_bf16 v[112:115], a[140:143], a[96:99], v[112:115]
    v_mfma_f32_16x16x32_bf16 v[116:119], a[140:143], a[100:103], v[116:119]
    v_lshlrev_b32 v52, 16, v234
    v_and_b32 v53, s43, v234
    v_mfma_f32_16x16x32_bf16 v[120:123], a[140:143], a[104:107], v[120:123]
    buffer_load_dwordx4 v12, s[12:15], s29 offen offset:2048 lds
    v_mfma_f32_16x16x32_bf16 v[124:127], a[140:143], a[108:111], v[124:127]
    s_waitcnt lgkmcnt(0)
    v_lshlrev_b32 v54, 16, v235
    v_and_b32 v55, s43, v235
    v_mfma_f32_16x16x32_bf16 v[64:67], a[144:147], a[112:115], v[64:67]
    v_lshlrev_b32 v56, 16, v236
    v_mfma_f32_16x16x32_bf16 v[68:71], a[144:147], a[116:119], v[68:71]
    s_waitcnt vmcnt(15)
    ds_read_b64_tr_b16 a[128:129], v22 offset:8192
    buffer_load_dwordx4 v13, s[12:15], s29 offen offset:3072 lds
    v_mfma_f32_16x16x32_bf16 v[72:75], a[144:147], a[120:123], v[72:75]
    ds_read_b64_tr_b16 a[130:131], v22 offset:10240
    v_mfma_f32_16x16x32_bf16 v[76:79], a[144:147], a[124:127], v[76:79]
    v_and_b32 v57, s43, v236
    v_lshlrev_b32 v58, 16, v237
    v_mfma_f32_16x16x32_bf16 v[80:83], a[148:151], a[112:115], v[80:83]
    s_add_u32 m0, s28, 4096
    s_add_u32 s29, s31, 327680
    ds_read_b64_tr_b16 a[132:133], v23 offset:8192
    buffer_load_dwordx4 v10, s[12:15], s29 offen offset:0 lds
    v_mfma_f32_16x16x32_bf16 v[84:87], a[148:151], a[116:119], v[84:87]
    ds_read_b64_tr_b16 a[134:135], v23 offset:10240
    v_mfma_f32_16x16x32_bf16 v[88:91], a[148:151], a[120:123], v[88:91]
    v_mfma_f32_16x16x32_bf16 v[92:95], a[148:151], a[124:127], v[92:95]
    ds_read_b64_tr_b16 a[136:137], v24 offset:8192
    v_mfma_f32_16x16x32_bf16 v[96:99], a[152:155], a[112:115], v[96:99]
    ds_read_b64_tr_b16 a[138:139], v24 offset:10240
    buffer_load_dwordx4 v11, s[12:15], s29 offen offset:1024 lds
    v_mfma_f32_16x16x32_bf16 v[100:103], a[152:155], a[116:119], v[100:103]
    v_mfma_f32_16x16x32_bf16 v[104:107], a[152:155], a[120:123], v[104:107]
    ds_read_b64_tr_b16 a[140:141], v25 offset:8192
    v_and_b32 v59, s43, v237
    v_mfma_f32_16x16x32_bf16 v[108:111], a[152:155], a[124:127], v[108:111]
    ds_read_b64_tr_b16 a[142:143], v25 offset:10240
    buffer_load_dwordx4 v12, s[12:15], s29 offen offset:2048 lds
    v_mfma_f32_16x16x32_bf16 v[112:115], a[156:159], a[112:115], v[112:115]
    v_lshlrev_b32 v60, 16, v238
    v_mfma_f32_16x16x32_bf16 v[116:119], a[156:159], a[116:119], v[116:119]
    v_and_b32 v61, s43, v238
    v_mfma_f32_16x16x32_bf16 v[120:123], a[156:159], a[120:123], v[120:123]
    buffer_load_dwordx4 v13, s[12:15], s29 offen offset:3072 lds
    v_lshlrev_b32 v62, 16, v239
    v_mfma_f32_16x16x32_bf16 v[124:127], a[156:159], a[124:127], v[124:127]
    s_waitcnt lgkmcnt(0)
    v_and_b32 v63, s43, v239
    v_mfma_f32_16x16x32_bf16 v[128:131], a[128:131], a[0:3], 0
    s_add_u32 m0, s28, 8192
    s_add_u32 s29, s31, 393216
    v_exp_f32 v192, v64
    v_mfma_f32_16x16x32_bf16 v[132:135], a[128:131], a[4:7], 0
    s_waitcnt vmcnt(16)
    ds_read_b64_tr_b16 a[144:145], v22 offset:12288
    v_exp_f32 v193, v65
    v_mfma_f32_16x16x32_bf16 v[136:139], a[128:131], a[8:11], 0
    ds_read_b64_tr_b16 a[146:147], v22 offset:14336
    buffer_load_dwordx4 v10, s[12:15], s29 offen offset:0 lds
    v_exp_f32 v194, v66
    v_mfma_f32_16x16x32_bf16 v[140:143], a[128:131], a[12:15], 0
    v_exp_f32 v195, v67
    v_add_f32 v192, 1.0, v192
    v_add_f32 v193, 1.0, v193
    v_mfma_f32_16x16x32_bf16 v[144:147], a[132:135], a[0:3], 0
    ds_read_b64_tr_b16 a[148:149], v23 offset:12288
    v_add_f32 v194, 1.0, v194
    v_add_f32 v195, 1.0, v195
    v_mfma_f32_16x16x32_bf16 v[148:151], a[132:135], a[4:7], 0
    ds_read_b64_tr_b16 a[150:151], v23 offset:14336
    v_rcp_f32 v192, v192
    v_rcp_f32 v193, v193
    v_mfma_f32_16x16x32_bf16 v[152:155], a[132:135], a[8:11], 0
    buffer_load_dwordx4 v11, s[12:15], s29 offen offset:1024 lds
    v_rcp_f32 v194, v194
    v_mfma_f32_16x16x32_bf16 v[156:159], a[132:135], a[12:15], 0
    ds_read_b64_tr_b16 a[152:153], v24 offset:12288
    v_rcp_f32 v195, v195
    v_mul_f32 v192, v64, v192
    v_mfma_f32_16x16x32_bf16 v[160:163], a[136:139], a[0:3], 0
    ds_read_b64_tr_b16 a[154:155], v24 offset:14336
    v_mul_f32 v193, v65, v193
    v_mul_f32 v194, v66, v194
    v_mul_f32 v195, v67, v195
    v_mfma_f32_16x16x32_bf16 v[164:167], a[136:139], a[4:7], 0
    v_cvt_pk_bf16_f32 v64, v192, v193
    v_cvt_pk_bf16_f32 v65, v194, v195
    v_exp_f32 v196, v80
    v_mfma_f32_16x16x32_bf16 v[168:171], a[136:139], a[8:11], 0
    ds_read_b64_tr_b16 a[156:157], v25 offset:12288
    buffer_load_dwordx4 v12, s[12:15], s29 offen offset:2048 lds
    v_exp_f32 v197, v81
    v_mfma_f32_16x16x32_bf16 v[172:175], a[136:139], a[12:15], 0
    ds_read_b64_tr_b16 a[158:159], v25 offset:14336
    v_exp_f32 v198, v82
    v_mfma_f32_16x16x32_bf16 v[176:179], a[140:143], a[0:3], 0
    v_exp_f32 v199, v83
    v_add_f32 v196, 1.0, v196
    v_add_f32 v197, 1.0, v197
    v_mfma_f32_16x16x32_bf16 v[180:183], a[140:143], a[4:7], 0
    v_add_f32 v198, 1.0, v198
    v_add_f32 v199, 1.0, v199
    v_rcp_f32 v196, v196
    v_mfma_f32_16x16x32_bf16 v[184:187], a[140:143], a[8:11], 0
    buffer_load_dwordx4 v13, s[12:15], s29 offen offset:3072 lds
    v_rcp_f32 v197, v197
    v_mfma_f32_16x16x32_bf16 v[188:191], a[140:143], a[12:15], 0
    s_waitcnt lgkmcnt(0)
    v_rcp_f32 v198, v198
    v_rcp_f32 v199, v199
    v_mfma_f32_16x16x32_bf16 v[128:131], a[144:147], a[16:19], v[128:131]
    s_add_u32 m0, s28, 12288
    s_add_u32 s29, s31, 458752
    v_mul_f32 v196, v80, v196
    v_mul_f32 v197, v81, v197
    v_mfma_f32_16x16x32_bf16 v[132:135], a[144:147], a[20:23], v[132:135]
    s_waitcnt vmcnt(16)
    ds_read_b64_tr_b16 a[128:129], v22 offset:16384
    v_mul_f32 v198, v82, v198
    v_mul_f32 v199, v83, v199
    v_mfma_f32_16x16x32_bf16 v[136:139], a[144:147], a[24:27], v[136:139]
    ds_read_b64_tr_b16 a[130:131], v22 offset:18432
    buffer_load_dwordx4 v10, s[12:15], s29 offen offset:0 lds
    v_cvt_pk_bf16_f32 v66, v196, v197
    v_cvt_pk_bf16_f32 v67, v198, v199
    v_mfma_f32_16x16x32_bf16 v[140:143], a[144:147], a[28:31], v[140:143]
    v_exp_f32 v192, v68
    v_exp_f32 v193, v69
    v_mfma_f32_16x16x32_bf16 v[144:147], a[148:151], a[16:19], v[144:147]
    ds_read_b64_tr_b16 a[132:133], v23 offset:16384
    v_exp_f32 v194, v70
    v_mfma_f32_16x16x32_bf16 v[148:151], a[148:151], a[20:23], v[148:151]
    ds_read_b64_tr_b16 a[134:135], v23 offset:18432
    v_exp_f32 v195, v71
    v_add_f32 v192, 1.0, v192
    v_mfma_f32_16x16x32_bf16 v[152:155], a[148:151], a[24:27], v[152:155]
    buffer_load_dwordx4 v11, s[12:15], s29 offen offset:1024 lds
    v_add_f32 v193, 1.0, v193
    v_add_f32 v194, 1.0, v194
    v_mfma_f32_16x16x32_bf16 v[156:159], a[148:151], a[28:31], v[156:159]
    ds_read_b64_tr_b16 a[136:137], v24 offset:16384
    v_add_f32 v195, 1.0, v195
    v_rcp_f32 v192, v192
    v_mfma_f32_16x16x32_bf16 v[160:163], a[152:155], a[16:19], v[160:163]
    ds_read_b64_tr_b16 a[138:139], v24 offset:18432
    v_rcp_f32 v193, v193
    v_mfma_f32_16x16x32_bf16 v[164:167], a[152:155], a[20:23], v[164:167]
    v_rcp_f32 v194, v194
    v_rcp_f32 v195, v195
    v_mfma_f32_16x16x32_bf16 v[168:171], a[152:155], a[24:27], v[168:171]
    ds_read_b64_tr_b16 a[140:141], v25 offset:16384
    buffer_load_dwordx4 v12, s[12:15], s29 offen offset:2048 lds
    v_mul_f32 v192, v68, v192
    v_mul_f32 v193, v69, v193
    v_mfma_f32_16x16x32_bf16 v[172:175], a[152:155], a[28:31], v[172:175]
    ds_read_b64_tr_b16 a[142:143], v25 offset:18432
    v_mul_f32 v194, v70, v194
    v_mul_f32 v195, v71, v195
    v_cvt_pk_bf16_f32 v68, v192, v193
    v_mfma_f32_16x16x32_bf16 v[176:179], a[156:159], a[16:19], v[176:179]
    v_cvt_pk_bf16_f32 v69, v194, v195
    v_exp_f32 v196, v84
    v_mfma_f32_16x16x32_bf16 v[180:183], a[156:159], a[20:23], v[180:183]
    v_exp_f32 v197, v85
    v_exp_f32 v198, v86
    v_mfma_f32_16x16x32_bf16 v[184:187], a[156:159], a[24:27], v[184:187]
    buffer_load_dwordx4 v13, s[12:15], s29 offen offset:3072 lds
    v_exp_f32 v199, v87
    v_mfma_f32_16x16x32_bf16 v[188:191], a[156:159], a[28:31], v[188:191]
    s_waitcnt lgkmcnt(0)
    v_add_f32 v196, 1.0, v196
    v_add_f32 v197, 1.0, v197
    v_add_f32 v198, 1.0, v198
    v_add_f32 v199, 1.0, v199
    v_mfma_f32_16x16x32_bf16 v[128:131], a[128:131], a[32:35], v[128:131]
    v_rcp_f32 v196, v196
    v_rcp_f32 v197, v197
    v_mfma_f32_16x16x32_bf16 v[132:135], a[128:131], a[36:39], v[132:135]
    s_waitcnt vmcnt(16)
    ds_read_b64_tr_b16 a[144:145], v22 offset:20480
    v_rcp_f32 v198, v198
    v_mfma_f32_16x16x32_bf16 v[136:139], a[128:131], a[40:43], v[136:139]
    ds_read_b64_tr_b16 a[146:147], v22 offset:22528
    v_rcp_f32 v199, v199
    v_mul_f32 v196, v84, v196
    v_mfma_f32_16x16x32_bf16 v[140:143], a[128:131], a[44:47], v[140:143]
    v_mul_f32 v197, v85, v197
    v_mul_f32 v198, v86, v198
    v_mul_f32 v199, v87, v199
    v_mfma_f32_16x16x32_bf16 v[144:147], a[132:135], a[32:35], v[144:147]
    ds_read_b64_tr_b16 a[148:149], v23 offset:20480
    buffer_store_dwordx4 v[248:251], v30, s[76:79], s70 offen offset:0 sc1
    v_cvt_pk_bf16_f32 v70, v196, v197
    v_cvt_pk_bf16_f32 v71, v198, v199
    v_mfma_f32_16x16x32_bf16 v[148:151], a[132:135], a[36:39], v[148:151]
    ds_read_b64_tr_b16 a[150:151], v23 offset:22528
    v_exp_f32 v192, v72
    v_mfma_f32_16x16x32_bf16 v[152:155], a[132:135], a[40:43], v[152:155]
    v_exp_f32 v193, v73
    v_exp_f32 v194, v74
    v_mfma_f32_16x16x32_bf16 v[156:159], a[132:135], a[44:47], v[156:159]
    ds_read_b64_tr_b16 a[152:153], v24 offset:20480
    v_exp_f32 v195, v75
    v_mfma_f32_16x16x32_bf16 v[160:163], a[136:139], a[32:35], v[160:163]
    ds_read_b64_tr_b16 a[154:155], v24 offset:22528
    buffer_store_dwordx4 v[248:251], v30, s[76:79], s70 offen offset:1024 sc1
    v_add_f32 v192, 1.0, v192
    v_add_f32 v193, 1.0, v193
    v_mfma_f32_16x16x32_bf16 v[164:167], a[136:139], a[36:39], v[164:167]
    v_add_f32 v194, 1.0, v194
    v_add_f32 v195, 1.0, v195
    v_rcp_f32 v192, v192
    v_mfma_f32_16x16x32_bf16 v[168:171], a[136:139], a[40:43], v[168:171]
    ds_read_b64_tr_b16 a[156:157], v25 offset:20480
    v_rcp_f32 v193, v193
    v_mfma_f32_16x16x32_bf16 v[172:175], a[136:139], a[44:47], v[172:175]
    ds_read_b64_tr_b16 a[158:159], v25 offset:22528
    v_rcp_f32 v194, v194
    v_mfma_f32_16x16x32_bf16 v[176:179], a[140:143], a[32:35], v[176:179]
    v_rcp_f32 v195, v195
    v_mul_f32 v192, v72, v192
    v_mul_f32 v193, v73, v193
    v_mfma_f32_16x16x32_bf16 v[180:183], a[140:143], a[36:39], v[180:183]
    v_mul_f32 v194, v74, v194
    v_mul_f32 v195, v75, v195
    v_cvt_pk_bf16_f32 v72, v192, v193
    v_mfma_f32_16x16x32_bf16 v[184:187], a[140:143], a[40:43], v[184:187]
    v_cvt_pk_bf16_f32 v73, v194, v195
    v_exp_f32 v196, v88
    v_mfma_f32_16x16x32_bf16 v[188:191], a[140:143], a[44:47], v[188:191]
    s_waitcnt lgkmcnt(0)
    v_exp_f32 v197, v89
    v_exp_f32 v198, v90
    v_mfma_f32_16x16x32_bf16 v[128:131], a[144:147], a[48:51], v[128:131]
    v_exp_f32 v199, v91
    v_add_f32 v196, 1.0, v196
    v_add_f32 v197, 1.0, v197
    v_mfma_f32_16x16x32_bf16 v[132:135], a[144:147], a[52:55], v[132:135]
    s_waitcnt vmcnt(14)
    ds_read_b64_tr_b16 a[128:129], v22 offset:0
    v_add_f32 v198, 1.0, v198
    v_add_f32 v199, 1.0, v199
    v_mfma_f32_16x16x32_bf16 v[136:139], a[144:147], a[56:59], v[136:139]
    ds_read_b64_tr_b16 a[130:131], v22 offset:2048
    v_rcp_f32 v196, v196
    v_mfma_f32_16x16x32_bf16 v[140:143], a[144:147], a[60:63], v[140:143]
    v_rcp_f32 v197, v197
    v_rcp_f32 v198, v198
    v_mfma_f32_16x16x32_bf16 v[144:147], a[148:151], a[48:51], v[144:147]
    ds_read_b64_tr_b16 a[132:133], v23 offset:0
    buffer_store_dwordx4 v[248:251], v30, s[76:79], s70 offen offset:2048 sc1
    v_rcp_f32 v199, v199
    v_mfma_f32_16x16x32_bf16 v[148:151], a[148:151], a[52:55], v[148:151]
    ds_read_b64_tr_b16 a[134:135], v23 offset:2048
    v_mul_f32 v196, v88, v196
    v_mul_f32 v197, v89, v197
    v_mfma_f32_16x16x32_bf16 v[152:155], a[148:151], a[56:59], v[152:155]
    v_mul_f32 v198, v90, v198
    v_mul_f32 v199, v91, v199
    v_cvt_pk_bf16_f32 v74, v196, v197
    v_cvt_pk_bf16_f32 v75, v198, v199
    v_mfma_f32_16x16x32_bf16 v[156:159], a[148:151], a[60:63], v[156:159]
    ds_read_b64_tr_b16 a[136:137], v24 offset:0
    v_exp_f32 v192, v76
    v_mfma_f32_16x16x32_bf16 v[160:163], a[152:155], a[48:51], v[160:163]
    ds_read_b64_tr_b16 a[138:139], v24 offset:2048
    buffer_store_dwordx4 v[248:251], v30, s[76:79], s70 offen offset:3072 sc1
    v_exp_f32 v193, v77
    v_mfma_f32_16x16x32_bf16 v[164:167], a[152:155], a[52:55], v[164:167]
    v_exp_f32 v194, v78
    v_exp_f32 v195, v79
    v_mfma_f32_16x16x32_bf16 v[168:171], a[152:155], a[56:59], v[168:171]
    ds_read_b64_tr_b16 a[140:141], v25 offset:0
    v_add_f32 v192, 1.0, v192
    v_add_f32 v193, 1.0, v193
    v_mfma_f32_16x16x32_bf16 v[172:175], a[152:155], a[60:63], v[172:175]
    ds_read_b64_tr_b16 a[142:143], v25 offset:2048
    v_add_f32 v194, 1.0, v194
    v_add_f32 v195, 1.0, v195
    v_mfma_f32_16x16x32_bf16 v[176:179], a[156:159], a[48:51], v[176:179]
    buffer_load_dword v242, v241, s[72:75], 0 offen sc1
    v_rcp_f32 v192, v192
    v_mfma_f32_16x16x32_bf16 v[180:183], a[156:159], a[52:55], v[180:183]
    v_rcp_f32 v193, v193
    v_rcp_f32 v194, v194
    v_mfma_f32_16x16x32_bf16 v[184:187], a[156:159], a[56:59], v[184:187]
    v_rcp_f32 v195, v195
    v_mul_f32 v192, v76, v192
    v_mul_f32 v193, v77, v193
    v_mfma_f32_16x16x32_bf16 v[188:191], a[156:159], a[60:63], v[188:191]
    s_waitcnt lgkmcnt(0)
    v_mul_f32 v194, v78, v194
    v_mul_f32 v195, v79, v195
    v_cvt_pk_bf16_f32 v76, v192, v193
    v_mfma_f32_16x16x32_bf16 v[128:131], a[128:131], a[64:67], v[128:131]
    v_cvt_pk_bf16_f32 v77, v194, v195
    v_exp_f32 v196, v92
    v_mfma_f32_16x16x32_bf16 v[132:135], a[128:131], a[68:71], v[132:135]
    s_waitcnt vmcnt(13)
    ds_read_b64_tr_b16 a[144:145], v22 offset:4096
    v_exp_f32 v197, v93
    v_mfma_f32_16x16x32_bf16 v[136:139], a[128:131], a[72:75], v[136:139]
    ds_read_b64_tr_b16 a[146:147], v22 offset:6144
    v_exp_f32 v198, v94
    v_mfma_f32_16x16x32_bf16 v[140:143], a[128:131], a[76:79], v[140:143]
    v_exp_f32 v199, v95
    v_add_f32 v196, 1.0, v196
    v_add_f32 v197, 1.0, v197
    v_mfma_f32_16x16x32_bf16 v[144:147], a[132:135], a[64:67], v[144:147]
    ds_read_b64_tr_b16 a[148:149], v23 offset:4096
    v_add_f32 v198, 1.0, v198
    v_add_f32 v199, 1.0, v199
    v_mfma_f32_16x16x32_bf16 v[148:151], a[132:135], a[68:71], v[148:151]
    ds_read_b64_tr_b16 a[150:151], v23 offset:6144
    v_rcp_f32 v196, v196
    v_mfma_f32_16x16x32_bf16 v[152:155], a[132:135], a[72:75], v[152:155]
    v_rcp_f32 v197, v197
    v_rcp_f32 v198, v198
    v_mfma_f32_16x16x32_bf16 v[156:159], a[132:135], a[76:79], v[156:159]
    ds_read_b64_tr_b16 a[152:153], v24 offset:4096
    v_rcp_f32 v199, v199
    v_mul_f32 v196, v92, v196
    v_mfma_f32_16x16x32_bf16 v[160:163], a[136:139], a[64:67], v[160:163]
    ds_read_b64_tr_b16 a[154:155], v24 offset:6144
    v_mul_f32 v197, v93, v197
    v_mul_f32 v198, v94, v198
    v_mfma_f32_16x16x32_bf16 v[164:167], a[136:139], a[68:71], v[164:167]
    v_mul_f32 v199, v95, v199
    v_cvt_pk_bf16_f32 v78, v196, v197
    v_cvt_pk_bf16_f32 v79, v198, v199
    v_mfma_f32_16x16x32_bf16 v[168:171], a[136:139], a[72:75], v[168:171]
    ds_write_b128 v27, v[64:67] offset:0
    ds_write_b128 v27, v[68:71] offset:1024
    ds_write_b128 v27, v[72:75] offset:2048
    ds_write_b128 v27, v[76:79] offset:3072
    ds_read_b64_tr_b16 a[156:157], v25 offset:4096
    v_mfma_f32_16x16x32_bf16 v[172:175], a[136:139], a[76:79], v[172:175]
    ds_read_b64_tr_b16 a[158:159], v25 offset:6144
    v_mfma_f32_16x16x32_bf16 v[176:179], a[140:143], a[64:67], v[176:179]
    v_mfma_f32_16x16x32_bf16 v[180:183], a[140:143], a[68:71], v[180:183]
    v_mfma_f32_16x16x32_bf16 v[184:187], a[140:143], a[72:75], v[184:187]
    v_mfma_f32_16x16x32_bf16 v[188:191], a[140:143], a[76:79], v[188:191]
    s_mov_b32 s85, 0x40000
    v_exp_f32 v192, v96
    s_mov_b32 s86, 0x80808080
standalone__conformer_family_zipformer__speech_kernel_ev:
    s_waitcnt vmcnt(0)
    v_and_b32 v244, s86, v242
    v_cmp_ne_u32 vcc, s86, v244
    s_nop 0
    s_cmp_eq_u64 vcc, 0
    s_cbranch_scc1 standalone__conformer_family_zipformer__speech_kernel_evx
    s_sleep 4
    buffer_load_dword v242, v241, s[72:75], 0 offen sc1
    s_waitcnt vmcnt(0)
    s_sub_u32 s85, s85, 1
    s_cbranch_scc0 standalone__conformer_family_zipformer__speech_kernel_ev
standalone__conformer_family_zipformer__speech_kernel_evx:
    s_xor_b32 s84, s2, 8
    s_lshr_b32 s84, s84, 2
    s_and_b32 s86, s2, 3
    s_lshl_b32 s86, s86, 3
    v_readlane_b32 s84, v242, s84
    s_nop 0
    s_lshr_b32 s84, s84, s86
    s_and_b32 s84, s84, 0xff
    s_cmp_eq_u32 s84, s82
    s_cselect_b32 s83, 1, 0
    s_waitcnt lgkmcnt(0)
    v_mfma_f32_16x16x32_bf16 v[128:131], a[144:147], a[80:83], v[128:131]
    s_add_u32 s62, s32, 0
    v_exp_f32 v193, v97
    v_mfma_f32_16x16x32_bf16 v[132:135], a[144:147], a[84:87], v[132:135]
    ds_read_b64_tr_b16 a[128:129], v22 offset:8192
    buffer_load_dwordx4 a[192:195], v30, s[24:27], s62 offen offset:0
    v_exp_f32 v194, v98
    v_mfma_f32_16x16x32_bf16 v[136:139], a[144:147], a[88:91], v[136:139]
    ds_read_b64_tr_b16 a[130:131], v22 offset:10240
    v_exp_f32 v195, v99
    v_add_f32 v192, 1.0, v192
    v_add_f32 v193, 1.0, v193
    v_mfma_f32_16x16x32_bf16 v[140:143], a[144:147], a[92:95], v[140:143]
    buffer_load_dwordx4 a[196:199], v30, s[24:27], s62 offen offset:1024
    v_add_f32 v194, 1.0, v194
    v_add_f32 v195, 1.0, v195
    v_mfma_f32_16x16x32_bf16 v[144:147], a[148:151], a[80:83], v[144:147]
    ds_read_b64_tr_b16 a[132:133], v23 offset:8192
    buffer_load_dwordx4 a[200:203], v30, s[24:27], s62 offen offset:2048
    v_rcp_f32 v192, v192
    v_mfma_f32_16x16x32_bf16 v[148:151], a[148:151], a[84:87], v[148:151]
    ds_read_b64_tr_b16 a[134:135], v23 offset:10240
    v_rcp_f32 v193, v193
    v_rcp_f32 v194, v194
    v_mfma_f32_16x16x32_bf16 v[152:155], a[148:151], a[88:91], v[152:155]
    buffer_load_dwordx4 a[204:207], v30, s[24:27], s62 offen offset:3072
    v_rcp_f32 v195, v195
    v_mul_f32 v192, v96, v192
    v_mfma_f32_16x16x32_bf16 v[156:159], a[148:151], a[92:95], v[156:159]
    ds_read_b64_tr_b16 a[136:137], v24 offset:8192
    s_add_u32 s62, s32, 8192
    v_mul_f32 v193, v97, v193
    v_mul_f32 v194, v98, v194
    v_mfma_f32_16x16x32_bf16 v[160:163], a[152:155], a[80:83], v[160:163]
    ds_read_b64_tr_b16 a[138:139], v24 offset:10240
    v_mul_f32 v195, v99, v195
    v_cvt_pk_bf16_f32 v96, v192, v193
    v_mfma_f32_16x16x32_bf16 v[164:167], a[152:155], a[84:87], v[164:167]
    buffer_load_dwordx4 a[208:211], v30, s[24:27], s62 offen offset:0
    v_cvt_pk_bf16_f32 v97, v194, v195
    v_exp_f32 v196, v112
    v_mfma_f32_16x16x32_bf16 v[168:171], a[152:155], a[88:91], v[168:171]
    ds_read_b64_tr_b16 a[140:141], v25 offset:8192
    buffer_load_dwordx4 a[212:215], v30, s[24:27], s62 offen offset:1024
    v_exp_f32 v197, v113
    v_mfma_f32_16x16x32_bf16 v[172:175], a[152:155], a[92:95], v[172:175]
    ds_read_b64_tr_b16 a[142:143], v25 offset:10240
    v_exp_f32 v198, v114
    v_exp_f32 v199, v115
    v_mfma_f32_16x16x32_bf16 v[176:179], a[156:159], a[80:83], v[176:179]
    buffer_load_dwordx4 a[216:219], v30, s[24:27], s62 offen offset:2048
    v_add_f32 v196, 1.0, v196
    v_add_f32 v197, 1.0, v197
    v_mfma_f32_16x16x32_bf16 v[180:183], a[156:159], a[84:87], v[180:183]
    buffer_load_dwordx4 a[220:223], v30, s[24:27], s62 offen offset:3072
    v_add_f32 v198, 1.0, v198
    v_add_f32 v199, 1.0, v199
    v_rcp_f32 v196, v196
    v_mfma_f32_16x16x32_bf16 v[184:187], a[156:159], a[88:91], v[184:187]
    v_rcp_f32 v197, v197
    v_rcp_f32 v198, v198
    v_mfma_f32_16x16x32_bf16 v[188:191], a[156:159], a[92:95], v[188:191]
    s_waitcnt lgkmcnt(0)
    v_rcp_f32 v199, v199
    v_mul_f32 v196, v112, v196
    v_mfma_f32_16x16x32_bf16 v[128:131], a[128:131], a[96:99], v[128:131]
    s_add_u32 s62, s32, 16384
    v_mul_f32 v197, v113, v197
    v_mul_f32 v198, v114, v198
    v_mul_f32 v199, v115, v199
    v_mfma_f32_16x16x32_bf16 v[132:135], a[128:131], a[100:103], v[132:135]
    ds_read_b64_tr_b16 a[144:145], v22 offset:12288
    v_cvt_pk_bf16_f32 v98, v196, v197
    v_cvt_pk_bf16_f32 v99, v198, v199
    v_mfma_f32_16x16x32_bf16 v[136:139], a[128:131], a[104:107], v[136:139]
    ds_write_b128 v27, v[96:99] offset:4096
    ds_read_b64_tr_b16 a[146:147], v22 offset:14336
    v_mfma_f32_16x16x32_bf16 v[140:143], a[128:131], a[108:111], v[140:143]
    buffer_load_dwordx4 a[224:227], v30, s[24:27], s62 offen offset:0
    v_exp_f32 v192, v100
    v_mfma_f32_16x16x32_bf16 v[144:147], a[132:135], a[96:99], v[144:147]
    ds_read_b64_tr_b16 a[148:149], v23 offset:12288
    v_exp_f32 v193, v101
    v_mfma_f32_16x16x32_bf16 v[148:151], a[132:135], a[100:103], v[148:151]
    ds_read_b64_tr_b16 a[150:151], v23 offset:14336
    v_exp_f32 v194, v102
    v_mfma_f32_16x16x32_bf16 v[152:155], a[132:135], a[104:107], v[152:155]
    buffer_load_dwordx4 a[228:231], v30, s[24:27], s62 offen offset:1024
    v_exp_f32 v195, v103
    v_add_f32 v192, 1.0, v192
    v_mfma_f32_16x16x32_bf16 v[156:159], a[132:135], a[108:111], v[156:159]
    ds_read_b64_tr_b16 a[152:153], v24 offset:12288
    v_add_f32 v193, 1.0, v193
    v_add_f32 v194, 1.0, v194
    v_add_f32 v195, 1.0, v195
    v_mfma_f32_16x16x32_bf16 v[160:163], a[136:139], a[96:99], v[160:163]
    ds_read_b64_tr_b16 a[154:155], v24 offset:14336
    v_rcp_f32 v192, v192
    v_mfma_f32_16x16x32_bf16 v[164:167], a[136:139], a[100:103], v[164:167]
    buffer_load_dwordx4 a[232:235], v30, s[24:27], s62 offen offset:2048
    v_rcp_f32 v193, v193
    v_rcp_f32 v194, v194
    v_mfma_f32_16x16x32_bf16 v[168:171], a[136:139], a[104:107], v[168:171]
    ds_read_b64_tr_b16 a[156:157], v25 offset:12288
    v_rcp_f32 v195, v195
    v_mfma_f32_16x16x32_bf16 v[172:175], a[136:139], a[108:111], v[172:175]
    ds_read_b64_tr_b16 a[158:159], v25 offset:14336
    v_mul_f32 v192, v100, v192
    v_mul_f32 v193, v101, v193
    v_mul_f32 v194, v102, v194
    v_mfma_f32_16x16x32_bf16 v[176:179], a[140:143], a[96:99], v[176:179]
    buffer_load_dwordx4 a[236:239], v30, s[24:27], s62 offen offset:3072
    v_mul_f32 v195, v103, v195
    v_cvt_pk_bf16_f32 v100, v192, v193
    v_mfma_f32_16x16x32_bf16 v[180:183], a[140:143], a[100:103], v[180:183]
    v_cvt_pk_bf16_f32 v101, v194, v195
    v_exp_f32 v196, v116
    v_mfma_f32_16x16x32_bf16 v[184:187], a[140:143], a[104:107], v[184:187]
    v_exp_f32 v197, v117
    v_exp_f32 v198, v118
    v_mfma_f32_16x16x32_bf16 v[188:191], a[140:143], a[108:111], v[188:191]
    v_exp_f32 v199, v119
    v_add_f32 v196, 1.0, v196
    v_add_f32 v197, 1.0, v197
    s_barrier
    s_waitcnt lgkmcnt(0)
    v_mfma_f32_16x16x32_bf16 v[128:131], a[144:147], a[112:115], v[128:131]
    ds_read_b128 a[160:163], v26 offset:0
    v_add_f32 v198, 1.0, v198
    v_add_f32 v199, 1.0, v199
    v_mfma_f32_16x16x32_bf16 v[132:135], a[144:147], a[116:119], v[132:135]
    ds_read_b128 a[164:167], v26 offset:1024
    v_rcp_f32 v196, v196
    v_mfma_f32_16x16x32_bf16 v[136:139], a[144:147], a[120:123], v[136:139]
    v_rcp_f32 v197, v197
    v_rcp_f32 v198, v198
    v_mfma_f32_16x16x32_bf16 v[140:143], a[144:147], a[124:127], v[140:143]
    ds_read_b128 a[168:171], v26 offset:2048
    v_rcp_f32 v199, v199
    v_mul_f32 v196, v116, v196
    v_mfma_f32_16x16x32_bf16 v[144:147], a[148:151], a[112:115], v[144:147]
    v_mul_f32 v197, v117, v197
    v_mul_f32 v198, v118, v198
    v_mul_f32 v199, v119, v199
    v_mfma_f32_16x16x32_bf16 v[148:151], a[148:151], a[116:119], v[148:151]
    ds_read_b128 a[172:175], v26 offset:3072
    v_cvt_pk_bf16_f32 v102, v196, v197
    v_cvt_pk_bf16_f32 v103, v198, v199
    v_mfma_f32_16x16x32_bf16 v[152:155], a[148:151], a[120:123], v[152:155]
    ds_write_b128 v27, v[100:103] offset:5120
    s_add_u32 s62, s32, 24576
    v_mfma_f32_16x16x32_bf16 v[156:159], a[148:151], a[124:127], v[156:159]
    v_exp_f32 v192, v104
    v_mfma_f32_16x16x32_bf16 v[160:163], a[152:155], a[112:115], v[160:163]
    buffer_load_dwordx4 a[240:243], v30, s[24:27], s62 offen offset:0
    v_exp_f32 v193, v105
    v_mfma_f32_16x16x32_bf16 v[164:167], a[152:155], a[116:119], v[164:167]
    v_exp_f32 v194, v106
    v_exp_f32 v195, v107
    v_mfma_f32_16x16x32_bf16 v[168:171], a[152:155], a[120:123], v[168:171]
    buffer_load_dwordx4 a[244:247], v30, s[24:27], s62 offen offset:1024
    v_add_f32 v192, 1.0, v192
    v_add_f32 v193, 1.0, v193
    v_mfma_f32_16x16x32_bf16 v[172:175], a[152:155], a[124:127], v[172:175]
    buffer_load_dwordx4 a[248:251], v30, s[24:27], s62 offen offset:2048
    v_add_f32 v194, 1.0, v194
    v_add_f32 v195, 1.0, v195
    v_mfma_f32_16x16x32_bf16 v[176:179], a[156:159], a[112:115], v[176:179]
    v_rcp_f32 v192, v192
    v_rcp_f32 v193, v193
    v_mfma_f32_16x16x32_bf16 v[180:183], a[156:159], a[116:119], v[180:183]
    buffer_load_dwordx4 a[252:255], v30, s[24:27], s62 offen offset:3072
    v_rcp_f32 v194, v194
    v_mfma_f32_16x16x32_bf16 v[184:187], a[156:159], a[120:123], v[184:187]
    v_rcp_f32 v195, v195
    v_mul_f32 v192, v104, v192
    v_mul_f32 v193, v105, v193
    v_mfma_f32_16x16x32_bf16 v[188:191], a[156:159], a[124:127], v[188:191]
    s_waitcnt vmcnt(12) lgkmcnt(4)
    v_mul_f32 v194, v106, v194
    v_mul_f32 v195, v107, v195
    v_cvt_pk_bf16_f32 v104, v192, v193
    v_mfma_f32_16x16x32_bf16 v[64:67], a[192:195], a[160:163], 0
    s_add_u32 s63, s32, 4096
    ds_read_b128 a[176:179], v26 offset:8192
    v_cvt_pk_bf16_f32 v105, v194, v195
    s_waitcnt lgkmcnt(4)
    v_mfma_f32_16x16x32_bf16 v[68:71], a[192:195], a[164:167], 0
    buffer_load_dwordx4 a[64:67], v30, s[24:27], s63 offen offset:0
    v_exp_f32 v196, v120
    v_exp_f32 v197, v121
    s_waitcnt lgkmcnt(3)
    v_mfma_f32_16x16x32_bf16 v[72:75], a[192:195], a[168:171], 0
    s_waitcnt lgkmcnt(2)
    v_exp_f32 v198, v122
    v_exp_f32 v199, v123
    v_mfma_f32_16x16x32_bf16 v[76:79], a[192:195], a[172:175], 0
    buffer_load_dwordx4 a[68:71], v30, s[24:27], s63 offen offset:1024
    ds_read_b128 a[180:183], v26 offset:9216
    v_add_f32 v196, 1.0, v196
    v_add_f32 v197, 1.0, v197
    v_mfma_f32_16x16x32_bf16 v[80:83], a[196:199], a[160:163], 0
    buffer_load_dwordx4 a[72:75], v30, s[24:27], s63 offen offset:2048
    v_add_f32 v198, 1.0, v198
    v_add_f32 v199, 1.0, v199
    v_mfma_f32_16x16x32_bf16 v[84:87], a[196:199], a[164:167], 0
    v_rcp_f32 v196, v196
    v_rcp_f32 v197, v197
    v_mfma_f32_16x16x32_bf16 v[88:91], a[196:199], a[168:171], 0
    buffer_load_dwordx4 a[76:79], v30, s[24:27], s63 offen offset:3072
    ds_read_b128 a[184:187], v26 offset:10240
    v_rcp_f32 v198, v198
    v_mfma_f32_16x16x32_bf16 v[92:95], a[196:199], a[172:175], 0
    s_add_u32 s63, s32, 12288
    v_rcp_f32 v199, v199
    v_mul_f32 v196, v120, v196
    v_mul_f32 v197, v121, v197
    v_mfma_f32_16x16x32_bf16 v[208:211], a[200:203], a[160:163], 0
    v_mul_f32 v198, v122, v198
    v_mul_f32 v199, v123, v199
    v_cvt_pk_bf16_f32 v106, v196, v197
    v_mfma_f32_16x16x32_bf16 v[212:215], a[200:203], a[164:167], 0
    buffer_load_dwordx4 a[80:83], v30, s[24:27], s63 offen offset:0
    ds_read_b128 a[188:191], v26 offset:11264
    v_cvt_pk_bf16_f32 v107, v198, v199
    v_mfma_f32_16x16x32_bf16 v[216:219], a[200:203], a[168:171], 0
    ds_write_b128 v27, v[104:107] offset:6144
    buffer_load_dwordx4 a[84:87], v30, s[24:27], s63 offen offset:1024
    v_mfma_f32_16x16x32_bf16 v[220:223], a[200:203], a[172:175], 0
    v_exp_f32 v192, v108
    v_exp_f32 v193, v109
    v_mfma_f32_16x16x32_bf16 v[224:227], a[204:207], a[160:163], 0
    buffer_load_dwordx4 a[88:91], v30, s[24:27], s63 offen offset:2048
    v_exp_f32 v194, v110
    v_exp_f32 v195, v111
    v_mfma_f32_16x16x32_bf16 v[228:231], a[204:207], a[164:167], 0
    buffer_load_dwordx4 a[92:95], v30, s[24:27], s63 offen offset:3072
    v_add_f32 v192, 1.0, v192
    v_add_f32 v193, 1.0, v193
    v_mfma_f32_16x16x32_bf16 v[232:235], a[204:207], a[168:171], 0
    v_add_f32 v194, 1.0, v194
    v_add_f32 v195, 1.0, v195
    v_rcp_f32 v192, v192
    v_mfma_f32_16x16x32_bf16 v[236:239], a[204:207], a[172:175], 0
    s_waitcnt vmcnt(16) lgkmcnt(4)
    v_rcp_f32 v193, v193
    v_rcp_f32 v194, v194
    v_mfma_f32_16x16x32_bf16 v[64:67], a[208:211], a[176:179], v[64:67]
    s_add_u32 s63, s32, 20480
    ds_read_b128 a[160:163], v26 offset:16384
    v_rcp_f32 v195, v195
    s_waitcnt lgkmcnt(4)
    v_mfma_f32_16x16x32_bf16 v[68:71], a[208:211], a[180:183], v[68:71]
    s_waitcnt lgkmcnt(3)
    v_mul_f32 v192, v108, v192
    v_mul_f32 v193, v109, v193
    v_mul_f32 v194, v110, v194
    v_mfma_f32_16x16x32_bf16 v[72:75], a[208:211], a[184:187], v[72:75]
    s_waitcnt lgkmcnt(2)
    v_mul_f32 v195, v111, v195
    v_cvt_pk_bf16_f32 v108, v192, v193
    v_cvt_pk_bf16_f32 v109, v194, v195
    v_mfma_f32_16x16x32_bf16 v[76:79], a[208:211], a[188:191], v[76:79]
    buffer_load_dwordx4 a[96:99], v30, s[24:27], s63 offen offset:0
    ds_read_b128 a[164:167], v26 offset:17408
    v_exp_f32 v196, v124
    v_mfma_f32_16x16x32_bf16 v[80:83], a[212:215], a[176:179], v[80:83]
    v_exp_f32 v197, v125
    v_exp_f32 v198, v126
    v_mfma_f32_16x16x32_bf16 v[84:87], a[212:215], a[180:183], v[84:87]
    v_exp_f32 v199, v127
    v_add_f32 v196, 1.0, v196
    v_add_f32 v197, 1.0, v197
    v_mfma_f32_16x16x32_bf16 v[88:91], a[212:215], a[184:187], v[88:91]
    buffer_load_dwordx4 a[100:103], v30, s[24:27], s63 offen offset:1024
    ds_read_b128 a[168:171], v26 offset:18432
    v_add_f32 v198, 1.0, v198
    v_mfma_f32_16x16x32_bf16 v[92:95], a[212:215], a[188:191], v[92:95]
    v_add_f32 v199, 1.0, v199
    v_rcp_f32 v196, v196
    v_rcp_f32 v197, v197
    v_mfma_f32_16x16x32_bf16 v[208:211], a[216:219], a[176:179], v[208:211]
    v_rcp_f32 v198, v198
    v_mfma_f32_16x16x32_bf16 v[212:215], a[216:219], a[180:183], v[212:215]
    buffer_load_dwordx4 a[104:107], v30, s[24:27], s63 offen offset:2048
    ds_read_b128 a[172:175], v26 offset:19456
    v_rcp_f32 v199, v199
    v_mfma_f32_16x16x32_bf16 v[216:219], a[216:219], a[184:187], v[216:219]
    v_mul_f32 v196, v124, v196
    v_mul_f32 v197, v125, v197
    v_mul_f32 v198, v126, v198
    v_mul_f32 v199, v127, v199
    v_mfma_f32_16x16x32_bf16 v[220:223], a[216:219], a[188:191], v[220:223]
    v_cvt_pk_bf16_f32 v110, v196, v197
    v_cvt_pk_bf16_f32 v111, v198, v199
    v_mfma_f32_16x16x32_bf16 v[224:227], a[220:223], a[176:179], v[224:227]
    ds_write_b128 v27, v[108:111] offset:7168
    buffer_load_dwordx4 a[108:111], v30, s[24:27], s63 offen offset:3072
    v_mfma_f32_16x16x32_bf16 v[228:231], a[220:223], a[180:183], v[228:231]
    v_exp_f32 v192, v128
    v_exp_f32 v193, v129
    v_mfma_f32_16x16x32_bf16 v[232:235], a[220:223], a[184:187], v[232:235]
    v_exp_f32 v194, v130
    v_exp_f32 v195, v131
    v_mfma_f32_16x16x32_bf16 v[236:239], a[220:223], a[188:191], v[236:239]
    s_waitcnt vmcnt(16) lgkmcnt(4)
    v_add_f32 v192, 1.0, v192
    v_add_f32 v193, 1.0, v193
    v_add_f32 v194, 1.0, v194
    v_mfma_f32_16x16x32_bf16 v[64:67], a[224:227], a[160:163], v[64:67]
    s_add_u32 s63, s32, 28672
    ds_read_b128 a[176:179], v26 offset:24576
    v_add_f32 v195, 1.0, v195
    s_waitcnt lgkmcnt(4)
    v_mfma_f32_16x16x32_bf16 v[68:71], a[224:227], a[164:167], v[68:71]
    s_waitcnt lgkmcnt(3)
    v_rcp_f32 v192, v192
    v_rcp_f32 v193, v193
    v_mfma_f32_16x16x32_bf16 v[72:75], a[224:227], a[168:171], v[72:75]
    s_waitcnt lgkmcnt(2)
    v_rcp_f32 v194, v194
    v_rcp_f32 v195, v195
    v_mfma_f32_16x16x32_bf16 v[76:79], a[224:227], a[172:175], v[76:79]
    buffer_load_dwordx4 a[112:115], v30, s[24:27], s63 offen offset:0
    ds_read_b128 a[180:183], v26 offset:25600
    v_mul_f32 v192, v128, v192
    v_mul_f32 v193, v129, v193
    v_mfma_f32_16x16x32_bf16 v[80:83], a[228:231], a[160:163], v[80:83]
    v_mul_f32 v194, v130, v194
    v_mul_f32 v195, v131, v195
    v_cvt_pk_bf16_f32 v128, v192, v193
    v_mfma_f32_16x16x32_bf16 v[84:87], a[228:231], a[164:167], v[84:87]
    v_cvt_pk_bf16_f32 v129, v194, v195
    v_exp_f32 v196, v144
    v_mfma_f32_16x16x32_bf16 v[88:91], a[228:231], a[168:171], v[88:91]
    buffer_load_dwordx4 a[116:119], v30, s[24:27], s63 offen offset:1024
    ds_read_b128 a[184:187], v26 offset:26624
    v_exp_f32 v197, v145
    v_mfma_f32_16x16x32_bf16 v[92:95], a[228:231], a[172:175], v[92:95]
    v_exp_f32 v198, v146
    v_exp_f32 v199, v147
    v_mfma_f32_16x16x32_bf16 v[208:211], a[232:235], a[160:163], v[208:211]
    v_add_f32 v196, 1.0, v196
    v_add_f32 v197, 1.0, v197
    v_add_f32 v198, 1.0, v198
    v_add_f32 v199, 1.0, v199
    v_mfma_f32_16x16x32_bf16 v[212:215], a[232:235], a[164:167], v[212:215]
    buffer_load_dwordx4 a[120:123], v30, s[24:27], s63 offen offset:2048
    ds_read_b128 a[188:191], v26 offset:27648
    v_rcp_f32 v196, v196
    v_mfma_f32_16x16x32_bf16 v[216:219], a[232:235], a[168:171], v[216:219]
    v_rcp_f32 v197, v197
    v_mfma_f32_16x16x32_bf16 v[220:223], a[232:235], a[172:175], v[220:223]
    v_rcp_f32 v198, v198
    v_rcp_f32 v199, v199
    v_mul_f32 v196, v144, v196
    v_mfma_f32_16x16x32_bf16 v[224:227], a[236:239], a[160:163], v[224:227]
    buffer_load_dwordx4 a[124:127], v30, s[24:27], s63 offen offset:3072
    v_mul_f32 v197, v145, v197
    v_mul_f32 v198, v146, v198
    v_mfma_f32_16x16x32_bf16 v[228:231], a[236:239], a[164:167], v[228:231]
    v_mul_f32 v199, v147, v199
    v_cvt_pk_bf16_f32 v130, v196, v197
    v_cvt_pk_bf16_f32 v131, v198, v199
    v_mfma_f32_16x16x32_bf16 v[232:235], a[236:239], a[168:171], v[232:235]
    ds_write_b128 v27, v[128:131] offset:32768
    v_mfma_f32_16x16x32_bf16 v[236:239], a[236:239], a[172:175], v[236:239]
    s_waitcnt lgkmcnt(5)
    v_exp_f32 v192, v132
    v_exp_f32 v193, v133
    s_barrier
    s_waitcnt vmcnt(16) lgkmcnt(4)
    v_mfma_f32_16x16x32_bf16 v[64:67], a[240:243], a[176:179], v[64:67]
    s_add_u32 s63, s32, 131072
    ds_read_b128 a[160:163], v26 offset:4096
    v_exp_f32 v194, v134
    s_waitcnt lgkmcnt(4)
    v_mfma_f32_16x16x32_bf16 v[68:71], a[240:243], a[180:183], v[68:71]
    s_waitcnt lgkmcnt(3)
    v_exp_f32 v195, v135
    v_add_f32 v192, 1.0, v192
    v_mfma_f32_16x16x32_bf16 v[72:75], a[240:243], a[184:187], v[72:75]
    s_waitcnt lgkmcnt(2)
    v_add_f32 v193, 1.0, v193
    v_add_f32 v194, 1.0, v194
    v_add_f32 v195, 1.0, v195
    v_mfma_f32_16x16x32_bf16 v[76:79], a[240:243], a[188:191], v[76:79]
    buffer_load_dwordx4 a[128:131], v30, s[24:27], s63 offen offset:0
    ds_read_b128 a[164:167], v26 offset:5120
    v_rcp_f32 v192, v192
    v_mfma_f32_16x16x32_bf16 v[80:83], a[244:247], a[176:179], v[80:83]
    v_rcp_f32 v193, v193
    v_rcp_f32 v194, v194
    v_mfma_f32_16x16x32_bf16 v[84:87], a[244:247], a[180:183], v[84:87]
    v_rcp_f32 v195, v195
    v_mul_f32 v192, v132, v192
    v_mfma_f32_16x16x32_bf16 v[88:91], a[244:247], a[184:187], v[88:91]
    buffer_load_dwordx4 a[132:135], v30, s[24:27], s63 offen offset:1024
    ds_read_b128 a[168:171], v26 offset:6144
    v_mul_f32 v193, v133, v193
    v_mul_f32 v194, v134, v194
    v_mfma_f32_16x16x32_bf16 v[92:95], a[244:247], a[188:191], v[92:95]
    v_mul_f32 v195, v135, v195
    v_cvt_pk_bf16_f32 v132, v192, v193
    v_cvt_pk_bf16_f32 v133, v194, v195
    v_mfma_f32_16x16x32_bf16 v[208:211], a[248:251], a[176:179], v[208:211]
    v_exp_f32 v196, v148
    v_exp_f32 v197, v149
    v_mfma_f32_16x16x32_bf16 v[212:215], a[248:251], a[180:183], v[212:215]
    buffer_load_dwordx4 a[136:139], v30, s[24:27], s63 offen offset:2048
    ds_read_b128 a[172:175], v26 offset:7168
    v_exp_f32 v198, v150
    v_mfma_f32_16x16x32_bf16 v[216:219], a[248:251], a[184:187], v[216:219]
    v_exp_f32 v199, v151
    v_add_f32 v196, 1.0, v196
    v_mfma_f32_16x16x32_bf16 v[220:223], a[248:251], a[188:191], v[220:223]
    v_add_f32 v197, 1.0, v197
    v_add_f32 v198, 1.0, v198
    v_add_f32 v199, 1.0, v199
    v_mfma_f32_16x16x32_bf16 v[224:227], a[252:255], a[176:179], v[224:227]
    buffer_load_dwordx4 a[140:143], v30, s[24:27], s63 offen offset:3072
    v_rcp_f32 v196, v196
    v_rcp_f32 v197, v197
    v_mfma_f32_16x16x32_bf16 v[228:231], a[252:255], a[180:183], v[228:231]
    v_rcp_f32 v198, v198
    v_mfma_f32_16x16x32_bf16 v[232:235], a[252:255], a[184:187], v[232:235]
    v_rcp_f32 v199, v199
    v_mul_f32 v196, v148, v196
    v_mul_f32 v197, v149, v197
    v_mfma_f32_16x16x32_bf16 v[236:239], a[252:255], a[188:191], v[236:239]
    s_cmp_eq_u32 s83, 0
    v_mul_f32 v198, v150, v198
    v_mul_f32 v199, v151, v199
    v_cvt_pk_bf16_f32 v134, v196, v197
    v_cvt_pk_bf16_f32 v135, v198, v199
    v_mov_b32 v244, 1
    s_cbranch_scc1 standalone__conformer_family_zipformer__speech_kernel_sndv243_2s
    buffer_store_dword v244, v243, s[24:27], s81 offen
    s_branch standalone__conformer_family_zipformer__speech_kernel_sndv243_2e
standalone__conformer_family_zipformer__speech_kernel_sndv243_2s:
    buffer_store_dword v244, v243, s[24:27], s81 offen sc1
standalone__conformer_family_zipformer__speech_kernel_sndv243_2e:
    s_waitcnt vmcnt(17) lgkmcnt(3)
    v_mfma_f32_16x16x32_bf16 v[64:67], a[64:67], a[160:163], v[64:67]
    ds_write_b128 v27, v[132:135] offset:33792
    s_add_u32 s63, s32, 139264
    ds_read_b128 a[176:179], v26 offset:12288
    s_waitcnt lgkmcnt(4)
    v_mfma_f32_16x16x32_bf16 v[68:71], a[64:67], a[164:167], v[68:71]
    buffer_load_dwordx4 a[144:147], v30, s[24:27], s63 offen offset:0
    s_waitcnt lgkmcnt(3)
    v_mfma_f32_16x16x32_bf16 v[72:75], a[64:67], a[168:171], v[72:75]
    s_waitcnt lgkmcnt(2)
    v_exp_f32 v192, v136
    v_exp_f32 v193, v137
    v_mfma_f32_16x16x32_bf16 v[76:79], a[64:67], a[172:175], v[76:79]
    buffer_load_dwordx4 a[148:151], v30, s[24:27], s63 offen offset:1024
    ds_read_b128 a[180:183], v26 offset:13312
    v_exp_f32 v194, v138
    v_mfma_f32_16x16x32_bf16 v[80:83], a[68:71], a[160:163], v[80:83]
    buffer_load_dwordx4 a[152:155], v30, s[24:27], s63 offen offset:2048
    v_exp_f32 v195, v139
    v_add_f32 v192, 1.0, v192
    v_mfma_f32_16x16x32_bf16 v[84:87], a[68:71], a[164:167], v[84:87]
    v_add_f32 v193, 1.0, v193
    v_add_f32 v194, 1.0, v194
    v_add_f32 v195, 1.0, v195
    v_rcp_f32 v192, v192
    v_mfma_f32_16x16x32_bf16 v[88:91], a[68:71], a[168:171], v[88:91]
    buffer_load_dwordx4 a[156:159], v30, s[24:27], s63 offen offset:3072
    ds_read_b128 a[184:187], v26 offset:14336
    v_rcp_f32 v193, v193
    v_mfma_f32_16x16x32_bf16 v[92:95], a[68:71], a[172:175], v[92:95]
    s_add_u32 s63, s32, 147456
    v_rcp_f32 v194, v194
    v_mfma_f32_16x16x32_bf16 v[208:211], a[72:75], a[160:163], v[208:211]
    v_rcp_f32 v195, v195
    v_mul_f32 v192, v136, v192
    v_mul_f32 v193, v137, v193
    v_mfma_f32_16x16x32_bf16 v[212:215], a[72:75], a[164:167], v[212:215]
    buffer_load_dwordx4 a[192:195], v30, s[24:27], s63 offen offset:0
    ds_read_b128 a[188:191], v26 offset:15360
    v_mul_f32 v194, v138, v194
    v_mul_f32 v195, v139, v195
    v_mfma_f32_16x16x32_bf16 v[216:219], a[72:75], a[168:171], v[216:219]
    buffer_load_dwordx4 a[196:199], v30, s[24:27], s63 offen offset:1024
    v_cvt_pk_bf16_f32 v136, v192, v193
    v_cvt_pk_bf16_f32 v137, v194, v195
    v_mfma_f32_16x16x32_bf16 v[220:223], a[72:75], a[172:175], v[220:223]
    v_exp_f32 v196, v152
    v_exp_f32 v197, v153
    v_mfma_f32_16x16x32_bf16 v[224:227], a[76:79], a[160:163], v[224:227]
    buffer_load_dwordx4 a[200:203], v30, s[24:27], s63 offen offset:2048
    v_exp_f32 v198, v154
    v_exp_f32 v199, v155
    v_mfma_f32_16x16x32_bf16 v[228:231], a[76:79], a[164:167], v[228:231]
    buffer_load_dwordx4 a[204:207], v30, s[24:27], s63 offen offset:3072
    v_add_f32 v196, 1.0, v196
    v_add_f32 v197, 1.0, v197
    v_mfma_f32_16x16x32_bf16 v[232:235], a[76:79], a[168:171], v[232:235]
    v_add_f32 v198, 1.0, v198
    v_add_f32 v199, 1.0, v199
    v_rcp_f32 v196, v196
    v_mfma_f32_16x16x32_bf16 v[236:239], a[76:79], a[172:175], v[236:239]
    s_waitcnt vmcnt(21) lgkmcnt(3)
    v_rcp_f32 v197, v197
    v_rcp_f32 v198, v198
    v_mfma_f32_16x16x32_bf16 v[64:67], a[80:83], a[176:179], v[64:67]
    s_add_u32 s63, s32, 155648
    ds_read_b128 a[160:163], v26 offset:20480
    v_rcp_f32 v199, v199
    s_waitcnt lgkmcnt(3)
    v_mfma_f32_16x16x32_bf16 v[68:71], a[80:83], a[180:183], v[68:71]
    s_waitcnt lgkmcnt(2)
    v_mul_f32 v196, v152, v196
    v_mul_f32 v197, v153, v197
    v_mul_f32 v198, v154, v198
    v_mfma_f32_16x16x32_bf16 v[72:75], a[80:83], a[184:187], v[72:75]
    s_waitcnt lgkmcnt(1)
    v_mul_f32 v199, v155, v199
    v_cvt_pk_bf16_f32 v138, v196, v197
    v_cvt_pk_bf16_f32 v139, v198, v199
    v_mfma_f32_16x16x32_bf16 v[76:79], a[80:83], a[188:191], v[76:79]
    ds_write_b128 v27, v[136:139] offset:34816
    buffer_load_dwordx4 a[208:211], v30, s[24:27], s63 offen offset:0
    ds_read_b128 a[164:167], v26 offset:21504
    v_mfma_f32_16x16x32_bf16 v[80:83], a[84:87], a[176:179], v[80:83]
    v_exp_f32 v192, v140
    v_mfma_f32_16x16x32_bf16 v[84:87], a[84:87], a[180:183], v[84:87]
    v_exp_f32 v193, v141
    v_exp_f32 v194, v142
    v_mfma_f32_16x16x32_bf16 v[88:91], a[84:87], a[184:187], v[88:91]
    buffer_load_dwordx4 a[212:215], v30, s[24:27], s63 offen offset:1024
    ds_read_b128 a[168:171], v26 offset:22528
    v_exp_f32 v195, v143
    v_mfma_f32_16x16x32_bf16 v[92:95], a[84:87], a[188:191], v[92:95]
    v_add_f32 v192, 1.0, v192
    v_add_f32 v193, 1.0, v193
    v_add_f32 v194, 1.0, v194
    v_mfma_f32_16x16x32_bf16 v[208:211], a[88:91], a[176:179], v[208:211]
    v_add_f32 v195, 1.0, v195
    v_rcp_f32 v192, v192
    v_mfma_f32_16x16x32_bf16 v[212:215], a[88:91], a[180:183], v[212:215]
    buffer_load_dwordx4 a[216:219], v30, s[24:27], s63 offen offset:2048
    ds_read_b128 a[172:175], v26 offset:23552
    v_rcp_f32 v193, v193
    v_mfma_f32_16x16x32_bf16 v[216:219], a[88:91], a[184:187], v[216:219]
    v_rcp_f32 v194, v194
    v_rcp_f32 v195, v195
    v_mfma_f32_16x16x32_bf16 v[220:223], a[88:91], a[188:191], v[220:223]
    v_mul_f32 v192, v140, v192
    v_mul_f32 v193, v141, v193
    v_mul_f32 v194, v142, v194
    v_mul_f32 v195, v143, v195
    v_mfma_f32_16x16x32_bf16 v[224:227], a[92:95], a[176:179], v[224:227]
    buffer_load_dwordx4 a[220:223], v30, s[24:27], s63 offen offset:3072
    v_cvt_pk_bf16_f32 v140, v192, v193
    v_cvt_pk_bf16_f32 v141, v194, v195
    v_mfma_f32_16x16x32_bf16 v[228:231], a[92:95], a[180:183], v[228:231]
    v_exp_f32 v196, v156
    v_exp_f32 v197, v157
    v_mfma_f32_16x16x32_bf16 v[232:235], a[92:95], a[184:187], v[232:235]
    v_exp_f32 v198, v158
    v_exp_f32 v199, v159
    v_mfma_f32_16x16x32_bf16 v[236:239], a[92:95], a[188:191], v[236:239]
    s_waitcnt vmcnt(21) lgkmcnt(4)
    v_add_f32 v196, 1.0, v196
    v_add_f32 v197, 1.0, v197
    v_add_f32 v198, 1.0, v198
    v_mfma_f32_16x16x32_bf16 v[64:67], a[96:99], a[160:163], v[64:67]
    s_add_u32 s63, s32, 135168
    ds_read_b128 a[176:179], v26 offset:28672
    v_add_f32 v199, 1.0, v199
    s_waitcnt lgkmcnt(3)
    v_mfma_f32_16x16x32_bf16 v[68:71], a[96:99], a[164:167], v[68:71]
    s_waitcnt lgkmcnt(2)
    v_rcp_f32 v196, v196
    v_rcp_f32 v197, v197
    v_mfma_f32_16x16x32_bf16 v[72:75], a[96:99], a[168:171], v[72:75]
    s_waitcnt lgkmcnt(1)
    v_rcp_f32 v198, v198
    v_rcp_f32 v199, v199
    v_mfma_f32_16x16x32_bf16 v[76:79], a[96:99], a[172:175], v[76:79]
    buffer_load_dwordx4 a[224:227], v30, s[24:27], s63 offen offset:0
    ds_read_b128 a[180:183], v26 offset:29696
    v_mul_f32 v196, v156, v196
    v_mul_f32 v197, v157, v197
    v_mfma_f32_16x16x32_bf16 v[80:83], a[100:103], a[160:163], v[80:83]
    v_mul_f32 v198, v158, v198
    v_mul_f32 v199, v159, v199
    v_cvt_pk_bf16_f32 v142, v196, v197
    v_mfma_f32_16x16x32_bf16 v[84:87], a[100:103], a[164:167], v[84:87]
    v_cvt_pk_bf16_f32 v143, v198, v199
    v_mfma_f32_16x16x32_bf16 v[88:91], a[100:103], a[168:171], v[88:91]
    ds_write_b128 v27, v[140:143] offset:35840
    buffer_load_dwordx4 a[228:231], v30, s[24:27], s63 offen offset:1024
    ds_read_b128 a[184:187], v26 offset:30720
    v_mfma_f32_16x16x32_bf16 v[92:95], a[100:103], a[172:175], v[92:95]
    v_exp_f32 v192, v160
    v_exp_f32 v193, v161
    v_mfma_f32_16x16x32_bf16 v[208:211], a[104:107], a[160:163], v[208:211]
    v_exp_f32 v194, v162
    v_exp_f32 v195, v163
    v_mfma_f32_16x16x32_bf16 v[212:215], a[104:107], a[164:167], v[212:215]
    buffer_load_dwordx4 a[232:235], v30, s[24:27], s63 offen offset:2048
    ds_read_b128 a[188:191], v26 offset:31744
    v_add_f32 v192, 1.0, v192
    v_mfma_f32_16x16x32_bf16 v[216:219], a[104:107], a[168:171], v[216:219]
    v_add_f32 v193, 1.0, v193
    v_add_f32 v194, 1.0, v194
    v_add_f32 v195, 1.0, v195
    v_mfma_f32_16x16x32_bf16 v[220:223], a[104:107], a[172:175], v[220:223]
    v_rcp_f32 v192, v192
    v_rcp_f32 v193, v193
    v_mfma_f32_16x16x32_bf16 v[224:227], a[108:111], a[160:163], v[224:227]
    buffer_load_dwordx4 a[236:239], v30, s[24:27], s63 offen offset:3072
    v_rcp_f32 v194, v194
    v_rcp_f32 v195, v195
    v_mfma_f32_16x16x32_bf16 v[228:231], a[108:111], a[164:167], v[228:231]
    v_mul_f32 v192, v160, v192
    v_mul_f32 v193, v161, v193
    v_mul_f32 v194, v162, v194
    v_mfma_f32_16x16x32_bf16 v[232:235], a[108:111], a[168:171], v[232:235]
    v_mul_f32 v195, v163, v195
    v_cvt_pk_bf16_f32 v160, v192, v193
    v_cvt_pk_bf16_f32 v161, v194, v195
    v_mfma_f32_16x16x32_bf16 v[236:239], a[108:111], a[172:175], v[236:239]
    s_waitcnt lgkmcnt(2)
    v_exp_f32 v196, v176
    v_exp_f32 v197, v177
    s_barrier
    s_waitcnt vmcnt(21)
    v_mfma_f32_16x16x32_bf16 v[64:67], a[112:115], a[176:179], v[64:67]
    s_add_u32 s63, s32, 143360
    ds_read_b128 a[160:163], v26 offset:32768
    v_exp_f32 v198, v178
    v_mfma_f32_16x16x32_bf16 v[68:71], a[112:115], a[180:183], v[68:71]
    s_waitcnt lgkmcnt(2)
    v_exp_f32 v199, v179
    v_add_f32 v196, 1.0, v196
    v_mfma_f32_16x16x32_bf16 v[72:75], a[112:115], a[184:187], v[72:75]
    s_waitcnt lgkmcnt(1)
    v_add_f32 v197, 1.0, v197
    v_add_f32 v198, 1.0, v198
    v_add_f32 v199, 1.0, v199
    v_mfma_f32_16x16x32_bf16 v[76:79], a[112:115], a[188:191], v[76:79]
    buffer_load_dwordx4 a[240:243], v30, s[24:27], s63 offen offset:0
    ds_read_b128 a[164:167], v26 offset:33792
    v_rcp_f32 v196, v196
    v_mfma_f32_16x16x32_bf16 v[80:83], a[116:119], a[176:179], v[80:83]
    v_rcp_f32 v197, v197
    v_rcp_f32 v198, v198
    v_mfma_f32_16x16x32_bf16 v[84:87], a[116:119], a[180:183], v[84:87]
    v_rcp_f32 v199, v199
    v_mul_f32 v196, v176, v196
    v_mfma_f32_16x16x32_bf16 v[88:91], a[116:119], a[184:187], v[88:91]
    buffer_load_dwordx4 a[244:247], v30, s[24:27], s63 offen offset:1024
    ds_read_b128 a[168:171], v26 offset:34816
    v_mul_f32 v197, v177, v197
    v_mul_f32 v198, v178, v198
    v_mfma_f32_16x16x32_bf16 v[92:95], a[116:119], a[188:191], v[92:95]
    v_mul_f32 v199, v179, v199
    v_cvt_pk_bf16_f32 v162, v196, v197
    v_cvt_pk_bf16_f32 v163, v198, v199
    v_mfma_f32_16x16x32_bf16 v[208:211], a[120:123], a[176:179], v[208:211]
    ds_write_b128 v27, v[160:163] offset:36864
    v_mfma_f32_16x16x32_bf16 v[212:215], a[120:123], a[180:183], v[212:215]
    buffer_load_dwordx4 a[248:251], v30, s[24:27], s63 offen offset:2048
    ds_read_b128 a[172:175], v26 offset:35840
    v_exp_f32 v192, v164
    v_mfma_f32_16x16x32_bf16 v[216:219], a[120:123], a[184:187], v[216:219]
    v_exp_f32 v193, v165
    v_exp_f32 v194, v166
    v_mfma_f32_16x16x32_bf16 v[220:223], a[120:123], a[188:191], v[220:223]
    v_exp_f32 v195, v167
    v_add_f32 v192, 1.0, v192
    v_mfma_f32_16x16x32_bf16 v[224:227], a[124:127], a[176:179], v[224:227]
    buffer_load_dwordx4 a[252:255], v30, s[24:27], s63 offen offset:3072
    v_add_f32 v193, 1.0, v193
    v_add_f32 v194, 1.0, v194
    v_mfma_f32_16x16x32_bf16 v[228:231], a[124:127], a[180:183], v[228:231]
    v_add_f32 v195, 1.0, v195
    v_rcp_f32 v192, v192
    v_mfma_f32_16x16x32_bf16 v[232:235], a[124:127], a[184:187], v[232:235]
    v_rcp_f32 v193, v193
    v_rcp_f32 v194, v194
    v_mfma_f32_16x16x32_bf16 v[236:239], a[124:127], a[188:191], v[236:239]
    s_waitcnt vmcnt(21) lgkmcnt(4)
    v_rcp_f32 v195, v195
    v_mul_f32 v192, v164, v192
    v_mul_f32 v193, v165, v193
    v_mfma_f32_16x16x32_bf16 v[64:67], a[128:131], a[160:163], v[64:67]
    s_add_u32 s63, s32, 151552
    ds_read_b128 a[176:179], v26 offset:40960
    v_mul_f32 v194, v166, v194
    v_mul_f32 v195, v167, v195
    s_waitcnt lgkmcnt(4)
    v_mfma_f32_16x16x32_bf16 v[68:71], a[128:131], a[164:167], v[68:71]
    buffer_load_dwordx4 a[64:67], v30, s[24:27], s63 offen offset:0
    v_cvt_pk_bf16_f32 v164, v192, v193
    v_cvt_pk_bf16_f32 v165, v194, v195
    s_waitcnt lgkmcnt(3)
    v_mfma_f32_16x16x32_bf16 v[72:75], a[128:131], a[168:171], v[72:75]
    s_waitcnt lgkmcnt(1)
    v_exp_f32 v196, v180
    v_exp_f32 v197, v181
    v_mfma_f32_16x16x32_bf16 v[76:79], a[128:131], a[172:175], v[76:79]
    buffer_load_dwordx4 a[68:71], v30, s[24:27], s63 offen offset:1024
    ds_read_b128 a[180:183], v26 offset:41984
    v_exp_f32 v198, v182
    v_mfma_f32_16x16x32_bf16 v[80:83], a[132:135], a[160:163], v[80:83]
    buffer_load_dwordx4 a[72:75], v30, s[24:27], s63 offen offset:2048
    v_exp_f32 v199, v183
    v_add_f32 v196, 1.0, v196
    v_mfma_f32_16x16x32_bf16 v[84:87], a[132:135], a[164:167], v[84:87]
    v_add_f32 v197, 1.0, v197
    v_add_f32 v198, 1.0, v198
    v_add_f32 v199, 1.0, v199
    v_rcp_f32 v196, v196
    v_mfma_f32_16x16x32_bf16 v[88:91], a[132:135], a[168:171], v[88:91]
    buffer_load_dwordx4 a[76:79], v30, s[24:27], s63 offen offset:3072
    ds_read_b128 a[184:187], v26 offset:43008
    v_rcp_f32 v197, v197
    v_mfma_f32_16x16x32_bf16 v[92:95], a[132:135], a[172:175], v[92:95]
    s_add_u32 s63, s32, 159744
    v_rcp_f32 v198, v198
    v_mfma_f32_16x16x32_bf16 v[208:211], a[136:139], a[160:163], v[208:211]
    v_rcp_f32 v199, v199
    v_mul_f32 v196, v180, v196
    v_mul_f32 v197, v181, v197
    v_mfma_f32_16x16x32_bf16 v[212:215], a[136:139], a[164:167], v[212:215]
    buffer_load_dwordx4 a[80:83], v30, s[24:27], s63 offen offset:0
    ds_read_b128 a[188:191], v26 offset:44032
    v_mul_f32 v198, v182, v198
    v_mul_f32 v199, v183, v199
    v_mfma_f32_16x16x32_bf16 v[216:219], a[136:139], a[168:171], v[216:219]
    buffer_load_dwordx4 a[84:87], v30, s[24:27], s63 offen offset:1024
    v_cvt_pk_bf16_f32 v166, v196, v197
    v_cvt_pk_bf16_f32 v167, v198, v199
    v_mfma_f32_16x16x32_bf16 v[220:223], a[136:139], a[172:175], v[220:223]
    ds_write_b128 v27, v[164:167] offset:37888
    v_mfma_f32_16x16x32_bf16 v[224:227], a[140:143], a[160:163], v[224:227]
    buffer_load_dwordx4 a[88:91], v30, s[24:27], s63 offen offset:2048
    v_exp_f32 v192, v168
    v_exp_f32 v193, v169
    v_mfma_f32_16x16x32_bf16 v[228:231], a[140:143], a[164:167], v[228:231]
    buffer_load_dwordx4 a[92:95], v30, s[24:27], s63 offen offset:3072
    v_exp_f32 v194, v170
    v_mfma_f32_16x16x32_bf16 v[232:235], a[140:143], a[168:171], v[232:235]
    v_exp_f32 v195, v171
    v_add_f32 v192, 1.0, v192
    v_add_f32 v193, 1.0, v193
    v_mfma_f32_16x16x32_bf16 v[236:239], a[140:143], a[172:175], v[236:239]
    s_waitcnt vmcnt(24) lgkmcnt(4)
    v_add_f32 v194, 1.0, v194
    v_add_f32 v195, 1.0, v195
    v_rcp_f32 v192, v192
    v_mfma_f32_16x16x32_bf16 v[64:67], a[144:147], a[176:179], v[64:67]
    s_add_u32 s63, s33, 524288
    ds_read_b128 a[160:163], v26 offset:49152
    v_rcp_f32 v193, v193
    s_waitcnt lgkmcnt(4)
    v_mfma_f32_16x16x32_bf16 v[68:71], a[144:147], a[180:183], v[68:71]
    s_waitcnt lgkmcnt(3)
    v_rcp_f32 v194, v194
    v_rcp_f32 v195, v195
    v_mfma_f32_16x16x32_bf16 v[72:75], a[144:147], a[184:187], v[72:75]
    s_waitcnt lgkmcnt(2)
    v_mul_f32 v192, v168, v192
    v_mul_f32 v193, v169, v193
    v_mul_f32 v194, v170, v194
    v_mfma_f32_16x16x32_bf16 v[76:79], a[144:147], a[188:191], v[76:79]
    buffer_load_dwordx4 a[96:99], v30, s[24:27], s63 offen offset:0
    ds_read_b128 a[164:167], v26 offset:50176
    v_mul_f32 v195, v171, v195
    v_cvt_pk_bf16_f32 v168, v192, v193
    v_mfma_f32_16x16x32_bf16 v[80:83], a[148:151], a[176:179], v[80:83]
    v_cvt_pk_bf16_f32 v169, v194, v195
    v_exp_f32 v196, v184
    v_mfma_f32_16x16x32_bf16 v[84:87], a[148:151], a[180:183], v[84:87]
    v_exp_f32 v197, v185
    v_exp_f32 v198, v186
    v_mfma_f32_16x16x32_bf16 v[88:91], a[148:151], a[184:187], v[88:91]
    buffer_load_dwordx4 a[100:103], v30, s[24:27], s63 offen offset:1024
    ds_read_b128 a[168:171], v26 offset:51200
    v_exp_f32 v199, v187
    v_mfma_f32_16x16x32_bf16 v[92:95], a[148:151], a[188:191], v[92:95]
    v_add_f32 v196, 1.0, v196
    v_add_f32 v197, 1.0, v197
    v_add_f32 v198, 1.0, v198
    v_add_f32 v199, 1.0, v199
    v_mfma_f32_16x16x32_bf16 v[208:211], a[152:155], a[176:179], v[208:211]
    v_rcp_f32 v196, v196
    v_rcp_f32 v197, v197
    v_mfma_f32_16x16x32_bf16 v[212:215], a[152:155], a[180:183], v[212:215]
    buffer_load_dwordx4 a[104:107], v30, s[24:27], s63 offen offset:2048
    ds_read_b128 a[172:175], v26 offset:52224
    v_mfma_f32_16x16x32_bf16 v[216:219], a[152:155], a[184:187], v[216:219]
    v_rcp_f32 v198, v198
    v_rcp_f32 v199, v199
    v_mul_f32 v196, v184, v196
    v_mfma_f32_16x16x32_bf16 v[220:223], a[152:155], a[188:191], v[220:223]
    v_mul_f32 v197, v185, v197
    v_mul_f32 v198, v186, v198
    v_mul_f32 v199, v187, v199
    v_mfma_f32_16x16x32_bf16 v[224:227], a[156:159], a[176:179], v[224:227]
    buffer_load_dwordx4 a[108:111], v30, s[24:27], s63 offen offset:3072
    v_cvt_pk_bf16_f32 v170, v196, v197
    v_cvt_pk_bf16_f32 v171, v198, v199
    v_mfma_f32_16x16x32_bf16 v[228:231], a[156:159], a[180:183], v[228:231]
    ds_write_b128 v27, v[168:171] offset:38912
    v_mfma_f32_16x16x32_bf16 v[232:235], a[156:159], a[184:187], v[232:235]
    v_exp_f32 v192, v172
    v_exp_f32 v193, v173
    v_mfma_f32_16x16x32_bf16 v[236:239], a[156:159], a[188:191], v[236:239]
    s_waitcnt vmcnt(24) lgkmcnt(4)
    v_exp_f32 v194, v174
    v_exp_f32 v195, v175
    v_mfma_f32_16x16x32_bf16 v[64:67], a[192:195], a[160:163], v[64:67]
    s_add_u32 s63, s33, 528384
    ds_read_b128 a[176:179], v26 offset:57344
    buffer_load_dword v244, v243, s[24:27], s80 offen sc1
    v_add_f32 v192, 1.0, v192
    s_waitcnt lgkmcnt(4)
    v_mfma_f32_16x16x32_bf16 v[68:71], a[192:195], a[164:167], v[68:71]
    s_waitcnt lgkmcnt(3)
    v_add_f32 v193, 1.0, v193
    v_add_f32 v194, 1.0, v194
    v_add_f32 v195, 1.0, v195
    v_mfma_f32_16x16x32_bf16 v[72:75], a[192:195], a[168:171], v[72:75]
    s_waitcnt lgkmcnt(2)
    v_rcp_f32 v192, v192
    v_rcp_f32 v193, v193
    v_mfma_f32_16x16x32_bf16 v[76:79], a[192:195], a[172:175], v[76:79]
    buffer_load_dwordx4 a[112:115], v30, s[24:27], s63 offen offset:0
    ds_read_b128 a[180:183], v26 offset:58368
    v_rcp_f32 v194, v194
    v_mfma_f32_16x16x32_bf16 v[80:83], a[196:199], a[160:163], v[80:83]
    v_rcp_f32 v195, v195
    v_mul_f32 v192, v172, v192
    v_mfma_f32_16x16x32_bf16 v[84:87], a[196:199], a[164:167], v[84:87]
    v_mul_f32 v193, v173, v193
    v_mul_f32 v194, v174, v194
    v_mul_f32 v195, v175, v195
    v_cvt_pk_bf16_f32 v172, v192, v193
    v_mfma_f32_16x16x32_bf16 v[88:91], a[196:199], a[168:171], v[88:91]
    buffer_load_dwordx4 a[116:119], v30, s[24:27], s63 offen offset:1024
    ds_read_b128 a[184:187], v26 offset:59392
    v_cvt_pk_bf16_f32 v173, v194, v195
    v_mfma_f32_16x16x32_bf16 v[92:95], a[196:199], a[172:175], v[92:95]
    v_exp_f32 v196, v188
    v_exp_f32 v197, v189
    v_mfma_f32_16x16x32_bf16 v[208:211], a[200:203], a[160:163], v[208:211]
    v_exp_f32 v198, v190
    v_exp_f32 v199, v191
    v_mfma_f32_16x16x32_bf16 v[212:215], a[200:203], a[164:167], v[212:215]
    buffer_load_dwordx4 a[120:123], v30, s[24:27], s63 offen offset:2048
    ds_read_b128 a[188:191], v26 offset:60416
    v_add_f32 v196, 1.0, v196
    v_mfma_f32_16x16x32_bf16 v[216:219], a[200:203], a[168:171], v[216:219]
    v_add_f32 v197, 1.0, v197
    v_add_f32 v198, 1.0, v198
    v_add_f32 v199, 1.0, v199
    v_mfma_f32_16x16x32_bf16 v[220:223], a[200:203], a[172:175], v[220:223]
    v_rcp_f32 v196, v196
    v_rcp_f32 v197, v197
    v_mfma_f32_16x16x32_bf16 v[224:227], a[204:207], a[160:163], v[224:227]
    buffer_load_dwordx4 a[124:127], v30, s[24:27], s63 offen offset:3072
    v_rcp_f32 v198, v198
    v_rcp_f32 v199, v199
    v_mfma_f32_16x16x32_bf16 v[228:231], a[204:207], a[164:167], v[228:231]
    v_mul_f32 v196, v188, v196
    v_mul_f32 v197, v189, v197
    v_mul_f32 v198, v190, v198
    v_mfma_f32_16x16x32_bf16 v[232:235], a[204:207], a[168:171], v[232:235]
    v_mul_f32 v199, v191, v199
    v_cvt_pk_bf16_f32 v174, v196, v197
    v_cvt_pk_bf16_f32 v175, v198, v199
    v_mfma_f32_16x16x32_bf16 v[236:239], a[204:207], a[172:175], v[236:239]
    ds_write_b128 v27, v[172:175] offset:39936
    s_waitcnt lgkmcnt(0)
    s_barrier
    s_waitcnt vmcnt(25)
    v_mfma_f32_16x16x32_bf16 v[64:67], a[208:211], a[176:179], v[64:67]
    s_add_u32 s63, s33, 532480
    ds_read_b128 a[160:163], v26 offset:36864
    v_mfma_f32_16x16x32_bf16 v[68:71], a[208:211], a[180:183], v[68:71]
    v_mfma_f32_16x16x32_bf16 v[72:75], a[208:211], a[184:187], v[72:75]
    v_mfma_f32_16x16x32_bf16 v[76:79], a[208:211], a[188:191], v[76:79]
    buffer_load_dwordx4 a[128:131], v30, s[24:27], s63 offen offset:0
    ds_read_b128 a[164:167], v26 offset:37888
    v_mfma_f32_16x16x32_bf16 v[80:83], a[212:215], a[176:179], v[80:83]
    v_mfma_f32_16x16x32_bf16 v[84:87], a[212:215], a[180:183], v[84:87]
    v_mfma_f32_16x16x32_bf16 v[88:91], a[212:215], a[184:187], v[88:91]
    buffer_load_dwordx4 a[132:135], v30, s[24:27], s63 offen offset:1024
    ds_read_b128 a[168:171], v26 offset:38912
    v_mfma_f32_16x16x32_bf16 v[92:95], a[212:215], a[188:191], v[92:95]
    v_mfma_f32_16x16x32_bf16 v[208:211], a[216:219], a[176:179], v[208:211]
    v_mfma_f32_16x16x32_bf16 v[212:215], a[216:219], a[180:183], v[212:215]
    buffer_load_dwordx4 a[136:139], v30, s[24:27], s63 offen offset:2048
    ds_read_b128 a[172:175], v26 offset:39936
    v_mfma_f32_16x16x32_bf16 v[216:219], a[216:219], a[184:187], v[216:219]
    v_mfma_f32_16x16x32_bf16 v[220:223], a[216:219], a[188:191], v[220:223]
    v_mfma_f32_16x16x32_bf16 v[224:227], a[220:223], a[176:179], v[224:227]
    buffer_load_dwordx4 a[140:143], v30, s[24:27], s63 offen offset:3072
    v_mfma_f32_16x16x32_bf16 v[228:231], a[220:223], a[180:183], v[228:231]
    v_mfma_f32_16x16x32_bf16 v[232:235], a[220:223], a[184:187], v[232:235]
    v_mfma_f32_16x16x32_bf16 v[236:239], a[220:223], a[188:191], v[236:239]
    s_waitcnt vmcnt(25) lgkmcnt(3)
    v_mfma_f32_16x16x32_bf16 v[64:67], a[224:227], a[160:163], v[64:67]
    s_add_u32 s63, s33, 536576
    ds_read_b128 a[176:179], v26 offset:45056
    s_waitcnt lgkmcnt(3)
    v_mfma_f32_16x16x32_bf16 v[68:71], a[224:227], a[164:167], v[68:71]
    s_waitcnt lgkmcnt(2)
    v_mfma_f32_16x16x32_bf16 v[72:75], a[224:227], a[168:171], v[72:75]
    s_waitcnt lgkmcnt(1)
    v_mfma_f32_16x16x32_bf16 v[76:79], a[224:227], a[172:175], v[76:79]
    buffer_load_dwordx4 a[144:147], v30, s[24:27], s63 offen offset:0
    ds_read_b128 a[180:183], v26 offset:46080
    v_mfma_f32_16x16x32_bf16 v[80:83], a[228:231], a[160:163], v[80:83]
    v_mfma_f32_16x16x32_bf16 v[84:87], a[228:231], a[164:167], v[84:87]
    v_mfma_f32_16x16x32_bf16 v[88:91], a[228:231], a[168:171], v[88:91]
    buffer_load_dwordx4 a[148:151], v30, s[24:27], s63 offen offset:1024
    ds_read_b128 a[184:187], v26 offset:47104
    v_mfma_f32_16x16x32_bf16 v[92:95], a[228:231], a[172:175], v[92:95]
    v_mfma_f32_16x16x32_bf16 v[208:211], a[232:235], a[160:163], v[208:211]
    v_mfma_f32_16x16x32_bf16 v[212:215], a[232:235], a[164:167], v[212:215]
    buffer_load_dwordx4 a[152:155], v30, s[24:27], s63 offen offset:2048
    ds_read_b128 a[188:191], v26 offset:48128
    v_mfma_f32_16x16x32_bf16 v[216:219], a[232:235], a[168:171], v[216:219]
    v_mfma_f32_16x16x32_bf16 v[220:223], a[232:235], a[172:175], v[220:223]
    v_mfma_f32_16x16x32_bf16 v[224:227], a[236:239], a[160:163], v[224:227]
    buffer_load_dwordx4 a[156:159], v30, s[24:27], s63 offen offset:3072
    v_mfma_f32_16x16x32_bf16 v[228:231], a[236:239], a[164:167], v[228:231]
    v_mfma_f32_16x16x32_bf16 v[232:235], a[236:239], a[168:171], v[232:235]
    v_mfma_f32_16x16x32_bf16 v[236:239], a[236:239], a[172:175], v[236:239]
    s_waitcnt vmcnt(25) lgkmcnt(3)
    v_mfma_f32_16x16x32_bf16 v[64:67], a[240:243], a[176:179], v[64:67]
    s_add_u32 s63, s33, 540672
    ds_read_b128 a[160:163], v26 offset:53248
    s_waitcnt lgkmcnt(3)
    v_mfma_f32_16x16x32_bf16 v[68:71], a[240:243], a[180:183], v[68:71]
    s_waitcnt lgkmcnt(2)
    v_mfma_f32_16x16x32_bf16 v[72:75], a[240:243], a[184:187], v[72:75]
    s_waitcnt lgkmcnt(1)
    v_mfma_f32_16x16x32_bf16 v[76:79], a[240:243], a[188:191], v[76:79]
    buffer_load_dwordx4 a[192:195], v30, s[24:27], s63 offen offset:0
    ds_read_b128 a[164:167], v26 offset:54272
    v_mfma_f32_16x16x32_bf16 v[80:83], a[244:247], a[176:179], v[80:83]
    v_mfma_f32_16x16x32_bf16 v[84:87], a[244:247], a[180:183], v[84:87]
    v_mfma_f32_16x16x32_bf16 v[88:91], a[244:247], a[184:187], v[88:91]
    buffer_load_dwordx4 a[196:199], v30, s[24:27], s63 offen offset:1024
    ds_read_b128 a[168:171], v26 offset:55296
    v_mfma_f32_16x16x32_bf16 v[92:95], a[244:247], a[188:191], v[92:95]
    v_mfma_f32_16x16x32_bf16 v[208:211], a[248:251], a[176:179], v[208:211]
    v_mfma_f32_16x16x32_bf16 v[212:215], a[248:251], a[180:183], v[212:215]
    buffer_load_dwordx4 a[200:203], v30, s[24:27], s63 offen offset:2048
    ds_read_b128 a[172:175], v26 offset:56320
    v_mfma_f32_16x16x32_bf16 v[216:219], a[248:251], a[184:187], v[216:219]
    v_mfma_f32_16x16x32_bf16 v[220:223], a[248:251], a[188:191], v[220:223]
    v_mfma_f32_16x16x32_bf16 v[224:227], a[252:255], a[176:179], v[224:227]
    buffer_load_dwordx4 a[204:207], v30, s[24:27], s63 offen offset:3072
    v_mfma_f32_16x16x32_bf16 v[228:231], a[252:255], a[180:183], v[228:231]
    v_mfma_f32_16x16x32_bf16 v[232:235], a[252:255], a[184:187], v[232:235]
    v_mfma_f32_16x16x32_bf16 v[236:239], a[252:255], a[188:191], v[236:239]
    s_waitcnt vmcnt(25) lgkmcnt(3)
    v_mfma_f32_16x16x32_bf16 v[64:67], a[64:67], a[160:163], v[64:67]
    s_add_u32 s63, s33, 544768
    ds_read_b128 a[176:179], v26 offset:61440
    s_waitcnt lgkmcnt(3)
    v_mfma_f32_16x16x32_bf16 v[68:71], a[64:67], a[164:167], v[68:71]
    s_waitcnt lgkmcnt(2)
    v_mfma_f32_16x16x32_bf16 v[72:75], a[64:67], a[168:171], v[72:75]
    s_waitcnt lgkmcnt(1)
    v_mfma_f32_16x16x32_bf16 v[76:79], a[64:67], a[172:175], v[76:79]
    buffer_load_dwordx4 a[208:211], v30, s[24:27], s63 offen offset:0
    ds_read_b128 a[180:183], v26 offset:62464
    v_mfma_f32_16x16x32_bf16 v[80:83], a[68:71], a[160:163], v[80:83]
    v_mfma_f32_16x16x32_bf16 v[84:87], a[68:71], a[164:167], v[84:87]
    v_mfma_f32_16x16x32_bf16 v[88:91], a[68:71], a[168:171], v[88:91]
    buffer_load_dwordx4 a[212:215], v30, s[24:27], s63 offen offset:1024
    ds_read_b128 a[184:187], v26 offset:63488
    v_mfma_f32_16x16x32_bf16 v[92:95], a[68:71], a[172:175], v[92:95]
    v_mfma_f32_16x16x32_bf16 v[208:211], a[72:75], a[160:163], v[208:211]
    v_mfma_f32_16x16x32_bf16 v[212:215], a[72:75], a[164:167], v[212:215]
    buffer_load_dwordx4 a[216:219], v30, s[24:27], s63 offen offset:2048
    ds_read_b128 a[188:191], v26 offset:64512
    v_mfma_f32_16x16x32_bf16 v[216:219], a[72:75], a[168:171], v[216:219]
    v_mfma_f32_16x16x32_bf16 v[220:223], a[72:75], a[172:175], v[220:223]
    v_mfma_f32_16x16x32_bf16 v[224:227], a[76:79], a[160:163], v[224:227]
    buffer_load_dwordx4 a[220:223], v30, s[24:27], s63 offen offset:3072
    v_mfma_f32_16x16x32_bf16 v[228:231], a[76:79], a[164:167], v[228:231]
    v_mfma_f32_16x16x32_bf16 v[232:235], a[76:79], a[168:171], v[232:235]
    v_mfma_f32_16x16x32_bf16 v[236:239], a[76:79], a[172:175], v[236:239]
    s_waitcnt vmcnt(25) lgkmcnt(3)
    v_mfma_f32_16x16x32_bf16 v[64:67], a[80:83], a[176:179], v[64:67]
    s_add_u32 s63, s33, 548864
    s_waitcnt lgkmcnt(2)
    v_mfma_f32_16x16x32_bf16 v[68:71], a[80:83], a[180:183], v[68:71]
    s_waitcnt lgkmcnt(1)
    v_mfma_f32_16x16x32_bf16 v[72:75], a[80:83], a[184:187], v[72:75]
    s_waitcnt lgkmcnt(0)
    v_mfma_f32_16x16x32_bf16 v[76:79], a[80:83], a[188:191], v[76:79]
    buffer_load_dwordx4 a[224:227], v30, s[24:27], s63 offen offset:0
    v_mfma_f32_16x16x32_bf16 v[80:83], a[84:87], a[176:179], v[80:83]
    v_mfma_f32_16x16x32_bf16 v[84:87], a[84:87], a[180:183], v[84:87]
    v_mfma_f32_16x16x32_bf16 v[88:91], a[84:87], a[184:187], v[88:91]
    buffer_load_dwordx4 a[228:231], v30, s[24:27], s63 offen offset:1024
    v_mfma_f32_16x16x32_bf16 v[92:95], a[84:87], a[188:191], v[92:95]
    v_mfma_f32_16x16x32_bf16 v[208:211], a[88:91], a[176:179], v[208:211]
    v_mfma_f32_16x16x32_bf16 v[212:215], a[88:91], a[180:183], v[212:215]
    buffer_load_dwordx4 a[232:235], v30, s[24:27], s63 offen offset:2048
    v_mfma_f32_16x16x32_bf16 v[216:219], a[88:91], a[184:187], v[216:219]
    v_mfma_f32_16x16x32_bf16 v[220:223], a[88:91], a[188:191], v[220:223]
    v_mfma_f32_16x16x32_bf16 v[224:227], a[92:95], a[176:179], v[224:227]
    buffer_load_dwordx4 a[236:239], v30, s[24:27], s63 offen offset:3072
    v_mfma_f32_16x16x32_bf16 v[228:231], a[92:95], a[180:183], v[228:231]
    v_mfma_f32_16x16x32_bf16 v[232:235], a[92:95], a[184:187], v[232:235]
    v_mfma_f32_16x16x32_bf16 v[236:239], a[92:95], a[188:191], v[236:239]
    s_mov_b32 s85, 0x40000
    s_waitcnt vmcnt(24)
    v_readfirstlane_b32 s84, v244
    s_nop 0
    s_cmp_ge_u32 s84, 1
    s_cbranch_scc1 standalone__conformer_family_zipformer__speech_kernel_spinv243_3x
standalone__conformer_family_zipformer__speech_kernel_spinv243_3:
    buffer_load_dword v244, v243, s[24:27], s80 offen sc1
    s_waitcnt vmcnt(0)
    s_sub_u32 s85, s85, 1
    s_cbranch_scc1 standalone__conformer_family_zipformer__speech_kernel_spinv243_3x
    v_readfirstlane_b32 s84, v244
    s_nop 0
    s_cmp_ge_u32 s84, 1
    s_cbranch_scc0 standalone__conformer_family_zipformer__speech_kernel_spinv243_3
standalone__conformer_family_zipformer__speech_kernel_spinv243_3x:
    s_nop 1
    v_cvt_pk_bf16_f32 v128, v72, v73
    v_cvt_pk_bf16_f32 v129, v74, v75
    v_cvt_pk_bf16_f32 v130, v88, v89
    v_cvt_pk_bf16_f32 v131, v90, v91
    v_cvt_pk_bf16_f32 v132, v216, v217
    v_cvt_pk_bf16_f32 v133, v218, v219
    v_cvt_pk_bf16_f32 v134, v232, v233
    v_cvt_pk_bf16_f32 v135, v234, v235
    v_cvt_pk_bf16_f32 v136, v76, v77
    v_cvt_pk_bf16_f32 v137, v78, v79
    v_cvt_pk_bf16_f32 v138, v92, v93
    v_cvt_pk_bf16_f32 v139, v94, v95
    v_cvt_pk_bf16_f32 v140, v220, v221
    v_cvt_pk_bf16_f32 v141, v222, v223
    v_cvt_pk_bf16_f32 v142, v236, v237
    v_cvt_pk_bf16_f32 v143, v238, v239
    s_cmp_eq_u32 s83, 0
    s_cbranch_scc1 standalone__conformer_family_zipformer__speech_kernel_sndv243_4s
    buffer_store_dwordx4 v[128:131], v30, s[76:79], s69 offen offset:0
    buffer_store_dwordx4 v[132:135], v30, s[76:79], s69 offen offset:1024
    buffer_store_dwordx4 v[136:139], v30, s[76:79], s69 offen offset:2048
    buffer_store_dwordx4 v[140:143], v30, s[76:79], s69 offen offset:3072
    s_branch standalone__conformer_family_zipformer__speech_kernel_sndv243_4e
standalone__conformer_family_zipformer__speech_kernel_sndv243_4s:
    buffer_store_dwordx4 v[128:131], v30, s[76:79], s69 offen offset:0 sc1
    buffer_store_dwordx4 v[132:135], v30, s[76:79], s69 offen offset:1024 sc1
    buffer_store_dwordx4 v[136:139], v30, s[76:79], s69 offen offset:2048 sc1
    buffer_store_dwordx4 v[140:143], v30, s[76:79], s69 offen offset:3072 sc1
standalone__conformer_family_zipformer__speech_kernel_sndv243_4e:
    s_mov_b32 s42, 0xbeb17218
    v_pk_fma_f32 v[32:33], v[64:65], s[42:43], v[32:33] op_sel_hi:[1,0,1]
    v_pk_fma_f32 v[34:35], v[66:67], s[42:43], v[34:35] op_sel_hi:[1,0,1]
    v_pk_fma_f32 v[36:37], v[68:69], s[42:43], v[36:37] op_sel_hi:[1,0,1]
    v_pk_fma_f32 v[38:39], v[70:71], s[42:43], v[38:39] op_sel_hi:[1,0,1]
    v_pk_fma_f32 v[40:41], v[80:81], s[42:43], v[40:41] op_sel_hi:[1,0,1]
    v_pk_fma_f32 v[42:43], v[82:83], s[42:43], v[42:43] op_sel_hi:[1,0,1]
    v_pk_fma_f32 v[44:45], v[84:85], s[42:43], v[44:45] op_sel_hi:[1,0,1]
    v_pk_fma_f32 v[46:47], v[86:87], s[42:43], v[46:47] op_sel_hi:[1,0,1]
    v_pk_fma_f32 v[48:49], v[208:209], s[42:43], v[48:49] op_sel_hi:[1,0,1]
    v_pk_fma_f32 v[50:51], v[210:211], s[42:43], v[50:51] op_sel_hi:[1,0,1]
    v_pk_fma_f32 v[52:53], v[212:213], s[42:43], v[52:53] op_sel_hi:[1,0,1]
    v_pk_fma_f32 v[54:55], v[214:215], s[42:43], v[54:55] op_sel_hi:[1,0,1]
    v_pk_fma_f32 v[56:57], v[224:225], s[42:43], v[56:57] op_sel_hi:[1,0,1]
    v_pk_fma_f32 v[58:59], v[226:227], s[42:43], v[58:59] op_sel_hi:[1,0,1]
    v_pk_fma_f32 v[60:61], v[228:229], s[42:43], v[60:61] op_sel_hi:[1,0,1]
    v_pk_fma_f32 v[62:63], v[230:231], s[42:43], v[62:63] op_sel_hi:[1,0,1]
    s_mov_b32 s85, 0x40000
standalone__conformer_family_zipformer__speech_kernel_rcvv243_5:
    buffer_load_dwordx4 v[144:147], v30, s[76:79], s70 offen offset:0 sc1
    buffer_load_dwordx4 v[148:151], v30, s[76:79], s70 offen offset:1024 sc1
    buffer_load_dwordx4 v[152:155], v30, s[76:79], s70 offen offset:2048 sc1
    buffer_load_dwordx4 v[156:159], v30, s[76:79], s70 offen offset:3072 sc1
    s_waitcnt vmcnt(3)
    v_max3_u32 v192, v144, v145, v146
    s_waitcnt vmcnt(2)
    v_max3_u32 v192, v192, v147, v148
    v_max3_u32 v192, v192, v149, v150
    s_waitcnt vmcnt(1)
    v_max3_u32 v192, v192, v151, v152
    v_max3_u32 v192, v192, v153, v154
    s_waitcnt vmcnt(0)
    v_max3_u32 v192, v192, v155, v156
    v_max3_u32 v192, v192, v157, v158
    v_max_u32 v192, v192, v159
    s_sub_u32 s85, s85, 1
    s_cbranch_scc1 standalone__conformer_family_zipformer__speech_kernel_rcvv243_5x
    v_cmp_eq_u32 vcc, -1, v192
    s_nop 0
    s_cmp_lg_u64 vcc, 0
    s_cbranch_scc1 standalone__conformer_family_zipformer__speech_kernel_rcvv243_5
standalone__conformer_family_zipformer__speech_kernel_rcvv243_5x:
    v_mov_b32 v248, -1
    v_mov_b32 v249, -1
    v_mov_b32 v250, -1
    v_mov_b32 v251, -1
    s_cmp_eq_u32 s83, 0
    s_cbranch_scc1 standalone__conformer_family_zipformer__speech_kernel_sndv243_6s
    buffer_store_dwordx4 v[248:251], v30, s[76:79], s70 offen offset:0
    buffer_store_dwordx4 v[248:251], v30, s[76:79], s70 offen offset:1024
    buffer_store_dwordx4 v[248:251], v30, s[76:79], s70 offen offset:2048
    buffer_store_dwordx4 v[248:251], v30, s[76:79], s70 offen offset:3072
    s_branch standalone__conformer_family_zipformer__speech_kernel_sndv243_6e
standalone__conformer_family_zipformer__speech_kernel_sndv243_6s:
    buffer_store_dwordx4 v[248:251], v30, s[76:79], s70 offen offset:0 sc1
    buffer_store_dwordx4 v[248:251], v30, s[76:79], s70 offen offset:1024 sc1
    buffer_store_dwordx4 v[248:251], v30, s[76:79], s70 offen offset:2048 sc1
    buffer_store_dwordx4 v[248:251], v30, s[76:79], s70 offen offset:3072 sc1
standalone__conformer_family_zipformer__speech_kernel_sndv243_6e:
    s_add_u32 s62, s33, 552960
    buffer_load_dwordx4 a[240:243], v30, s[24:27], s62 offen offset:0
    buffer_load_dwordx4 a[244:247], v30, s[24:27], s62 offen offset:1024
    buffer_load_dwordx4 a[248:251], v30, s[24:27], s62 offen offset:2048
    buffer_load_dwordx4 a[252:255], v30, s[24:27], s62 offen offset:3072
    v_lshlrev_b32 v192, 16, v144
    v_and_b32 v193, s43, v144
    v_lshlrev_b32 v194, 16, v145
    v_and_b32 v195, s43, v145
    v_lshlrev_b32 v196, 16, v146
    v_and_b32 v197, s43, v146
    v_lshlrev_b32 v198, 16, v147
    v_and_b32 v199, s43, v147
    v_pk_fma_f32 v[32:33], v[192:193], s[42:43], v[32:33] op_sel_hi:[1,0,1]
    v_pk_fma_f32 v[34:35], v[194:195], s[42:43], v[34:35] op_sel_hi:[1,0,1]
    v_pk_fma_f32 v[40:41], v[196:197], s[42:43], v[40:41] op_sel_hi:[1,0,1]
    v_pk_fma_f32 v[42:43], v[198:199], s[42:43], v[42:43] op_sel_hi:[1,0,1]
    s_add_u32 s62, s33, 655360
    buffer_load_dwordx4 a[64:67], v30, s[24:27], s62 offen offset:0
    v_lshlrev_b32 v200, 16, v148
    v_and_b32 v201, s43, v148
    v_lshlrev_b32 v202, 16, v149
    v_and_b32 v203, s43, v149
    v_lshlrev_b32 v204, 16, v150
    v_and_b32 v205, s43, v150
    v_lshlrev_b32 v206, 16, v151
    v_and_b32 v207, s43, v151
    v_pk_fma_f32 v[48:49], v[200:201], s[42:43], v[48:49] op_sel_hi:[1,0,1]
    v_pk_fma_f32 v[50:51], v[202:203], s[42:43], v[50:51] op_sel_hi:[1,0,1]
    v_pk_fma_f32 v[56:57], v[204:205], s[42:43], v[56:57] op_sel_hi:[1,0,1]
    v_pk_fma_f32 v[58:59], v[206:207], s[42:43], v[58:59] op_sel_hi:[1,0,1]
    buffer_load_dwordx4 a[68:71], v30, s[24:27], s62 offen offset:1024
    v_lshlrev_b32 v192, 16, v152
    v_and_b32 v193, s43, v152
    v_lshlrev_b32 v194, 16, v153
    v_and_b32 v195, s43, v153
    v_lshlrev_b32 v196, 16, v154
    v_and_b32 v197, s43, v154
    v_lshlrev_b32 v198, 16, v155
    v_and_b32 v199, s43, v155
    v_pk_fma_f32 v[36:37], v[192:193], s[42:43], v[36:37] op_sel_hi:[1,0,1]
    v_pk_fma_f32 v[38:39], v[194:195], s[42:43], v[38:39] op_sel_hi:[1,0,1]
    v_pk_fma_f32 v[44:45], v[196:197], s[42:43], v[44:45] op_sel_hi:[1,0,1]
    v_pk_fma_f32 v[46:47], v[198:199], s[42:43], v[46:47] op_sel_hi:[1,0,1]
    buffer_load_dwordx4 a[72:75], v30, s[24:27], s62 offen offset:2048
    v_lshlrev_b32 v200, 16, v156
    v_and_b32 v201, s43, v156
    v_lshlrev_b32 v202, 16, v157
    v_and_b32 v203, s43, v157
    v_lshlrev_b32 v204, 16, v158
    v_and_b32 v205, s43, v158
    v_lshlrev_b32 v206, 16, v159
    v_and_b32 v207, s43, v159
    v_pk_fma_f32 v[52:53], v[200:201], s[42:43], v[52:53] op_sel_hi:[1,0,1]
    v_pk_fma_f32 v[54:55], v[202:203], s[42:43], v[54:55] op_sel_hi:[1,0,1]
    v_pk_fma_f32 v[60:61], v[204:205], s[42:43], v[60:61] op_sel_hi:[1,0,1]
    v_pk_fma_f32 v[62:63], v[206:207], s[42:43], v[62:63] op_sel_hi:[1,0,1]
    buffer_load_dwordx4 a[76:79], v30, s[24:27], s62 offen offset:3072
    v_pk_add_f32 v[192:193], v[32:33], v[34:35]
    v_pk_mul_f32 v[194:195], v[32:33], v[32:33]
    v_pk_fma_f32 v[194:195], v[34:35], v[34:35], v[194:195]
    v_pk_add_f32 v[192:193], v[192:193], v[40:41]
    v_pk_fma_f32 v[194:195], v[40:41], v[40:41], v[194:195]
    v_pk_add_f32 v[192:193], v[192:193], v[42:43]
    s_add_u32 s62, s33, 659456
    buffer_load_dwordx4 a[80:83], v30, s[24:27], s62 offen offset:0
    v_pk_fma_f32 v[194:195], v[42:43], v[42:43], v[194:195]
    v_pk_add_f32 v[192:193], v[192:193], v[48:49]
    v_pk_fma_f32 v[194:195], v[48:49], v[48:49], v[194:195]
    v_pk_add_f32 v[192:193], v[192:193], v[50:51]
    v_pk_fma_f32 v[194:195], v[50:51], v[50:51], v[194:195]
    v_pk_add_f32 v[192:193], v[192:193], v[56:57]
    v_pk_fma_f32 v[194:195], v[56:57], v[56:57], v[194:195]
    v_pk_add_f32 v[192:193], v[192:193], v[58:59]
    v_pk_fma_f32 v[194:195], v[58:59], v[58:59], v[194:195]
    v_pk_add_f32 v[196:197], v[36:37], v[38:39]
    buffer_load_dwordx4 a[84:87], v30, s[24:27], s62 offen offset:1024
    v_pk_mul_f32 v[198:199], v[36:37], v[36:37]
    v_pk_fma_f32 v[198:199], v[38:39], v[38:39], v[198:199]
    v_pk_add_f32 v[196:197], v[196:197], v[44:45]
    v_pk_fma_f32 v[198:199], v[44:45], v[44:45], v[198:199]
    v_pk_add_f32 v[196:197], v[196:197], v[46:47]
    v_pk_fma_f32 v[198:199], v[46:47], v[46:47], v[198:199]
    v_pk_add_f32 v[196:197], v[196:197], v[52:53]
    v_pk_fma_f32 v[198:199], v[52:53], v[52:53], v[198:199]
    v_pk_add_f32 v[196:197], v[196:197], v[54:55]
    v_pk_fma_f32 v[198:199], v[54:55], v[54:55], v[198:199]
    buffer_load_dwordx4 a[88:91], v30, s[24:27], s62 offen offset:2048
    v_pk_add_f32 v[196:197], v[196:197], v[60:61]
    v_pk_fma_f32 v[198:199], v[60:61], v[60:61], v[198:199]
    v_pk_add_f32 v[196:197], v[196:197], v[62:63]
    v_pk_fma_f32 v[198:199], v[62:63], v[62:63], v[198:199]
    v_add_f32 v192, v192, v193
    v_add_f32 v194, v194, v195
    v_add_f32 v196, v196, v197
    v_add_f32 v198, v198, v199
    v_permlane32_swap_b32 v192, v194
    s_nop 0
    v_permlane32_swap_b32 v196, v198
    buffer_load_dwordx4 a[92:95], v30, s[24:27], s62 offen offset:3072
    v_add_f32 v192, v192, v194
    v_add_f32 v196, v196, v198
    s_nop 1
    v_permlane16_swap_b32 v192, v196
    v_add_f32 v192, v192, v196
    ds_write_b32 v28, v192 offset:0
    s_add_u32 s62, s33, 663552
    buffer_load_dwordx4 a[160:163], v30, s[24:27], s62 offen offset:0
    buffer_load_dwordx4 a[164:167], v30, s[24:27], s62 offen offset:1024
    buffer_load_dwordx4 a[168:171], v30, s[24:27], s62 offen offset:2048
    buffer_load_dwordx4 a[172:175], v30, s[24:27], s62 offen offset:3072
    s_waitcnt lgkmcnt(0)
    s_barrier
    ds_read_b128 v[208:211], v29 offset:0
    ds_read_b128 v[216:219], v29 offset:512
    ds_read_b128 v[212:215], v29 offset:256
    ds_read_b128 v[220:223], v29 offset:768
    s_waitcnt lgkmcnt(3)
    v_pk_add_f32 v[208:209], v[208:209], v[210:211]
    s_waitcnt lgkmcnt(2)
    v_pk_add_f32 v[216:217], v[216:217], v[218:219]
    s_waitcnt lgkmcnt(1)
    v_pk_add_f32 v[212:213], v[212:213], v[214:215]
    s_waitcnt lgkmcnt(0)
    v_pk_add_f32 v[220:221], v[220:221], v[222:223]
    v_add_f32 v208, v208, v209
    v_add_f32 v216, v216, v217
    v_add_f32 v212, v212, v213
    v_add_f32 v220, v220, v221
    v_mul_f32 v208, 0x3b800000, v208
    v_mul_f32 v216, 0x3b800000, v216
    v_mul_f32 v212, 0x3b800000, v212
    v_mul_f32 v220, 0x3b800000, v220
    v_fma_f32 v216, -v208, v208, v216
    v_fma_f32 v220, -v212, v212, v220
    v_max_f32 v216, 0, v216
    v_max_f32 v220, 0, v220
    v_add_f32 v216, 0x3727c5ac, v216
    v_add_f32 v220, 0x3727c5ac, v220
    v_rsq_f32 v192, v216
    v_rsq_f32 v196, v220
    v_mul_f32 v194, -v208, v192
    v_mul_f32 v198, -v212, v196
    v_pk_fma_f32 v[208:209], v[32:33], v[192:193], v[194:195] op_sel_hi:[1,0,0]
    v_pk_fma_f32 v[210:211], v[34:35], v[192:193], v[194:195] op_sel_hi:[1,0,0]
    v_pk_fma_f32 v[212:213], v[40:41], v[192:193], v[194:195] op_sel_hi:[1,0,0]
    v_pk_fma_f32 v[214:215], v[42:43], v[192:193], v[194:195] op_sel_hi:[1,0,0]
    v_cvt_pk_bf16_f32 v216, v208, v209
    v_cvt_pk_bf16_f32 v217, v210, v211
    v_cvt_pk_bf16_f32 v218, v212, v213
    v_cvt_pk_bf16_f32 v219, v214, v215
    ds_write_b128 v245, v[216:219] offset:0
    v_pk_fma_f32 v[220:221], v[48:49], v[192:193], v[194:195] op_sel_hi:[1,0,0]
    v_pk_fma_f32 v[222:223], v[50:51], v[192:193], v[194:195] op_sel_hi:[1,0,0]
    v_pk_fma_f32 v[224:225], v[56:57], v[192:193], v[194:195] op_sel_hi:[1,0,0]
    v_pk_fma_f32 v[226:227], v[58:59], v[192:193], v[194:195] op_sel_hi:[1,0,0]
    v_cvt_pk_bf16_f32 v228, v220, v221
    v_cvt_pk_bf16_f32 v229, v222, v223
    v_cvt_pk_bf16_f32 v230, v224, v225
    v_cvt_pk_bf16_f32 v231, v226, v227
    ds_write_b128 v245, v[228:231] offset:2048
    v_pk_fma_f32 v[208:209], v[36:37], v[196:197], v[198:199] op_sel_hi:[1,0,0]
    v_pk_fma_f32 v[210:211], v[38:39], v[196:197], v[198:199] op_sel_hi:[1,0,0]
    v_pk_fma_f32 v[212:213], v[44:45], v[196:197], v[198:199] op_sel_hi:[1,0,0]
    v_pk_fma_f32 v[214:215], v[46:47], v[196:197], v[198:199] op_sel_hi:[1,0,0]
    v_cvt_pk_bf16_f32 v216, v208, v209
    v_cvt_pk_bf16_f32 v217, v210, v211
    v_cvt_pk_bf16_f32 v218, v212, v213
    v_cvt_pk_bf16_f32 v219, v214, v215
    ds_write_b128 v245, v[216:219] offset:1024
    v_pk_fma_f32 v[220:221], v[52:53], v[196:197], v[198:199] op_sel_hi:[1,0,0]
    v_pk_fma_f32 v[222:223], v[54:55], v[196:197], v[198:199] op_sel_hi:[1,0,0]
    v_pk_fma_f32 v[224:225], v[60:61], v[196:197], v[198:199] op_sel_hi:[1,0,0]
    v_pk_fma_f32 v[226:227], v[62:63], v[196:197], v[198:199] op_sel_hi:[1,0,0]
    v_cvt_pk_bf16_f32 v228, v220, v221
    v_cvt_pk_bf16_f32 v229, v222, v223
    v_cvt_pk_bf16_f32 v230, v224, v225
    v_cvt_pk_bf16_f32 v231, v226, v227
    ds_write_b128 v245, v[228:231] offset:3072
    s_add_u32 s62, s33, 667648
    buffer_load_dwordx4 a[176:179], v30, s[24:27], s62 offen offset:0
    buffer_load_dwordx4 a[180:183], v30, s[24:27], s62 offen offset:1024
    buffer_load_dwordx4 a[184:187], v30, s[24:27], s62 offen offset:2048
    buffer_load_dwordx4 a[188:191], v30, s[24:27], s62 offen offset:3072
    s_waitcnt lgkmcnt(0)
    s_barrier
    ds_read_b128 a[0:3], v26 offset:0
    ds_read_b128 a[4:7], v26 offset:1024
    s_waitcnt vmcnt(20)
    v_mov_b32 v244, 2
    s_cmp_eq_u32 s83, 0
    s_cbranch_scc1 standalone__conformer_family_zipformer__speech_kernel_sndv243_7s
    buffer_store_dword v244, v243, s[24:27], s81 offen
    s_branch standalone__conformer_family_zipformer__speech_kernel_sndv243_7e
standalone__conformer_family_zipformer__speech_kernel_sndv243_7s:
    buffer_store_dword v244, v243, s[24:27], s81 offen sc1
standalone__conformer_family_zipformer__speech_kernel_sndv243_7e:
    s_mov_b32 s43, 0x3e38aa3b
    ds_read_b128 a[8:11], v26 offset:2048
    ds_read_b128 a[12:15], v26 offset:3072
    s_waitcnt lgkmcnt(3)
    v_mfma_f32_16x16x32_bf16 v[64:67], a[96:99], a[0:3], 0
    ds_read_b128 a[16:19], v26 offset:4096
    s_waitcnt lgkmcnt(3)
    v_mfma_f32_16x16x32_bf16 v[68:71], a[96:99], a[4:7], 0
    ds_read_b128 a[20:23], v26 offset:5120
    v_mfma_f32_16x16x32_bf16 v[72:75], a[100:103], a[0:3], 0
    v_cvt_pk_bf16_f32 v216, v32, v33
    v_mfma_f32_16x16x32_bf16 v[76:79], a[100:103], a[4:7], 0
    ds_read_b128 a[24:27], v26 offset:6144
    s_waitcnt lgkmcnt(4)
    v_mfma_f32_16x16x32_bf16 v[64:67], a[104:107], a[8:11], v[64:67]
    ds_read_b128 a[28:31], v26 offset:7168
    s_waitcnt lgkmcnt(4)
    v_mfma_f32_16x16x32_bf16 v[68:71], a[104:107], a[12:15], v[68:71]
    v_cvt_pk_bf16_f32 v217, v34, v35
    v_mfma_f32_16x16x32_bf16 v[72:75], a[108:111], a[8:11], v[72:75]
    v_cvt_pk_bf16_f32 v218, v40, v41
    v_mfma_f32_16x16x32_bf16 v[76:79], a[108:111], a[12:15], v[76:79]
    s_waitcnt lgkmcnt(3)
    v_cvt_pk_bf16_f32 v219, v42, v43
    v_mfma_f32_16x16x32_bf16 v[64:67], a[112:115], a[16:19], v[64:67]
    ds_read_b128 a[32:35], v26 offset:8192
    s_waitcnt lgkmcnt(3)
    v_mfma_f32_16x16x32_bf16 v[68:71], a[112:115], a[20:23], v[68:71]
    ds_read_b128 a[36:39], v26 offset:9216
    v_mfma_f32_16x16x32_bf16 v[72:75], a[116:119], a[16:19], v[72:75]
    v_cvt_pk_bf16_f32 v220, v48, v49
    v_mfma_f32_16x16x32_bf16 v[76:79], a[116:119], a[20:23], v[76:79]
    ds_read_b128 a[40:43], v26 offset:10240
    s_waitcnt lgkmcnt(4)
    v_mfma_f32_16x16x32_bf16 v[64:67], a[120:123], a[24:27], v[64:67]
    ds_read_b128 a[44:47], v26 offset:11264
    s_waitcnt lgkmcnt(4)
    v_mfma_f32_16x16x32_bf16 v[68:71], a[120:123], a[28:31], v[68:71]
    v_cvt_pk_bf16_f32 v221, v50, v51
    v_mfma_f32_16x16x32_bf16 v[72:75], a[124:127], a[24:27], v[72:75]
    v_cvt_pk_bf16_f32 v222, v56, v57
    v_mfma_f32_16x16x32_bf16 v[76:79], a[124:127], a[28:31], v[76:79]
    s_waitcnt lgkmcnt(3)
    v_cvt_pk_bf16_f32 v223, v58, v59
    v_mfma_f32_16x16x32_bf16 v[64:67], a[128:131], a[32:35], v[64:67]
    s_add_u32 s62, s33, 671744
    ds_read_b128 a[48:51], v26 offset:12288
    s_waitcnt lgkmcnt(3)
    v_mfma_f32_16x16x32_bf16 v[68:71], a[128:131], a[36:39], v[68:71]
    buffer_load_dwordx4 a[128:131], v30, s[24:27], s62 offen offset:0
    ds_read_b128 a[52:55], v26 offset:13312
    v_mfma_f32_16x16x32_bf16 v[72:75], a[132:135], a[32:35], v[72:75]
    v_cvt_pk_bf16_f32 v224, v36, v37
    v_mfma_f32_16x16x32_bf16 v[76:79], a[132:135], a[36:39], v[76:79]
    buffer_load_dwordx4 a[132:135], v30, s[24:27], s62 offen offset:1024
    ds_read_b128 a[56:59], v26 offset:14336
    s_waitcnt lgkmcnt(4)
    v_mfma_f32_16x16x32_bf16 v[64:67], a[136:139], a[40:43], v[64:67]
    ds_read_b128 a[60:63], v26 offset:15360
    s_waitcnt lgkmcnt(4)
    v_mfma_f32_16x16x32_bf16 v[68:71], a[136:139], a[44:47], v[68:71]
    buffer_load_dwordx4 a[136:139], v30, s[24:27], s62 offen offset:2048
    v_cvt_pk_bf16_f32 v225, v38, v39
    v_mfma_f32_16x16x32_bf16 v[72:75], a[140:143], a[40:43], v[72:75]
    v_cvt_pk_bf16_f32 v226, v44, v45
    v_mfma_f32_16x16x32_bf16 v[76:79], a[140:143], a[44:47], v[76:79]
    buffer_load_dwordx4 a[140:143], v30, s[24:27], s62 offen offset:3072
    v_cvt_pk_bf16_f32 v227, v46, v47
    s_waitcnt lgkmcnt(3)
    v_mfma_f32_16x16x32_bf16 v[64:67], a[144:147], a[48:51], v[64:67]
    s_add_u32 s62, s33, 675840
    s_waitcnt lgkmcnt(2)
    v_mfma_f32_16x16x32_bf16 v[68:71], a[144:147], a[52:55], v[68:71]
    buffer_load_dwordx4 a[144:147], v30, s[24:27], s62 offen offset:0
    v_mfma_f32_16x16x32_bf16 v[72:75], a[148:151], a[48:51], v[72:75]
    v_cvt_pk_bf16_f32 v228, v52, v53
    v_mfma_f32_16x16x32_bf16 v[76:79], a[148:151], a[52:55], v[76:79]
    buffer_load_dwordx4 a[148:151], v30, s[24:27], s62 offen offset:1024
    v_cvt_pk_bf16_f32 v229, v54, v55
    s_waitcnt lgkmcnt(1)
    v_mfma_f32_16x16x32_bf16 v[64:67], a[152:155], a[56:59], v[64:67]
    s_waitcnt lgkmcnt(0)
    v_cvt_pk_bf16_f32 v230, v60, v61
    v_mfma_f32_16x16x32_bf16 v[68:71], a[152:155], a[60:63], v[68:71]
    buffer_load_dwordx4 a[152:155], v30, s[24:27], s62 offen offset:2048
    v_mfma_f32_16x16x32_bf16 v[72:75], a[156:159], a[56:59], v[72:75]
    v_cvt_pk_bf16_f32 v231, v62, v63
    v_mfma_f32_16x16x32_bf16 v[76:79], a[156:159], a[60:63], v[76:79]
    buffer_load_dwordx4 a[156:159], v30, s[24:27], s62 offen offset:3072
    v_mfma_f32_16x16x32_bf16 v[80:83], a[192:195], a[0:3], 0
    s_add_u32 s62, s33, 679936
    v_mul_f32 v64, s43, v64
    v_mfma_f32_16x16x32_bf16 v[84:87], a[192:195], a[4:7], 0
    buffer_load_dwordx4 a[192:195], v30, s[24:27], s62 offen offset:0
    v_mfma_f32_16x16x32_bf16 v[88:91], a[196:199], a[0:3], 0
    v_mul_f32 v65, s43, v65
    v_mul_f32 v66, s43, v66
    v_mfma_f32_16x16x32_bf16 v[92:95], a[196:199], a[4:7], 0
    buffer_load_dwordx4 a[196:199], v30, s[24:27], s62 offen offset:1024
    v_mfma_f32_16x16x32_bf16 v[80:83], a[200:203], a[8:11], v[80:83]
    v_mul_f32 v67, s43, v67
    v_cvt_pk_bf16_f32 v176, v64, v65
    v_mfma_f32_16x16x32_bf16 v[84:87], a[200:203], a[12:15], v[84:87]
    buffer_load_dwordx4 a[200:203], v30, s[24:27], s62 offen offset:2048
    v_mfma_f32_16x16x32_bf16 v[88:91], a[204:207], a[8:11], v[88:91]
    v_cvt_pk_bf16_f32 v177, v66, v67
    v_mul_f32 v72, s43, v72
    v_mfma_f32_16x16x32_bf16 v[92:95], a[204:207], a[12:15], v[92:95]
    buffer_load_dwordx4 a[204:207], v30, s[24:27], s62 offen offset:3072
    v_mfma_f32_16x16x32_bf16 v[80:83], a[208:211], a[16:19], v[80:83]
    s_add_u32 s62, s33, 684032
    v_mfma_f32_16x16x32_bf16 v[84:87], a[208:211], a[20:23], v[84:87]
    buffer_load_dwordx4 a[208:211], v30, s[24:27], s62 offen offset:0
    v_mul_f32 v73, s43, v73
    v_mfma_f32_16x16x32_bf16 v[88:91], a[212:215], a[16:19], v[88:91]
    v_mul_f32 v74, s43, v74
    v_mfma_f32_16x16x32_bf16 v[92:95], a[212:215], a[20:23], v[92:95]
    buffer_load_dwordx4 a[212:215], v30, s[24:27], s62 offen offset:1024
    v_mfma_f32_16x16x32_bf16 v[80:83], a[216:219], a[24:27], v[80:83]
    v_mul_f32 v75, s43, v75
    v_mfma_f32_16x16x32_bf16 v[84:87], a[216:219], a[28:31], v[84:87]
    buffer_load_dwordx4 a[216:219], v30, s[24:27], s62 offen offset:2048
    v_cvt_pk_bf16_f32 v178, v72, v73
    v_mfma_f32_16x16x32_bf16 v[88:91], a[220:223], a[24:27], v[88:91]
    v_cvt_pk_bf16_f32 v179, v74, v75
    v_mfma_f32_16x16x32_bf16 v[92:95], a[220:223], a[28:31], v[92:95]
    buffer_load_dwordx4 a[220:223], v30, s[24:27], s62 offen offset:3072
    v_mfma_f32_16x16x32_bf16 v[80:83], a[224:227], a[32:35], v[80:83]
    buffer_store_dwordx4 v[176:179], v30, s[24:27], s58 offen offset:0 sc1
    s_add_u32 s62, s33, 786432
    v_mfma_f32_16x16x32_bf16 v[84:87], a[224:227], a[36:39], v[84:87]
    buffer_load_dwordx4 a[224:227], v30, s[24:27], s62 offen offset:0
    v_mfma_f32_16x16x32_bf16 v[88:91], a[228:231], a[32:35], v[88:91]
    v_mul_f32 v68, s43, v68
    v_mul_f32 v69, s43, v69
    v_mfma_f32_16x16x32_bf16 v[92:95], a[228:231], a[36:39], v[92:95]
    buffer_load_dwordx4 a[228:231], v30, s[24:27], s62 offen offset:1024
    v_mul_f32 v70, s43, v70
    v_mfma_f32_16x16x32_bf16 v[80:83], a[232:235], a[40:43], v[80:83]
    v_mul_f32 v71, s43, v71
    v_mfma_f32_16x16x32_bf16 v[84:87], a[232:235], a[44:47], v[84:87]
    buffer_load_dwordx4 a[232:235], v30, s[24:27], s62 offen offset:2048
    v_cvt_pk_bf16_f32 v184, v68, v69
    v_mfma_f32_16x16x32_bf16 v[88:91], a[236:239], a[40:43], v[88:91]
    v_cvt_pk_bf16_f32 v185, v70, v71
    v_mfma_f32_16x16x32_bf16 v[92:95], a[236:239], a[44:47], v[92:95]
    buffer_load_dwordx4 a[236:239], v30, s[24:27], s62 offen offset:3072
    v_mul_f32 v76, s43, v76
    s_waitcnt vmcnt(38)
    v_mfma_f32_16x16x32_bf16 v[80:83], a[240:243], a[48:51], v[80:83]
    v_mul_f32 v77, s43, v77
    v_mfma_f32_16x16x32_bf16 v[84:87], a[240:243], a[52:55], v[84:87]
    v_mul_f32 v78, s43, v78
    v_mfma_f32_16x16x32_bf16 v[88:91], a[244:247], a[48:51], v[88:91]
    v_mfma_f32_16x16x32_bf16 v[92:95], a[244:247], a[52:55], v[92:95]
    v_mul_f32 v79, s43, v79
    v_mfma_f32_16x16x32_bf16 v[80:83], a[248:251], a[56:59], v[80:83]
    v_cvt_pk_bf16_f32 v186, v76, v77
    v_mfma_f32_16x16x32_bf16 v[84:87], a[248:251], a[60:63], v[84:87]
    v_cvt_pk_bf16_f32 v187, v78, v79
    v_mfma_f32_16x16x32_bf16 v[88:91], a[252:255], a[56:59], v[88:91]
    buffer_store_dwordx4 v[184:187], v30, s[24:27], s58 offen offset:2048 sc1
    v_mfma_f32_16x16x32_bf16 v[92:95], a[252:255], a[60:63], v[92:95]
    s_waitcnt vmcnt(35)
    v_mfma_f32_16x16x32_bf16 v[96:99], a[64:67], a[0:3], 0
    s_add_u32 s63, s33, 790528
    v_mul_f32 v80, s43, v80
    v_mfma_f32_16x16x32_bf16 v[100:103], a[64:67], a[4:7], 0
    buffer_load_dwordx4 a[240:243], v30, s[24:27], s63 offen offset:0
    v_mfma_f32_16x16x32_bf16 v[104:107], a[68:71], a[0:3], 0
    buffer_load_dwordx4 a[244:247], v30, s[24:27], s63 offen offset:1024
    v_mul_f32 v81, s43, v81
    v_mfma_f32_16x16x32_bf16 v[108:111], a[68:71], a[4:7], 0
    v_mul_f32 v82, s43, v82
    v_mfma_f32_16x16x32_bf16 v[96:99], a[72:75], a[8:11], v[96:99]
    buffer_load_dwordx4 a[248:251], v30, s[24:27], s63 offen offset:2048
    v_mul_f32 v83, s43, v83
    v_mfma_f32_16x16x32_bf16 v[100:103], a[72:75], a[12:15], v[100:103]
    buffer_load_dwordx4 a[252:255], v30, s[24:27], s63 offen offset:3072
    v_mfma_f32_16x16x32_bf16 v[104:107], a[76:79], a[8:11], v[104:107]
    v_cvt_pk_bf16_f32 v180, v80, v81
    v_cvt_pk_bf16_f32 v181, v82, v83
    v_mfma_f32_16x16x32_bf16 v[108:111], a[76:79], a[12:15], v[108:111]
    s_waitcnt vmcnt(35)
    v_mul_f32 v88, s43, v88
    v_mfma_f32_16x16x32_bf16 v[96:99], a[80:83], a[16:19], v[96:99]
    s_add_u32 s63, s33, 794624
    v_mfma_f32_16x16x32_bf16 v[100:103], a[80:83], a[20:23], v[100:103]
    buffer_load_dwordx4 a[64:67], v30, s[24:27], s63 offen offset:0
    v_mul_f32 v89, s43, v89
    v_mfma_f32_16x16x32_bf16 v[104:107], a[84:87], a[16:19], v[104:107]
    buffer_load_dwordx4 a[68:71], v30, s[24:27], s63 offen offset:1024
    v_mfma_f32_16x16x32_bf16 v[108:111], a[84:87], a[20:23], v[108:111]
    v_mul_f32 v90, s43, v90
    v_mfma_f32_16x16x32_bf16 v[96:99], a[88:91], a[24:27], v[96:99]
    buffer_load_dwordx4 a[72:75], v30, s[24:27], s63 offen offset:2048
    v_mfma_f32_16x16x32_bf16 v[100:103], a[88:91], a[28:31], v[100:103]
    buffer_load_dwordx4 a[76:79], v30, s[24:27], s63 offen offset:3072
    v_mul_f32 v91, s43, v91
    v_mfma_f32_16x16x32_bf16 v[104:107], a[92:95], a[24:27], v[104:107]
    v_cvt_pk_bf16_f32 v182, v88, v89
    v_mfma_f32_16x16x32_bf16 v[108:111], a[92:95], a[28:31], v[108:111]
    s_waitcnt vmcnt(35)
    v_cvt_pk_bf16_f32 v183, v90, v91
    v_mfma_f32_16x16x32_bf16 v[96:99], a[160:163], a[32:35], v[96:99]
    buffer_store_dwordx4 v[180:183], v30, s[24:27], s58 offen offset:1024 sc1
    s_add_u32 s63, s33, 798720
    v_mfma_f32_16x16x32_bf16 v[100:103], a[160:163], a[36:39], v[100:103]
    buffer_load_dwordx4 a[80:83], v30, s[24:27], s63 offen offset:0
    v_mfma_f32_16x16x32_bf16 v[104:107], a[164:167], a[32:35], v[104:107]
    buffer_load_dwordx4 a[84:87], v30, s[24:27], s63 offen offset:1024
    v_mul_f32 v84, s43, v84
    v_mfma_f32_16x16x32_bf16 v[108:111], a[164:167], a[36:39], v[108:111]
    v_mul_f32 v85, s43, v85
    v_mul_f32 v86, s43, v86
    v_mfma_f32_16x16x32_bf16 v[96:99], a[168:171], a[40:43], v[96:99]
    buffer_load_dwordx4 a[88:91], v30, s[24:27], s63 offen offset:2048
    v_mfma_f32_16x16x32_bf16 v[100:103], a[168:171], a[44:47], v[100:103]
    buffer_load_dwordx4 a[92:95], v30, s[24:27], s63 offen offset:3072
    v_mul_f32 v87, s43, v87
    v_mfma_f32_16x16x32_bf16 v[104:107], a[172:175], a[40:43], v[104:107]
    v_cvt_pk_bf16_f32 v188, v84, v85
    v_mfma_f32_16x16x32_bf16 v[108:111], a[172:175], a[44:47], v[108:111]
    s_waitcnt vmcnt(36)
    v_cvt_pk_bf16_f32 v189, v86, v87
    v_mul_f32 v92, s43, v92
    v_mfma_f32_16x16x32_bf16 v[96:99], a[176:179], a[48:51], v[96:99]
    v_mul_f32 v93, s43, v93
    v_mfma_f32_16x16x32_bf16 v[100:103], a[176:179], a[52:55], v[100:103]
    v_mul_f32 v94, s43, v94
    v_mfma_f32_16x16x32_bf16 v[104:107], a[180:183], a[48:51], v[104:107]
    v_mfma_f32_16x16x32_bf16 v[108:111], a[180:183], a[52:55], v[108:111]
    v_mul_f32 v95, s43, v95
    v_mfma_f32_16x16x32_bf16 v[96:99], a[184:187], a[56:59], v[96:99]
    v_cvt_pk_bf16_f32 v190, v92, v93
    v_mfma_f32_16x16x32_bf16 v[100:103], a[184:187], a[60:63], v[100:103]
    v_cvt_pk_bf16_f32 v191, v94, v95
    v_mfma_f32_16x16x32_bf16 v[104:107], a[188:191], a[56:59], v[104:107]
    buffer_store_dwordx4 v[188:191], v30, s[24:27], s58 offen offset:3072 sc1
    v_mfma_f32_16x16x32_bf16 v[108:111], a[188:191], a[60:63], v[108:111]
    s_waitcnt vmcnt(32)
    v_mfma_f32_16x16x32_bf16 v[112:115], a[128:131], a[0:3], 0
    s_add_u32 s63, s33, 802816
    v_mfma_f32_16x16x32_bf16 v[116:119], a[128:131], a[4:7], 0
    buffer_load_dwordx4 a[96:99], v30, s[24:27], s63 offen offset:0
    v_mfma_f32_16x16x32_bf16 v[120:123], a[132:135], a[0:3], 0
    buffer_load_dwordx4 a[100:103], v30, s[24:27], s63 offen offset:1024
    v_mfma_f32_16x16x32_bf16 v[124:127], a[132:135], a[4:7], 0
    v_cvt_pk_bf16_f32 v160, v96, v97
    v_mfma_f32_16x16x32_bf16 v[112:115], a[136:139], a[8:11], v[112:115]
    buffer_load_dwordx4 a[104:107], v30, s[24:27], s63 offen offset:2048
    v_mfma_f32_16x16x32_bf16 v[116:119], a[136:139], a[12:15], v[116:119]
    buffer_load_dwordx4 a[108:111], v30, s[24:27], s63 offen offset:3072
    v_mfma_f32_16x16x32_bf16 v[120:123], a[140:143], a[8:11], v[120:123]
    v_cvt_pk_bf16_f32 v161, v98, v99
    v_mfma_f32_16x16x32_bf16 v[124:127], a[140:143], a[12:15], v[124:127]
    s_waitcnt vmcnt(32)
    v_cvt_pk_bf16_f32 v162, v104, v105
    v_mfma_f32_16x16x32_bf16 v[112:115], a[144:147], a[16:19], v[112:115]
    s_add_u32 s63, s33, 806912
    v_mfma_f32_16x16x32_bf16 v[116:119], a[144:147], a[20:23], v[116:119]
    buffer_load_dwordx4 a[112:115], v30, s[24:27], s63 offen offset:0
    v_mfma_f32_16x16x32_bf16 v[120:123], a[148:151], a[16:19], v[120:123]
    buffer_load_dwordx4 a[116:119], v30, s[24:27], s63 offen offset:1024
    v_mfma_f32_16x16x32_bf16 v[124:127], a[148:151], a[20:23], v[124:127]
    v_mfma_f32_16x16x32_bf16 v[112:115], a[152:155], a[24:27], v[112:115]
    buffer_load_dwordx4 a[120:123], v30, s[24:27], s63 offen offset:2048
    v_mfma_f32_16x16x32_bf16 v[116:119], a[152:155], a[28:31], v[116:119]
    buffer_load_dwordx4 a[124:127], v30, s[24:27], s63 offen offset:3072
    v_mfma_f32_16x16x32_bf16 v[120:123], a[156:159], a[24:27], v[120:123]
    v_mfma_f32_16x16x32_bf16 v[124:127], a[156:159], a[28:31], v[124:127]
    s_waitcnt vmcnt(32)
    v_cvt_pk_bf16_f32 v163, v106, v107
    v_mfma_f32_16x16x32_bf16 v[112:115], a[192:195], a[32:35], v[112:115]
    buffer_store_dwordx4 v[160:163], v30, s[24:27], s59 offen offset:0 sc1
    v_mfma_f32_16x16x32_bf16 v[116:119], a[192:195], a[36:39], v[116:119]
    v_mfma_f32_16x16x32_bf16 v[120:123], a[196:199], a[32:35], v[120:123]
    v_cvt_pk_bf16_f32 v168, v100, v101
    v_mfma_f32_16x16x32_bf16 v[124:127], a[196:199], a[36:39], v[124:127]
    v_mfma_f32_16x16x32_bf16 v[112:115], a[200:203], a[40:43], v[112:115]
    v_cvt_pk_bf16_f32 v169, v102, v103
    v_mfma_f32_16x16x32_bf16 v[116:119], a[200:203], a[44:47], v[116:119]
    v_mfma_f32_16x16x32_bf16 v[120:123], a[204:207], a[40:43], v[120:123]
    v_cvt_pk_bf16_f32 v170, v108, v109
    v_mfma_f32_16x16x32_bf16 v[124:127], a[204:207], a[44:47], v[124:127]
    s_waitcnt vmcnt(29)
    v_mfma_f32_16x16x32_bf16 v[112:115], a[208:211], a[48:51], v[112:115]
    s_add_u32 s63, s33, 811008
    v_mfma_f32_16x16x32_bf16 v[116:119], a[208:211], a[52:55], v[116:119]
    buffer_load_dwordx4 a[128:131], v30, s[24:27], s63 offen offset:0
    v_mfma_f32_16x16x32_bf16 v[120:123], a[212:215], a[48:51], v[120:123]
    buffer_load_dwordx4 a[132:135], v30, s[24:27], s63 offen offset:1024
    v_mfma_f32_16x16x32_bf16 v[124:127], a[212:215], a[52:55], v[124:127]
    v_cvt_pk_bf16_f32 v171, v110, v111
    v_mfma_f32_16x16x32_bf16 v[112:115], a[216:219], a[56:59], v[112:115]
    buffer_store_dwordx4 v[168:171], v30, s[24:27], s59 offen offset:2048 sc1
    buffer_load_dwordx4 a[136:139], v30, s[24:27], s63 offen offset:2048
    v_mfma_f32_16x16x32_bf16 v[116:119], a[216:219], a[60:63], v[116:119]
    buffer_load_dwordx4 a[140:143], v30, s[24:27], s63 offen offset:3072
    v_mfma_f32_16x16x32_bf16 v[120:123], a[220:223], a[56:59], v[120:123]
    v_mfma_f32_16x16x32_bf16 v[124:127], a[220:223], a[60:63], v[124:127]
    s_waitcnt vmcnt(29)
    v_mfma_f32_16x16x32_bf16 v[128:131], a[0:3], a[224:227], 0
    s_add_u32 s63, s33, 815104
    v_mfma_f32_16x16x32_bf16 v[132:135], a[4:7], a[224:227], 0
    buffer_load_dwordx4 a[144:147], v30, s[24:27], s63 offen offset:0
    v_mfma_f32_16x16x32_bf16 v[136:139], a[0:3], a[228:231], 0
    buffer_load_dwordx4 a[148:151], v30, s[24:27], s63 offen offset:1024
    v_mfma_f32_16x16x32_bf16 v[140:143], a[4:7], a[228:231], 0
    v_cvt_pk_bf16_f32 v164, v112, v113
    v_cvt_pk_bf16_f32 v165, v114, v115
    v_mfma_f32_16x16x32_bf16 v[128:131], a[8:11], a[232:235], v[128:131]
    buffer_load_dwordx4 a[152:155], v30, s[24:27], s63 offen offset:2048
    v_mfma_f32_16x16x32_bf16 v[132:135], a[12:15], a[232:235], v[132:135]
    buffer_load_dwordx4 a[156:159], v30, s[24:27], s63 offen offset:3072
    v_mfma_f32_16x16x32_bf16 v[136:139], a[8:11], a[236:239], v[136:139]
    v_cvt_pk_bf16_f32 v166, v120, v121
    v_mfma_f32_16x16x32_bf16 v[140:143], a[12:15], a[236:239], v[140:143]
    s_waitcnt vmcnt(28)
    v_cvt_pk_bf16_f32 v167, v122, v123
    v_mfma_f32_16x16x32_bf16 v[128:131], a[16:19], a[240:243], v[128:131]
    buffer_store_dwordx4 v[164:167], v30, s[24:27], s59 offen offset:1024 sc1
    v_mfma_f32_16x16x32_bf16 v[132:135], a[20:23], a[240:243], v[132:135]
    v_mfma_f32_16x16x32_bf16 v[136:139], a[16:19], a[244:247], v[136:139]
    v_cvt_pk_bf16_f32 v172, v116, v117
    v_mfma_f32_16x16x32_bf16 v[140:143], a[20:23], a[244:247], v[140:143]
    v_cvt_pk_bf16_f32 v173, v118, v119
    v_mfma_f32_16x16x32_bf16 v[128:131], a[24:27], a[248:251], v[128:131]
    v_mfma_f32_16x16x32_bf16 v[132:135], a[28:31], a[248:251], v[132:135]
    v_cvt_pk_bf16_f32 v174, v124, v125
    v_mfma_f32_16x16x32_bf16 v[136:139], a[24:27], a[252:255], v[136:139]
    v_mfma_f32_16x16x32_bf16 v[140:143], a[28:31], a[252:255], v[140:143]
    s_waitcnt vmcnt(25)
    v_cvt_pk_bf16_f32 v175, v126, v127
    v_mfma_f32_16x16x32_bf16 v[128:131], a[32:35], a[64:67], v[128:131]
    buffer_store_dwordx4 v[172:175], v30, s[24:27], s59 offen offset:3072 sc1
    v_mfma_f32_16x16x32_bf16 v[132:135], a[36:39], a[64:67], v[132:135]
    v_mfma_f32_16x16x32_bf16 v[136:139], a[32:35], a[68:71], v[136:139]
    v_mfma_f32_16x16x32_bf16 v[192:195], v[160:163], v[176:179], 0
    v_mfma_f32_16x16x32_bf16 v[140:143], a[36:39], a[68:71], v[140:143]
    v_mfma_f32_16x16x32_bf16 v[200:203], v[160:163], v[184:187], 0
    v_mfma_f32_16x16x32_bf16 v[128:131], a[40:43], a[72:75], v[128:131]
    v_mfma_f32_16x16x32_bf16 v[132:135], a[44:47], a[72:75], v[132:135]
    v_mfma_f32_16x16x32_bf16 v[196:199], v[168:171], v[176:179], 0
    v_mfma_f32_16x16x32_bf16 v[136:139], a[40:43], a[76:79], v[136:139]
    v_mfma_f32_16x16x32_bf16 v[140:143], a[44:47], a[76:79], v[140:143]
    v_mfma_f32_16x16x32_bf16 v[204:207], v[168:171], v[184:187], 0
    s_waitcnt vmcnt(21)
    v_mfma_f32_16x16x32_bf16 v[128:131], a[48:51], a[80:83], v[128:131]
    v_mfma_f32_16x16x32_bf16 v[192:195], v[164:167], v[180:183], v[192:195]
    v_mfma_f32_16x16x32_bf16 v[132:135], a[52:55], a[80:83], v[132:135]
    v_mfma_f32_16x16x32_bf16 v[136:139], a[48:51], a[84:87], v[136:139]
    v_mfma_f32_16x16x32_bf16 v[200:203], v[164:167], v[188:191], v[200:203]
    v_mfma_f32_16x16x32_bf16 v[140:143], a[52:55], a[84:87], v[140:143]
    v_mfma_f32_16x16x32_bf16 v[128:131], a[56:59], a[88:91], v[128:131]
    v_mfma_f32_16x16x32_bf16 v[196:199], v[172:175], v[180:183], v[196:199]
    v_mfma_f32_16x16x32_bf16 v[132:135], a[60:63], a[88:91], v[132:135]
    v_mfma_f32_16x16x32_bf16 v[136:139], a[56:59], a[92:95], v[136:139]
    v_mfma_f32_16x16x32_bf16 v[204:207], v[172:175], v[188:191], v[204:207]
    v_mfma_f32_16x16x32_bf16 v[140:143], a[60:63], a[92:95], v[140:143]
    s_waitcnt vmcnt(16)
    v_mfma_f32_16x16x32_bf16 v[144:147], a[0:3], a[96:99], 0
    s_nop 0
    v_cvt_pk_bf16_f32 v64, v128, v129
    v_mfma_f32_16x16x32_bf16 v[148:151], a[4:7], a[96:99], 0
    v_cvt_pk_bf16_f32 v65, v130, v131
    v_mfma_f32_16x16x32_bf16 v[152:155], a[0:3], a[100:103], 0
    v_cvt_pk_bf16_f32 v66, v132, v133
    v_mfma_f32_16x16x32_bf16 v[156:159], a[4:7], a[100:103], 0
    v_cvt_pk_bf16_f32 v67, v134, v135
    v_mfma_f32_16x16x32_bf16 v[144:147], a[8:11], a[104:107], v[144:147]
    buffer_store_dwordx4 v[64:67], v30, s[24:27], s60 offen offset:0 sc1
    v_mfma_f32_16x16x32_bf16 v[148:151], a[12:15], a[104:107], v[148:151]
    v_mfma_f32_16x16x32_bf16 v[152:155], a[8:11], a[108:111], v[152:155]
    v_cvt_pk_bf16_f32 v68, v136, v137
    v_mfma_f32_16x16x32_bf16 v[156:159], a[12:15], a[108:111], v[156:159]
    s_waitcnt vmcnt(13)
    v_cvt_pk_bf16_f32 v69, v138, v139
    v_mfma_f32_16x16x32_bf16 v[144:147], a[16:19], a[112:115], v[144:147]
    v_cvt_pk_bf16_f32 v70, v140, v141
    v_mfma_f32_16x16x32_bf16 v[148:151], a[20:23], a[112:115], v[148:151]
    v_cvt_pk_bf16_f32 v71, v142, v143
    v_mfma_f32_16x16x32_bf16 v[152:155], a[16:19], a[116:119], v[152:155]
    buffer_store_dwordx4 v[68:71], v30, s[24:27], s60 offen offset:1024 sc1
    v_mfma_f32_16x16x32_bf16 v[156:159], a[20:23], a[116:119], v[156:159]
    v_max3_f32 v192, v192, v193, v194
    v_mfma_f32_16x16x32_bf16 v[144:147], a[24:27], a[120:123], v[144:147]
    v_mfma_f32_16x16x32_bf16 v[148:151], a[28:31], a[120:123], v[148:151]
    v_max3_f32 v195, v195, v196, v197
    v_mfma_f32_16x16x32_bf16 v[152:155], a[24:27], a[124:127], v[152:155]
    v_max3_f32 v192, v192, v198, v199
    v_mfma_f32_16x16x32_bf16 v[156:159], a[28:31], a[124:127], v[156:159]
    s_waitcnt vmcnt(8)
    v_max_f32 v192, v192, v195
    v_mfma_f32_16x16x32_bf16 v[144:147], a[32:35], a[128:131], v[144:147]
    v_max3_f32 v200, v200, v201, v202
    v_mfma_f32_16x16x32_bf16 v[148:151], a[36:39], a[128:131], v[148:151]
    v_max3_f32 v203, v203, v204, v205
    v_mfma_f32_16x16x32_bf16 v[152:155], a[32:35], a[132:135], v[152:155]
    v_mfma_f32_16x16x32_bf16 v[156:159], a[36:39], a[132:135], v[156:159]
    v_max3_f32 v200, v200, v206, v207
    v_mfma_f32_16x16x32_bf16 v[144:147], a[40:43], a[136:139], v[144:147]
    v_max_f32 v200, v200, v203
    v_mfma_f32_16x16x32_bf16 v[148:151], a[44:47], a[136:139], v[148:151]
    v_mfma_f32_16x16x32_bf16 v[152:155], a[40:43], a[140:143], v[152:155]
    v_permlane32_swap_b32 v192, v200
    v_mfma_f32_16x16x32_bf16 v[156:159], a[44:47], a[140:143], v[156:159]
    s_waitcnt vmcnt(4)
    v_mfma_f32_16x16x32_bf16 v[144:147], a[48:51], a[144:147], v[144:147]
    v_max_f32 v192, v192, v200
    v_mfma_f32_16x16x32_bf16 v[148:151], a[52:55], a[144:147], v[148:151]
    v_mov_b32 v193, v192
    v_mfma_f32_16x16x32_bf16 v[152:155], a[48:51], a[148:151], v[152:155]
    v_mfma_f32_16x16x32_bf16 v[156:159], a[52:55], a[148:151], v[156:159]
    v_permlane16_swap_b32 v192, v193
    v_mfma_f32_16x16x32_bf16 v[144:147], a[56:59], a[152:155], v[144:147]
    v_mfma_f32_16x16x32_bf16 v[148:151], a[60:63], a[152:155], v[148:151]
    v_max_f32 v192, v192, v193
    v_mfma_f32_16x16x32_bf16 v[152:155], a[56:59], a[156:159], v[152:155]
    v_sub_f32 v192, 0, v192
    v_mfma_f32_16x16x32_bf16 v[156:159], a[60:63], a[156:159], v[156:159]
    buffer_store_dword v192, v31, s[24:27], s61 offen sc1
    s_nop 1
    v_cvt_pk_bf16_f32 v72, v144, v145
    v_cvt_pk_bf16_f32 v73, v146, v147
    v_cvt_pk_bf16_f32 v74, v148, v149
    v_cvt_pk_bf16_f32 v75, v150, v151
    buffer_store_dwordx4 v[72:75], v30, s[24:27], s60 offen offset:2048 sc1
    v_cvt_pk_bf16_f32 v76, v152, v153
    v_cvt_pk_bf16_f32 v77, v154, v155
    v_cvt_pk_bf16_f32 v78, v156, v157
    v_cvt_pk_bf16_f32 v79, v158, v159
    buffer_store_dwordx4 v[76:79], v30, s[24:27], s60 offen offset:3072 sc1
    s_cmp_eq_u32 s68, 0
    s_cbranch_scc1 standalone__conformer_family_zipformer__speech_kernel_x0
    v_accvgpr_write_b32 a240, v216
    v_accvgpr_write_b32 a241, v217
    v_accvgpr_write_b32 a242, v218
    v_accvgpr_write_b32 a243, v219
    v_accvgpr_write_b32 a244, v220
    v_accvgpr_write_b32 a245, v221
    v_accvgpr_write_b32 a246, v222
    v_accvgpr_write_b32 a247, v223
    v_accvgpr_write_b32 a232, v224
    v_accvgpr_write_b32 a233, v225
    v_accvgpr_write_b32 a234, v226
    v_accvgpr_write_b32 a235, v227
    v_accvgpr_write_b32 a236, v228
    v_accvgpr_write_b32 a237, v229
    v_accvgpr_write_b32 a238, v230
    v_accvgpr_write_b32 a239, v231
    s_branch standalone__conformer_family_zipformer__speech_kernel_x1
standalone__conformer_family_zipformer__speech_kernel_x0:
    v_accvgpr_write_b32 a232, v216
    v_accvgpr_write_b32 a233, v217
    v_accvgpr_write_b32 a234, v218
    v_accvgpr_write_b32 a235, v219
    v_accvgpr_write_b32 a236, v220
    v_accvgpr_write_b32 a237, v221
    v_accvgpr_write_b32 a238, v222
    v_accvgpr_write_b32 a239, v223
    v_accvgpr_write_b32 a240, v224
    v_accvgpr_write_b32 a241, v225
    v_accvgpr_write_b32 a242, v226
    v_accvgpr_write_b32 a243, v227
    v_accvgpr_write_b32 a244, v228
    v_accvgpr_write_b32 a245, v229
    v_accvgpr_write_b32 a246, v230
    v_accvgpr_write_b32 a247, v231
standalone__conformer_family_zipformer__speech_kernel_x1:
standalone__conformer_family_zipformer__speech_kernel_p2:
    s_load_dwordx2 s[4:5], s[0:1], 96
    s_load_dwordx2 s[6:7], s[0:1], 80
    s_load_dwordx2 s[48:49], s[0:1], 88
    v_lshlrev_b32 v2, 4, v1
    v_and_b32 v3, 15, v1
    v_lshlrev_b32 v3, 3, v3
    s_and_b32 s12, s2, 7
    s_lshr_b32 s13, s2, 3
    s_add_u32 s14, s3, 0
    s_and_b32 s14, s14, 3
    s_lshl_b32 s14, s14, 1
    s_lshl_b32 s15, s13, 3
    s_add_u32 s14, s14, s15
    s_min_u32 s16, s14, 248
    s_mov_b32 s33, s14
    s_add_u32 s14, s3, 1
    s_and_b32 s14, s14, 3
    s_lshl_b32 s14, s14, 1
    s_lshl_b32 s15, s13, 3
    s_add_u32 s14, s14, s15
    s_min_u32 s17, s14, 248
    s_add_u32 s14, s3, 2
    s_and_b32 s14, s14, 3
    s_lshl_b32 s14, s14, 1
    s_lshl_b32 s15, s13, 3
    s_add_u32 s14, s14, s15
    s_min_u32 s18, s14, 248
    s_add_u32 s14, s3, 3
    s_and_b32 s14, s14, 3
    s_lshl_b32 s14, s14, 1
    s_lshl_b32 s15, s13, 3
    s_add_u32 s14, s14, s15
    s_min_u32 s19, s14, 248
    s_mul_i32 s14, s12, 250
    s_add_u32 s15, s14, s16
    s_lshl_b32 s20, s15, 11
    s_add_u32 s20, s20, 4194304
    s_lshl_b32 s24, s15, 6
    s_add_u32 s24, s24, 16777216
    s_add_u32 s15, s14, s17
    s_lshl_b32 s21, s15, 11
    s_add_u32 s21, s21, 4194304
    s_lshl_b32 s25, s15, 6
    s_add_u32 s25, s25, 16777216
    s_add_u32 s15, s14, s18
    s_lshl_b32 s22, s15, 11
    s_add_u32 s22, s22, 4194304
    s_lshl_b32 s26, s15, 6
    s_add_u32 s26, s26, 16777216
    s_add_u32 s15, s14, s19
    s_lshl_b32 s23, s15, 11
    s_add_u32 s23, s23, 4194304
    s_lshl_b32 s27, s15, 6
    s_add_u32 s27, s27, 16777216
    s_mul_i32 s14, s12, 125
    s_add_u32 s15, s14, 124
    s_lshl_b32 s28, s15, 13
    s_add_u32 s28, s28, 8388608
    s_mul_i32 s15, s3, 31
    s_add_u32 s14, s14, s15
    s_lshl_b32 s29, s14, 13
    s_add_u32 s29, s29, 8388608
    s_add_u32 s30, s29, 253952
    s_mov_b32 s34, s29
    v_add_u32 v13, 4096, v2
    s_lshl_b32 s14, s3, 13
    v_lshlrev_b32 v14, 7, v1
    v_add_u32 v14, s14, v14
    s_mul_i32 s38, s13, 49152
    s_add_u32 s38, s38, 23068672
    s_mul_i32 s14, s13, 1280
    s_add_u32 s14, s14, 25116672
    s_sub_u32 s14, s14, s38
    v_min_u32 v15, 17536, v14
    v_add_u32 v4, s14, v15
    v_cmp_gt_u32 vcc, 16384, v14
    s_nop 1
    v_cndmask_b32 v15, v4, v15, vcc
    s_add_u32 s39, s38, 32768
    v_mov_b32 v183, 0
    s_and_b32 s67, s2, 7
    s_lshl_b32 s67, s67, 4
    s_lshr_b32 s65, s2, 4
    s_add_u32 s67, s67, s65
    s_bfe_u32 s65, s2, 0x10003
    s_lshl_b32 s66, s67, 1
    s_add_u32 s66, s66, s65
    s_min_u32 s66, s66, 249
    s_cmp_ge_u32 s66, 125
    s_cselect_b32 s50, 125, 0
    s_sub_u32 s50, s66, s50
    s_lshl_b32 s51, s66, 1
    s_add_u32 s57, s51, s65
    s_xor_b32 s58, s57, 1
    s_mul_i32 s51, s65, 124
    s_cmp_eq_u32 s50, s51
    s_cselect_b32 s60, 0, -1
    s_lshl_b32 s59, s65, 1
    s_sub_u32 s59, s59, 1
    s_and_b32 s59, s59, s60
    s_add_u32 s56, s57, s59
    s_min_u32 s56, s56, 499
    s_sub_u32 s51, 124, s51
    s_cmp_eq_u32 s50, s51
    s_cselect_b32 s61, 0, -1
    s_lshl_b32 s51, s3, 11
    s_lshl_b32 s56, s56, 13
    s_add_u32 s56, s56, s51
    s_add_u32 s90, s56, 0
    s_add_u32 s56, s56, 17825792
    s_lshl_b32 s57, s57, 13
    s_add_u32 s57, s57, s51
    s_add_u32 s91, s57, 0
    s_add_u32 s57, s57, 17825792
    s_lshl_b32 s58, s58, 13
    s_add_u32 s58, s58, s51
    s_add_u32 s92, s58, 0
    s_add_u32 s58, s58, 17825792
    s_cmp_ge_u32 s67, 125
    s_cselect_b32 s91, 0x7fff0000, s91
    s_lshl_b32 s93, s3, 15
    s_add_u32 s93, s93, 23089152
    s_waitcnt lgkmcnt(0)
    s_mov_b32 s8, s4
    s_and_b32 s9, s5, 0xffff
    s_mov_b32 s10, 0x10000000
    s_mov_b32 s11, 0x20000
    s_mov_b32 s31, s34
    s_mov_b32 s44, s48
    s_and_b32 s45, s49, 0xffff
    s_mov_b32 s46, 0x100
    s_mov_b32 s47, 0x20000
    v_lshlrev_b32 v4, 2, v1
    buffer_load_dword v250, v4, s[44:47], 0 offen sc1
    v_accvgpr_write_b32 a0, 0
    v_accvgpr_write_b32 a1, 0
    v_accvgpr_write_b32 a2, 0
    v_accvgpr_write_b32 a3, 0
    v_accvgpr_write_b32 a4, 0
    v_accvgpr_write_b32 a5, 0
    v_accvgpr_write_b32 a6, 0
    v_accvgpr_write_b32 a7, 0
    v_accvgpr_write_b32 a8, 0
    v_accvgpr_write_b32 a9, 0
    v_accvgpr_write_b32 a10, 0
    v_accvgpr_write_b32 a11, 0
    v_accvgpr_write_b32 a12, 0
    v_accvgpr_write_b32 a13, 0
    v_accvgpr_write_b32 a14, 0
    v_accvgpr_write_b32 a15, 0
    v_accvgpr_write_b32 a16, 0
    v_accvgpr_write_b32 a17, 0
    v_accvgpr_write_b32 a18, 0
    v_accvgpr_write_b32 a19, 0
    v_accvgpr_write_b32 a20, 0
    v_accvgpr_write_b32 a21, 0
    v_accvgpr_write_b32 a22, 0
    v_accvgpr_write_b32 a23, 0
    v_accvgpr_write_b32 a24, 0
    v_accvgpr_write_b32 a25, 0
    v_accvgpr_write_b32 a26, 0
    v_accvgpr_write_b32 a27, 0
    v_accvgpr_write_b32 a28, 0
    v_accvgpr_write_b32 a29, 0
    v_accvgpr_write_b32 a30, 0
    v_accvgpr_write_b32 a31, 0
    v_accvgpr_write_b32 a32, 0
    v_accvgpr_write_b32 a33, 0
    v_accvgpr_write_b32 a34, 0
    v_accvgpr_write_b32 a35, 0
    v_accvgpr_write_b32 a36, 0
    v_accvgpr_write_b32 a37, 0
    v_accvgpr_write_b32 a38, 0
    v_accvgpr_write_b32 a39, 0
    v_accvgpr_write_b32 a40, 0
    v_accvgpr_write_b32 a41, 0
    v_accvgpr_write_b32 a42, 0
    v_accvgpr_write_b32 a43, 0
    v_accvgpr_write_b32 a44, 0
    v_accvgpr_write_b32 a45, 0
    v_accvgpr_write_b32 a46, 0
    v_accvgpr_write_b32 a47, 0
    v_accvgpr_write_b32 a48, 0
    v_accvgpr_write_b32 a49, 0
    v_accvgpr_write_b32 a50, 0
    v_accvgpr_write_b32 a51, 0
    v_accvgpr_write_b32 a52, 0
    v_accvgpr_write_b32 a53, 0
    v_accvgpr_write_b32 a54, 0
    v_accvgpr_write_b32 a55, 0
    v_accvgpr_write_b32 a56, 0
    v_accvgpr_write_b32 a57, 0
    v_accvgpr_write_b32 a58, 0
    v_accvgpr_write_b32 a59, 0
    v_accvgpr_write_b32 a60, 0
    v_accvgpr_write_b32 a61, 0
    v_accvgpr_write_b32 a62, 0
    v_accvgpr_write_b32 a63, 0
    v_accvgpr_write_b32 a64, 0
    v_accvgpr_write_b32 a65, 0
    v_accvgpr_write_b32 a66, 0
    v_accvgpr_write_b32 a67, 0
    v_accvgpr_write_b32 a68, 0
    v_accvgpr_write_b32 a69, 0
    v_accvgpr_write_b32 a70, 0
    v_accvgpr_write_b32 a71, 0
    v_accvgpr_write_b32 a72, 0
    v_accvgpr_write_b32 a73, 0
    v_accvgpr_write_b32 a74, 0
    v_accvgpr_write_b32 a75, 0
    v_accvgpr_write_b32 a76, 0
    v_accvgpr_write_b32 a77, 0
    v_accvgpr_write_b32 a78, 0
    v_accvgpr_write_b32 a79, 0
    v_accvgpr_write_b32 a80, 0
    v_accvgpr_write_b32 a81, 0
    v_accvgpr_write_b32 a82, 0
    v_accvgpr_write_b32 a83, 0
    v_accvgpr_write_b32 a84, 0
    v_accvgpr_write_b32 a85, 0
    v_accvgpr_write_b32 a86, 0
    v_accvgpr_write_b32 a87, 0
    v_accvgpr_write_b32 a88, 0
    v_accvgpr_write_b32 a89, 0
    v_accvgpr_write_b32 a90, 0
    v_accvgpr_write_b32 a91, 0
    v_accvgpr_write_b32 a92, 0
    v_accvgpr_write_b32 a93, 0
    v_accvgpr_write_b32 a94, 0
    v_accvgpr_write_b32 a95, 0
    v_accvgpr_write_b32 a96, 0
    v_accvgpr_write_b32 a97, 0
    v_accvgpr_write_b32 a98, 0
    v_accvgpr_write_b32 a99, 0
    v_accvgpr_write_b32 a100, 0
    v_accvgpr_write_b32 a101, 0
    v_accvgpr_write_b32 a102, 0
    v_accvgpr_write_b32 a103, 0
    v_accvgpr_write_b32 a104, 0
    v_accvgpr_write_b32 a105, 0
    v_accvgpr_write_b32 a106, 0
    v_accvgpr_write_b32 a107, 0
    v_accvgpr_write_b32 a108, 0
    v_accvgpr_write_b32 a109, 0
    v_accvgpr_write_b32 a110, 0
    v_accvgpr_write_b32 a111, 0
    v_accvgpr_write_b32 a112, 0
    v_accvgpr_write_b32 a113, 0
    v_accvgpr_write_b32 a114, 0
    v_accvgpr_write_b32 a115, 0
    v_accvgpr_write_b32 a116, 0
    v_accvgpr_write_b32 a117, 0
    v_accvgpr_write_b32 a118, 0
    v_accvgpr_write_b32 a119, 0
    v_accvgpr_write_b32 a120, 0
    v_accvgpr_write_b32 a121, 0
    v_accvgpr_write_b32 a122, 0
    v_accvgpr_write_b32 a123, 0
    v_accvgpr_write_b32 a124, 0
    v_accvgpr_write_b32 a125, 0
    v_accvgpr_write_b32 a126, 0
    v_accvgpr_write_b32 a127, 0
    v_accvgpr_write_b32 a192, 0
    v_accvgpr_write_b32 a193, 0
    v_accvgpr_write_b32 a194, 0
    v_accvgpr_write_b32 a195, 0
    v_accvgpr_write_b32 a196, 0
    v_accvgpr_write_b32 a197, 0
    v_accvgpr_write_b32 a198, 0
    v_accvgpr_write_b32 a199, 0
    v_accvgpr_write_b32 a200, 0
    v_accvgpr_write_b32 a201, 0
    v_accvgpr_write_b32 a202, 0
    v_accvgpr_write_b32 a203, 0
    v_accvgpr_write_b32 a204, 0
    v_accvgpr_write_b32 a205, 0
    v_accvgpr_write_b32 a206, 0
    v_accvgpr_write_b32 a207, 0
    v_lshrrev_b32 v4, 1, v1
    v_lshrrev_b32 v5, 5, v1
    v_xor_b32 v4, v4, v5
    v_and_b32 v4, 1, v4
    v_cmp_eq_u32 vcc, 0, v4
    v_mov_b32 v5, 0x3f803f80
    s_nop 0
    v_cndmask_b32 v176, 0, v5, vcc
    v_cndmask_b32 v177, 0, v5, vcc
    v_cndmask_b32 v178, 0, v5, vcc
    v_cndmask_b32 v179, 0, v5, vcc
    v_and_b32 v4, 1, v1
    v_cmp_eq_u32 vcc, 0, v4
    v_mov_b32 v5, 0x44444444
    v_mov_b32 v6, 0xeeeeeeee
    v_cndmask_b32 v180, v6, v5, vcc
    s_add_u32 s14, s3, 1
    s_and_b32 s14, s14, 3
    s_mul_i32 s14, s14, 27648
    s_add_u32 s14, s14, 0
    v_add_u32 v7, s14, v2
    s_add_u32 s14, s3, 2
    s_and_b32 s14, s14, 3
    s_mul_i32 s14, s14, 27648
    s_add_u32 s14, s14, 9216
    v_add_u32 v8, s14, v2
    s_add_u32 s14, s3, 3
    s_and_b32 s14, s14, 3
    s_mul_i32 s14, s14, 27648
    s_add_u32 s14, s14, 18432
    v_add_u32 v9, s14, v2
    s_mul_i32 s14, s3, 27648
    v_add_u32 v10, s14, v2
    s_lshl_b32 s14, s3, 2
    s_add_u32 s14, s14, 110592
    v_mov_b32 v11, s14
    v_mov_b32 v12, 110592
    s_mul_i32 s14, s3, 31
    v_add_u32 v5, s14, v1
    v_cmp_gt_u32 vcc, 31, v1
    s_lshl_b32 s14, s13, 2
    s_sub_u32 s14, s14, 32
    v_add_u32 v6, s14, v1
    v_cndmask_b32 v5, v6, v5, vcc
    v_cmp_eq_u32 vcc, 31, v1
    v_mov_b32 v6, 124
    s_nop 0
    v_cndmask_b32 v5, v5, v6, vcc
    v_min_u32 v5, 124, v5
    s_lshl_b32 s14, s12, 7
    s_sub_u32 s14, 988, s14
    v_min_u32 v6, 59, v1
    v_add_u32 v6, s14, v6
    v_cmp_lt_u32 vcc, 35, v1
    s_nop 1
    v_cndmask_b32 v5, v5, v6, vcc
    v_lshlrev_b32 v5, 7, v5
    s_lshl_b32 s15, s12, 14
    s_add_u32 s15, s15, 28311552
    s_waitcnt vmcnt(0)
    v_mov_b32 v6, 1
    buffer_store_dword v6, v183, s[8:11], s87 offen sc1
    s_barrier
    s_mov_b32 s85, 0x40000
    s_mov_b32 s14, 0x80808080
    v_lshlrev_b32 v4, 2, v1
standalone__conformer_family_zipformer__speech_kernel_al:
    v_and_b32 v250, s14, v250
    v_cmp_ne_u32 vcc, s14, v250
    s_nop 0
    s_cmp_eq_u64 vcc, 0
    s_cbranch_scc1 standalone__conformer_family_zipformer__speech_kernel_kw0
    buffer_load_dword v250, v4, s[44:47], 0 offen sc1
    s_waitcnt vmcnt(0)
    s_sub_u32 s85, s85, 1
    s_cbranch_scc0 standalone__conformer_family_zipformer__speech_kernel_al
standalone__conformer_family_zipformer__speech_kernel_kw0:
    s_mov_b32 s85, 0x40000
standalone__conformer_family_zipformer__speech_kernel_kw:
    buffer_load_dword v6, v5, s[8:11], s15 offen sc1
    s_waitcnt vmcnt(0)
    s_sub_u32 s85, s85, 1
    s_cbranch_scc1 standalone__conformer_family_zipformer__speech_kernel_kwx
    v_cmp_eq_u32 vcc, 0, v6
    s_nop 0
    s_cmp_eq_u64 vcc, 0
    s_cbranch_scc1 standalone__conformer_family_zipformer__speech_kernel_kwx
    s_mov_b64 exec, vcc
    s_sleep 4
    s_branch standalone__conformer_family_zipformer__speech_kernel_kw
standalone__conformer_family_zipformer__speech_kernel_kwx:
    s_mov_b64 exec, -1
    buffer_load_dwordx2 v[184:185], v3, s[8:11], s24 offen
    buffer_load_dwordx4 a[128:131], v2, s[8:11], s20 offen offset:0
    buffer_load_dwordx4 a[132:135], v2, s[8:11], s20 offen offset:1024
    buffer_load_dwordx4 a[136:139], v2, s[8:11], s20 offen offset:2048
    buffer_load_dwordx4 a[140:143], v2, s[8:11], s20 offen offset:3072
    buffer_load_dwordx4 v[16:19], v2, s[8:11], s31 offen offset:0
    buffer_load_dwordx4 v[20:23], v2, s[8:11], s31 offen offset:1024
    buffer_load_dwordx4 v[24:27], v2, s[8:11], s31 offen offset:2048
    buffer_load_dwordx4 v[28:31], v2, s[8:11], s31 offen offset:3072
    buffer_load_dwordx2 v[186:187], v3, s[8:11], s25 offen
    buffer_load_dwordx4 a[144:147], v2, s[8:11], s21 offen offset:0
    buffer_load_dwordx4 a[148:151], v2, s[8:11], s21 offen offset:1024
    buffer_load_dwordx4 a[152:155], v2, s[8:11], s21 offen offset:2048
    buffer_load_dwordx4 a[156:159], v2, s[8:11], s21 offen offset:3072
    buffer_load_dwordx2 v[188:189], v3, s[8:11], s26 offen
    buffer_load_dwordx2 v[190:191], v3, s[8:11], s27 offen
    buffer_load_dwordx4 v[32:35], v13, s[8:11], s31 offen offset:0
    buffer_load_dwordx4 v[36:39], v13, s[8:11], s31 offen offset:1024
    buffer_load_dwordx4 v[40:43], v13, s[8:11], s31 offen offset:2048
    buffer_load_dwordx4 v[44:47], v13, s[8:11], s31 offen offset:3072
    s_waitcnt vmcnt(19)
    v_mov_b32 v80, v184
    v_mov_b32 v81, v184
    v_mov_b32 v82, v184
    v_mov_b32 v83, v184
    v_mov_b32 v84, v185
    v_mov_b32 v85, v185
    v_mov_b32 v86, v185
    v_mov_b32 v87, v185
    s_mov_b32 s37, 0
standalone__conformer_family_zipformer__speech_kernel_main:
    s_cmp_eq_u32 s13, 31
    s_cbranch_scc1 standalone__conformer_family_zipformer__speech_kernel_short
    s_mul_i32 s40, s3, 10240
    s_waitcnt vmcnt(11)
    v_mfma_f32_16x16x32_bf16 v[112:115], v[16:19], a[128:131], v[80:83]
    s_waitcnt vmcnt(10)
    v_mov_b32 v88, v186
    v_mov_b32 v89, v186
    v_mov_b32 v90, v186
    v_mov_b32 v91, v186
    v_mfma_f32_16x16x32_bf16 v[120:123], v[16:19], a[136:139], v[84:87]
    buffer_load_dwordx4 a[160:163], v2, s[8:11], s22 offen offset:0
    v_mov_b32 v92, v187
    v_mov_b32 v93, v187
    v_mfma_f32_16x16x32_bf16 v[116:119], v[24:27], a[128:131], v[80:83]
    s_waitcnt vmcnt(6)
    v_mov_b32 v94, v187
    v_mov_b32 v95, v187
    v_mov_b32 v96, v188
    v_mov_b32 v97, v188
    v_mfma_f32_16x16x32_bf16 v[124:127], v[24:27], a[136:139], v[84:87]
    buffer_load_dwordx4 a[164:167], v2, s[8:11], s22 offen offset:1024
    v_mov_b32 v98, v188
    v_mov_b32 v99, v188
    v_mov_b32 v100, v189
    v_mfma_f32_16x16x32_bf16 v[112:115], v[20:23], a[132:135], v[112:115]
    buffer_load_dwordx4 a[168:171], v2, s[8:11], s22 offen offset:2048
    v_mov_b32 v101, v189
    v_mov_b32 v102, v189
    v_mfma_f32_16x16x32_bf16 v[120:123], v[20:23], a[140:143], v[120:123]
    s_waitcnt vmcnt(7)
    v_mov_b32 v103, v189
    v_mov_b32 v104, v190
    v_mov_b32 v105, v190
    v_mov_b32 v106, v190
    v_mfma_f32_16x16x32_bf16 v[116:119], v[28:31], a[132:135], v[116:119]
    buffer_load_dwordx4 a[172:175], v2, s[8:11], s22 offen offset:3072
    v_mov_b32 v107, v190
    v_mov_b32 v108, v191
    v_mfma_f32_16x16x32_bf16 v[124:127], v[28:31], a[140:143], v[124:127]
    s_add_u32 s31, s31, 8192
    v_mov_b32 v109, v191
    v_mov_b32 v110, v191
    v_mov_b32 v111, v191
    v_mfma_f32_16x16x32_bf16 v[128:131], v[16:19], a[144:147], v[88:91]
    v_exp_f32 v144, v112
    v_exp_f32 v145, v113
    v_mfma_f32_16x16x32_bf16 v[136:139], v[16:19], a[152:155], v[92:95]
    buffer_load_dwordx4 a[176:179], v2, s[8:11], s23 offen offset:0
    buffer_load_dwordx4 a[180:183], v2, s[8:11], s23 offen offset:1024
    v_exp_f32 v146, v114
    v_exp_f32 v147, v115
    v_cvt_pk_bf16_f32 v160, v144, v145
    v_mfma_f32_16x16x32_bf16 v[132:135], v[24:27], a[144:147], v[88:91]
    v_exp_f32 v148, v116
    v_exp_f32 v149, v117
    v_cvt_pk_bf16_f32 v161, v146, v147
    v_mfma_f32_16x16x32_bf16 v[140:143], v[24:27], a[152:155], v[92:95]
    buffer_load_dwordx4 a[184:187], v2, s[8:11], s23 offen offset:2048
    buffer_load_dwordx4 a[188:191], v2, s[8:11], s23 offen offset:3072
    v_exp_f32 v150, v118
    v_exp_f32 v151, v119
    v_cvt_pk_bf16_f32 v162, v148, v149
    v_mfma_f32_16x16x32_bf16 v[128:131], v[20:23], a[148:151], v[128:131]
    v_exp_f32 v152, v120
    v_exp_f32 v153, v121
    v_cvt_pk_bf16_f32 v163, v150, v151
    v_mfma_f32_16x16x32_bf16 v[136:139], v[20:23], a[156:159], v[136:139]
    buffer_load_dwordx4 v[48:51], v2, s[8:11], s31 offen offset:0
    buffer_load_dwordx4 v[52:55], v2, s[8:11], s31 offen offset:1024
    v_exp_f32 v154, v122
    v_exp_f32 v155, v123
    v_cvt_pk_bf16_f32 v164, v152, v153
    v_mfma_f32_16x16x32_bf16 v[132:135], v[28:31], a[148:151], v[132:135]
    v_exp_f32 v156, v124
    v_exp_f32 v157, v125
    v_cvt_pk_bf16_f32 v165, v154, v155
    v_mfma_f32_16x16x32_bf16 v[140:143], v[28:31], a[156:159], v[140:143]
    buffer_load_dwordx4 v[56:59], v2, s[8:11], s31 offen offset:2048
    buffer_load_dwordx4 v[60:63], v2, s[8:11], s31 offen offset:3072
    v_exp_f32 v158, v126
    v_exp_f32 v159, v127
    v_cvt_pk_bf16_f32 v166, v156, v157
    v_cvt_pk_bf16_f32 v167, v158, v159
    s_waitcnt vmcnt(11)
    v_mfma_f32_16x16x32_bf16 v[112:115], v[16:19], a[160:163], v[96:99]
    s_waitcnt vmcnt(9)
    v_exp_f32 v144, v128
    v_mfma_f32_16x16x32_bf16 v[120:123], v[16:19], a[168:171], v[100:103]
    buffer_load_dwordx4 v[64:67], v13, s[8:11], s31 offen offset:0
    buffer_load_dwordx4 v[68:71], v13, s[8:11], s31 offen offset:1024
    v_exp_f32 v145, v129
    v_mfma_f32_16x16x32_bf16 v[116:119], v[24:27], a[160:163], v[96:99]
    v_exp_f32 v146, v130
    v_mfma_f32_16x16x32_bf16 v[124:127], v[24:27], a[168:171], v[100:103]
    buffer_load_dwordx4 v[72:75], v13, s[8:11], s31 offen offset:2048
    buffer_load_dwordx4 v[76:79], v13, s[8:11], s31 offen offset:3072
    v_exp_f32 v147, v131
    v_cvt_pk_bf16_f32 v168, v144, v145
    v_mfma_f32_16x16x32_bf16 v[112:115], v[20:23], a[164:167], v[112:115]
    s_waitcnt vmcnt(12)
    v_exp_f32 v148, v132
    v_mfma_f32_16x16x32_bf16 v[120:123], v[20:23], a[172:175], v[120:123]
    s_add_u32 s31, s31, 8192
    s_add_u32 m0, s40, 122880
    v_exp_f32 v149, v133
    v_cvt_pk_bf16_f32 v169, v146, v147
    v_mfma_f32_16x16x32_bf16 v[116:119], v[28:31], a[164:167], v[116:119]
    v_exp_f32 v150, v134
    v_mfma_f32_16x16x32_bf16 v[124:127], v[28:31], a[172:175], v[124:127]
    s_add_u32 s41, s40, 25165824
    buffer_load_dwordx4 v2, s[8:11], s41 offen offset:0 lds
    v_exp_f32 v151, v135
    v_cvt_pk_bf16_f32 v170, v148, v149
    v_mfma_f32_16x16x32_bf16 a[0:3], v[32:35], v[160:163], a[0:3]
    v_exp_f32 v152, v136
    v_mfma_f32_16x16x32_bf16 a[4:7], v[32:35], v[164:167], a[4:7]
    buffer_load_dwordx4 v2, s[8:11], s41 offen offset:1024 lds
    buffer_load_dwordx4 v2, s[8:11], s41 offen offset:2048 lds
    v_exp_f32 v153, v137
    v_mfma_f32_16x16x32_bf16 a[8:11], v[36:39], v[160:163], a[8:11]
    v_exp_f32 v154, v138
    v_cvt_pk_bf16_f32 v171, v150, v151
    v_mfma_f32_16x16x32_bf16 a[12:15], v[36:39], v[164:167], a[12:15]
    buffer_load_dwordx4 v2, s[8:11], s41 offen offset:3072 lds
    v_exp_f32 v155, v139
    v_mfma_f32_16x16x32_bf16 a[16:19], v[40:43], v[160:163], a[16:19]
    v_exp_f32 v156, v140
    v_mfma_f32_16x16x32_bf16 a[20:23], v[40:43], v[164:167], a[20:23]
    v_exp_f32 v157, v141
    v_cvt_pk_bf16_f32 v172, v152, v153
    v_mfma_f32_16x16x32_bf16 a[24:27], v[44:47], v[160:163], a[24:27]
    v_exp_f32 v158, v142
    v_mfma_f32_16x16x32_bf16 a[28:31], v[44:47], v[164:167], a[28:31]
    v_exp_f32 v159, v143
    v_cvt_pk_bf16_f32 v173, v154, v155
    v_smfmac_f32_16x16x64_bf16 a[192:195], v[176:179], v[160:167], v180
    s_waitcnt vmcnt(15)
    v_cvt_pk_bf16_f32 v174, v156, v157
    v_cvt_pk_bf16_f32 v175, v158, v159
    v_mfma_f32_16x16x32_bf16 v[128:131], v[16:19], a[176:179], v[104:107]
    s_waitcnt vmcnt(13)
    v_exp_f32 v144, v112
    v_mfma_f32_16x16x32_bf16 v[136:139], v[16:19], a[184:187], v[108:111]
    s_add_u32 m0, s40, 126976
    s_add_u32 s41, s40, 25169920
    v_exp_f32 v145, v113
    v_mfma_f32_16x16x32_bf16 v[132:135], v[24:27], a[176:179], v[104:107]
    v_exp_f32 v146, v114
    v_mfma_f32_16x16x32_bf16 v[140:143], v[24:27], a[184:187], v[108:111]
    buffer_load_dwordx4 v2, s[8:11], s41 offen offset:0 lds
    buffer_load_dwordx4 v2, s[8:11], s41 offen offset:1024 lds
    v_exp_f32 v147, v115
    v_cvt_pk_bf16_f32 v160, v144, v145
    v_mfma_f32_16x16x32_bf16 v[128:131], v[20:23], a[180:183], v[128:131]
    s_waitcnt vmcnt(14)
    v_exp_f32 v148, v116
    v_mfma_f32_16x16x32_bf16 v[136:139], v[20:23], a[188:191], v[136:139]
    buffer_load_dwordx4 v2, s[8:11], s41 offen offset:2048 lds
    buffer_load_dwordx4 v2, s[8:11], s41 offen offset:3072 lds
    v_exp_f32 v149, v117
    v_cvt_pk_bf16_f32 v161, v146, v147
    v_mfma_f32_16x16x32_bf16 v[132:135], v[28:31], a[180:183], v[132:135]
    v_exp_f32 v150, v118
    v_mfma_f32_16x16x32_bf16 v[140:143], v[28:31], a[188:191], v[140:143]
    s_add_u32 m0, s40, 131072
    s_add_u32 s41, s40, 25174016
    v_exp_f32 v151, v119
    v_cvt_pk_bf16_f32 v162, v148, v149
    v_mfma_f32_16x16x32_bf16 a[32:35], v[32:35], v[168:171], a[32:35]
    v_exp_f32 v152, v120
    v_mfma_f32_16x16x32_bf16 a[36:39], v[32:35], v[172:175], a[36:39]
    buffer_load_dwordx4 v2, s[8:11], s41 offen offset:0 lds
    buffer_load_dwordx4 v2, s[8:11], s41 offen offset:1024 lds
    v_exp_f32 v153, v121
    v_mfma_f32_16x16x32_bf16 a[40:43], v[36:39], v[168:171], a[40:43]
    v_exp_f32 v154, v122
    v_cvt_pk_bf16_f32 v163, v150, v151
    v_mfma_f32_16x16x32_bf16 a[44:47], v[36:39], v[172:175], a[44:47]
    v_exp_f32 v155, v123
    v_mfma_f32_16x16x32_bf16 a[48:51], v[40:43], v[168:171], a[48:51]
    v_exp_f32 v156, v124
    v_mfma_f32_16x16x32_bf16 a[52:55], v[40:43], v[172:175], a[52:55]
    v_exp_f32 v157, v125
    v_cvt_pk_bf16_f32 v164, v152, v153
    v_mfma_f32_16x16x32_bf16 a[56:59], v[44:47], v[168:171], a[56:59]
    v_exp_f32 v158, v126
    v_mfma_f32_16x16x32_bf16 a[60:63], v[44:47], v[172:175], a[60:63]
    v_exp_f32 v159, v127
    v_cvt_pk_bf16_f32 v165, v154, v155
    v_smfmac_f32_16x16x64_bf16 a[196:199], v[176:179], v[168:175], v180
    s_waitcnt vmcnt(14)
    v_cvt_pk_bf16_f32 v166, v156, v157
    v_cvt_pk_bf16_f32 v167, v158, v159
    s_mov_b32 s32, 13
    .p2align 3
standalone__conformer_family_zipformer__speech_kernel_loop:
    v_mfma_f32_16x16x32_bf16 v[112:115], v[48:51], a[128:131], v[80:83]
    v_exp_f32 v144, v128
    v_mfma_f32_16x16x32_bf16 v[120:123], v[48:51], a[136:139], v[84:87]
    buffer_load_dwordx4 v[16:19], v2, s[8:11], s31 offen offset:0
    v_exp_f32 v145, v129
    v_mfma_f32_16x16x32_bf16 v[116:119], v[56:59], a[128:131], v[80:83]
    v_exp_f32 v146, v130
    v_mfma_f32_16x16x32_bf16 v[124:127], v[56:59], a[136:139], v[84:87]
    buffer_load_dwordx4 v[20:23], v2, s[8:11], s31 offen offset:1024
    v_exp_f32 v147, v131
    v_cvt_pk_bf16_f32 v168, v144, v145
    v_mfma_f32_16x16x32_bf16 v[112:115], v[52:55], a[132:135], v[112:115]
    v_exp_f32 v148, v132
    v_mfma_f32_16x16x32_bf16 v[120:123], v[52:55], a[140:143], v[120:123]
    buffer_load_dwordx4 v[24:27], v2, s[8:11], s31 offen offset:2048
    v_exp_f32 v149, v133
    v_cvt_pk_bf16_f32 v169, v146, v147
    v_mfma_f32_16x16x32_bf16 v[116:119], v[60:63], a[132:135], v[116:119]
    v_exp_f32 v150, v134
    v_mfma_f32_16x16x32_bf16 v[124:127], v[60:63], a[140:143], v[124:127]
    buffer_load_dwordx4 v[28:31], v2, s[8:11], s31 offen offset:3072
    v_exp_f32 v151, v135
    v_cvt_pk_bf16_f32 v170, v148, v149
    v_mfma_f32_16x16x32_bf16 a[64:67], v[32:35], v[160:163], a[64:67]
    v_exp_f32 v152, v136
    v_mfma_f32_16x16x32_bf16 a[68:71], v[32:35], v[164:167], a[68:71]
    v_exp_f32 v153, v137
    v_mfma_f32_16x16x32_bf16 a[72:75], v[36:39], v[160:163], a[72:75]
    v_exp_f32 v154, v138
    v_cvt_pk_bf16_f32 v171, v150, v151
    v_mfma_f32_16x16x32_bf16 a[76:79], v[36:39], v[164:167], a[76:79]
    v_exp_f32 v155, v139
    v_mfma_f32_16x16x32_bf16 a[80:83], v[40:43], v[160:163], a[80:83]
    v_exp_f32 v156, v140
    v_mfma_f32_16x16x32_bf16 a[84:87], v[40:43], v[164:167], a[84:87]
    v_exp_f32 v157, v141
    v_cvt_pk_bf16_f32 v172, v152, v153
    v_mfma_f32_16x16x32_bf16 a[88:91], v[44:47], v[160:163], a[88:91]
    v_exp_f32 v158, v142
    v_mfma_f32_16x16x32_bf16 a[92:95], v[44:47], v[164:167], a[92:95]
    v_exp_f32 v159, v143
    v_cvt_pk_bf16_f32 v173, v154, v155
    v_smfmac_f32_16x16x64_bf16 a[200:203], v[176:179], v[160:167], v180
    v_cvt_pk_bf16_f32 v174, v156, v157
    v_cvt_pk_bf16_f32 v175, v158, v159
    v_mfma_f32_16x16x32_bf16 v[128:131], v[48:51], a[144:147], v[88:91]
    v_exp_f32 v144, v112
    v_mfma_f32_16x16x32_bf16 v[136:139], v[48:51], a[152:155], v[92:95]
    v_exp_f32 v145, v113
    v_mfma_f32_16x16x32_bf16 v[132:135], v[56:59], a[144:147], v[88:91]
    v_exp_f32 v146, v114
    v_mfma_f32_16x16x32_bf16 v[140:143], v[56:59], a[152:155], v[92:95]
    v_exp_f32 v147, v115
    v_cvt_pk_bf16_f32 v160, v144, v145
    v_mfma_f32_16x16x32_bf16 v[128:131], v[52:55], a[148:151], v[128:131]
    v_exp_f32 v148, v116
    v_mfma_f32_16x16x32_bf16 v[136:139], v[52:55], a[156:159], v[136:139]
    v_exp_f32 v149, v117
    v_cvt_pk_bf16_f32 v161, v146, v147
    v_mfma_f32_16x16x32_bf16 v[132:135], v[60:63], a[148:151], v[132:135]
    v_exp_f32 v150, v118
    v_mfma_f32_16x16x32_bf16 v[140:143], v[60:63], a[156:159], v[140:143]
    v_exp_f32 v151, v119
    v_cvt_pk_bf16_f32 v162, v148, v149
    v_mfma_f32_16x16x32_bf16 a[96:99], v[32:35], v[168:171], a[96:99]
    v_exp_f32 v152, v120
    v_mfma_f32_16x16x32_bf16 a[100:103], v[32:35], v[172:175], a[100:103]
    v_exp_f32 v153, v121
    v_mfma_f32_16x16x32_bf16 a[104:107], v[36:39], v[168:171], a[104:107]
    v_exp_f32 v154, v122
    v_cvt_pk_bf16_f32 v163, v150, v151
    v_mfma_f32_16x16x32_bf16 a[108:111], v[36:39], v[172:175], a[108:111]
    v_exp_f32 v155, v123
    v_mfma_f32_16x16x32_bf16 a[112:115], v[40:43], v[168:171], a[112:115]
    v_exp_f32 v156, v124
    v_mfma_f32_16x16x32_bf16 a[116:119], v[40:43], v[172:175], a[116:119]
    v_exp_f32 v157, v125
    v_cvt_pk_bf16_f32 v164, v152, v153
    v_mfma_f32_16x16x32_bf16 a[120:123], v[44:47], v[168:171], a[120:123]
    v_exp_f32 v158, v126
    v_mfma_f32_16x16x32_bf16 a[124:127], v[44:47], v[172:175], a[124:127]
    v_exp_f32 v159, v127
    v_cvt_pk_bf16_f32 v165, v154, v155
    v_smfmac_f32_16x16x64_bf16 a[204:207], v[176:179], v[168:175], v180
    s_waitcnt vmcnt(4)
    v_cvt_pk_bf16_f32 v166, v156, v157
    v_cvt_pk_bf16_f32 v167, v158, v159
    v_mfma_f32_16x16x32_bf16 v[112:115], v[48:51], a[160:163], v[96:99]
    v_exp_f32 v144, v128
    v_mfma_f32_16x16x32_bf16 v[120:123], v[48:51], a[168:171], v[100:103]
    buffer_load_dwordx4 v[32:35], v13, s[8:11], s31 offen offset:0
    v_exp_f32 v145, v129
    v_mfma_f32_16x16x32_bf16 v[116:119], v[56:59], a[160:163], v[96:99]
    v_exp_f32 v146, v130
    v_mfma_f32_16x16x32_bf16 v[124:127], v[56:59], a[168:171], v[100:103]
    buffer_load_dwordx4 v[36:39], v13, s[8:11], s31 offen offset:1024
    v_exp_f32 v147, v131
    v_cvt_pk_bf16_f32 v168, v144, v145
    v_mfma_f32_16x16x32_bf16 v[112:115], v[52:55], a[164:167], v[112:115]
    v_exp_f32 v148, v132
    v_mfma_f32_16x16x32_bf16 v[120:123], v[52:55], a[172:175], v[120:123]
    buffer_load_dwordx4 v[40:43], v13, s[8:11], s31 offen offset:2048
    v_exp_f32 v149, v133
    v_cvt_pk_bf16_f32 v169, v146, v147
    v_mfma_f32_16x16x32_bf16 v[116:119], v[60:63], a[164:167], v[116:119]
    v_exp_f32 v150, v134
    v_mfma_f32_16x16x32_bf16 v[124:127], v[60:63], a[172:175], v[124:127]
    buffer_load_dwordx4 v[44:47], v13, s[8:11], s31 offen offset:3072
    v_exp_f32 v151, v135
    v_cvt_pk_bf16_f32 v170, v148, v149
    v_mfma_f32_16x16x32_bf16 a[0:3], v[64:67], v[160:163], a[0:3]
    v_exp_f32 v152, v136
    v_mfma_f32_16x16x32_bf16 a[4:7], v[64:67], v[164:167], a[4:7]
    s_add_u32 s31, s31, 8192
    v_exp_f32 v153, v137
    v_mfma_f32_16x16x32_bf16 a[8:11], v[68:71], v[160:163], a[8:11]
    v_exp_f32 v154, v138
    v_cvt_pk_bf16_f32 v171, v150, v151
    v_mfma_f32_16x16x32_bf16 a[12:15], v[68:71], v[164:167], a[12:15]
    v_exp_f32 v155, v139
    v_mfma_f32_16x16x32_bf16 a[16:19], v[72:75], v[160:163], a[16:19]
    v_exp_f32 v156, v140
    v_mfma_f32_16x16x32_bf16 a[20:23], v[72:75], v[164:167], a[20:23]
    v_exp_f32 v157, v141
    v_cvt_pk_bf16_f32 v172, v152, v153
    v_mfma_f32_16x16x32_bf16 a[24:27], v[76:79], v[160:163], a[24:27]
    v_exp_f32 v158, v142
    v_mfma_f32_16x16x32_bf16 a[28:31], v[76:79], v[164:167], a[28:31]
    v_exp_f32 v159, v143
    v_cvt_pk_bf16_f32 v173, v154, v155
    v_smfmac_f32_16x16x64_bf16 a[192:195], v[176:179], v[160:167], v180
    v_cvt_pk_bf16_f32 v174, v156, v157
    v_cvt_pk_bf16_f32 v175, v158, v159
    v_mfma_f32_16x16x32_bf16 v[128:131], v[48:51], a[176:179], v[104:107]
    v_exp_f32 v144, v112
    v_mfma_f32_16x16x32_bf16 v[136:139], v[48:51], a[184:187], v[108:111]
    v_exp_f32 v145, v113
    v_mfma_f32_16x16x32_bf16 v[132:135], v[56:59], a[176:179], v[104:107]
    v_exp_f32 v146, v114
    v_mfma_f32_16x16x32_bf16 v[140:143], v[56:59], a[184:187], v[108:111]
    v_exp_f32 v147, v115
    v_cvt_pk_bf16_f32 v160, v144, v145
    v_mfma_f32_16x16x32_bf16 v[128:131], v[52:55], a[180:183], v[128:131]
    v_exp_f32 v148, v116
    v_mfma_f32_16x16x32_bf16 v[136:139], v[52:55], a[188:191], v[136:139]
    v_exp_f32 v149, v117
    v_cvt_pk_bf16_f32 v161, v146, v147
    v_mfma_f32_16x16x32_bf16 v[132:135], v[60:63], a[180:183], v[132:135]
    v_exp_f32 v150, v118
    v_mfma_f32_16x16x32_bf16 v[140:143], v[60:63], a[188:191], v[140:143]
    v_exp_f32 v151, v119
    v_cvt_pk_bf16_f32 v162, v148, v149
    v_mfma_f32_16x16x32_bf16 a[32:35], v[64:67], v[168:171], a[32:35]
    v_exp_f32 v152, v120
    v_mfma_f32_16x16x32_bf16 a[36:39], v[64:67], v[172:175], a[36:39]
    v_exp_f32 v153, v121
    v_mfma_f32_16x16x32_bf16 a[40:43], v[68:71], v[168:171], a[40:43]
    v_exp_f32 v154, v122
    v_cvt_pk_bf16_f32 v163, v150, v151
    v_mfma_f32_16x16x32_bf16 a[44:47], v[68:71], v[172:175], a[44:47]
    v_exp_f32 v155, v123
    v_mfma_f32_16x16x32_bf16 a[48:51], v[72:75], v[168:171], a[48:51]
    v_exp_f32 v156, v124
    v_mfma_f32_16x16x32_bf16 a[52:55], v[72:75], v[172:175], a[52:55]
    v_exp_f32 v157, v125
    v_cvt_pk_bf16_f32 v164, v152, v153
    v_mfma_f32_16x16x32_bf16 a[56:59], v[76:79], v[168:171], a[56:59]
    v_exp_f32 v158, v126
    v_mfma_f32_16x16x32_bf16 a[60:63], v[76:79], v[172:175], a[60:63]
    v_exp_f32 v159, v127
    v_cvt_pk_bf16_f32 v165, v154, v155
    v_smfmac_f32_16x16x64_bf16 a[196:199], v[176:179], v[168:175], v180
    s_waitcnt vmcnt(4)
    v_cvt_pk_bf16_f32 v166, v156, v157
    v_cvt_pk_bf16_f32 v167, v158, v159
    v_mfma_f32_16x16x32_bf16 v[112:115], v[16:19], a[128:131], v[80:83]
    v_exp_f32 v144, v128
    v_mfma_f32_16x16x32_bf16 v[120:123], v[16:19], a[136:139], v[84:87]
    buffer_load_dwordx4 v[48:51], v2, s[8:11], s31 offen offset:0
    v_exp_f32 v145, v129
    v_mfma_f32_16x16x32_bf16 v[116:119], v[24:27], a[128:131], v[80:83]
    v_exp_f32 v146, v130
    v_mfma_f32_16x16x32_bf16 v[124:127], v[24:27], a[136:139], v[84:87]
    buffer_load_dwordx4 v[52:55], v2, s[8:11], s31 offen offset:1024
    v_exp_f32 v147, v131
    v_cvt_pk_bf16_f32 v168, v144, v145
    v_mfma_f32_16x16x32_bf16 v[112:115], v[20:23], a[132:135], v[112:115]
    v_exp_f32 v148, v132
    v_mfma_f32_16x16x32_bf16 v[120:123], v[20:23], a[140:143], v[120:123]
    buffer_load_dwordx4 v[56:59], v2, s[8:11], s31 offen offset:2048
    v_exp_f32 v149, v133
    v_cvt_pk_bf16_f32 v169, v146, v147
    v_mfma_f32_16x16x32_bf16 v[116:119], v[28:31], a[132:135], v[116:119]
    v_exp_f32 v150, v134
    v_mfma_f32_16x16x32_bf16 v[124:127], v[28:31], a[140:143], v[124:127]
    buffer_load_dwordx4 v[60:63], v2, s[8:11], s31 offen offset:3072
    v_exp_f32 v151, v135
    v_cvt_pk_bf16_f32 v170, v148, v149
    v_mfma_f32_16x16x32_bf16 a[64:67], v[64:67], v[160:163], a[64:67]
    v_exp_f32 v152, v136
    v_mfma_f32_16x16x32_bf16 a[68:71], v[64:67], v[164:167], a[68:71]
    v_exp_f32 v153, v137
    v_mfma_f32_16x16x32_bf16 a[72:75], v[68:71], v[160:163], a[72:75]
    v_exp_f32 v154, v138
    v_cvt_pk_bf16_f32 v171, v150, v151
    v_mfma_f32_16x16x32_bf16 a[76:79], v[68:71], v[164:167], a[76:79]
    v_exp_f32 v155, v139
    v_mfma_f32_16x16x32_bf16 a[80:83], v[72:75], v[160:163], a[80:83]
    v_exp_f32 v156, v140
    v_mfma_f32_16x16x32_bf16 a[84:87], v[72:75], v[164:167], a[84:87]
    v_exp_f32 v157, v141
    v_cvt_pk_bf16_f32 v172, v152, v153
    v_mfma_f32_16x16x32_bf16 a[88:91], v[76:79], v[160:163], a[88:91]
    v_exp_f32 v158, v142
    v_mfma_f32_16x16x32_bf16 a[92:95], v[76:79], v[164:167], a[92:95]
    v_exp_f32 v159, v143
    v_cvt_pk_bf16_f32 v173, v154, v155
    v_smfmac_f32_16x16x64_bf16 a[200:203], v[176:179], v[160:167], v180
    v_cvt_pk_bf16_f32 v174, v156, v157
    v_cvt_pk_bf16_f32 v175, v158, v159
    v_mfma_f32_16x16x32_bf16 v[128:131], v[16:19], a[144:147], v[88:91]
    v_exp_f32 v144, v112
    v_mfma_f32_16x16x32_bf16 v[136:139], v[16:19], a[152:155], v[92:95]
    v_exp_f32 v145, v113
    v_mfma_f32_16x16x32_bf16 v[132:135], v[24:27], a[144:147], v[88:91]
    v_exp_f32 v146, v114
    v_mfma_f32_16x16x32_bf16 v[140:143], v[24:27], a[152:155], v[92:95]
    v_exp_f32 v147, v115
    v_cvt_pk_bf16_f32 v160, v144, v145
    v_mfma_f32_16x16x32_bf16 v[128:131], v[20:23], a[148:151], v[128:131]
    v_exp_f32 v148, v116
    v_mfma_f32_16x16x32_bf16 v[136:139], v[20:23], a[156:159], v[136:139]
    v_exp_f32 v149, v117
    v_cvt_pk_bf16_f32 v161, v146, v147
    v_mfma_f32_16x16x32_bf16 v[132:135], v[28:31], a[148:151], v[132:135]
    v_exp_f32 v150, v118
    v_mfma_f32_16x16x32_bf16 v[140:143], v[28:31], a[156:159], v[140:143]
    v_exp_f32 v151, v119
    v_cvt_pk_bf16_f32 v162, v148, v149
    v_mfma_f32_16x16x32_bf16 a[96:99], v[64:67], v[168:171], a[96:99]
    v_exp_f32 v152, v120
    v_mfma_f32_16x16x32_bf16 a[100:103], v[64:67], v[172:175], a[100:103]
    v_exp_f32 v153, v121
    v_mfma_f32_16x16x32_bf16 a[104:107], v[68:71], v[168:171], a[104:107]
    v_exp_f32 v154, v122
    v_cvt_pk_bf16_f32 v163, v150, v151
    v_mfma_f32_16x16x32_bf16 a[108:111], v[68:71], v[172:175], a[108:111]
    v_exp_f32 v155, v123
    v_mfma_f32_16x16x32_bf16 a[112:115], v[72:75], v[168:171], a[112:115]
    v_exp_f32 v156, v124
    v_mfma_f32_16x16x32_bf16 a[116:119], v[72:75], v[172:175], a[116:119]
    v_exp_f32 v157, v125
    v_cvt_pk_bf16_f32 v164, v152, v153
    v_mfma_f32_16x16x32_bf16 a[120:123], v[76:79], v[168:171], a[120:123]
    v_exp_f32 v158, v126
    v_mfma_f32_16x16x32_bf16 a[124:127], v[76:79], v[172:175], a[124:127]
    v_exp_f32 v159, v127
    v_cvt_pk_bf16_f32 v165, v154, v155
    v_smfmac_f32_16x16x64_bf16 a[204:207], v[176:179], v[168:175], v180
    s_waitcnt vmcnt(4)
    v_cvt_pk_bf16_f32 v166, v156, v157
    v_cvt_pk_bf16_f32 v167, v158, v159
    v_mfma_f32_16x16x32_bf16 v[112:115], v[16:19], a[160:163], v[96:99]
    v_exp_f32 v144, v128
    v_mfma_f32_16x16x32_bf16 v[120:123], v[16:19], a[168:171], v[100:103]
    buffer_load_dwordx4 v[64:67], v13, s[8:11], s31 offen offset:0
    v_exp_f32 v145, v129
    v_mfma_f32_16x16x32_bf16 v[116:119], v[24:27], a[160:163], v[96:99]
    v_exp_f32 v146, v130
    v_mfma_f32_16x16x32_bf16 v[124:127], v[24:27], a[168:171], v[100:103]
    buffer_load_dwordx4 v[68:71], v13, s[8:11], s31 offen offset:1024
    v_exp_f32 v147, v131
    v_cvt_pk_bf16_f32 v168, v144, v145
    v_mfma_f32_16x16x32_bf16 v[112:115], v[20:23], a[164:167], v[112:115]
    v_exp_f32 v148, v132
    v_mfma_f32_16x16x32_bf16 v[120:123], v[20:23], a[172:175], v[120:123]
    buffer_load_dwordx4 v[72:75], v13, s[8:11], s31 offen offset:2048
    v_exp_f32 v149, v133
    v_cvt_pk_bf16_f32 v169, v146, v147
    v_mfma_f32_16x16x32_bf16 v[116:119], v[28:31], a[164:167], v[116:119]
    v_exp_f32 v150, v134
    v_mfma_f32_16x16x32_bf16 v[124:127], v[28:31], a[172:175], v[124:127]
    buffer_load_dwordx4 v[76:79], v13, s[8:11], s31 offen offset:3072
    v_exp_f32 v151, v135
    v_cvt_pk_bf16_f32 v170, v148, v149
    v_mfma_f32_16x16x32_bf16 a[0:3], v[32:35], v[160:163], a[0:3]
    v_exp_f32 v152, v136
    v_mfma_f32_16x16x32_bf16 a[4:7], v[32:35], v[164:167], a[4:7]
    s_add_u32 s31, s31, 8192
    v_exp_f32 v153, v137
    v_mfma_f32_16x16x32_bf16 a[8:11], v[36:39], v[160:163], a[8:11]
    v_exp_f32 v154, v138
    v_cvt_pk_bf16_f32 v171, v150, v151
    v_mfma_f32_16x16x32_bf16 a[12:15], v[36:39], v[164:167], a[12:15]
    v_exp_f32 v155, v139
    v_mfma_f32_16x16x32_bf16 a[16:19], v[40:43], v[160:163], a[16:19]
    v_exp_f32 v156, v140
    v_mfma_f32_16x16x32_bf16 a[20:23], v[40:43], v[164:167], a[20:23]
    v_exp_f32 v157, v141
    v_cvt_pk_bf16_f32 v172, v152, v153
    v_mfma_f32_16x16x32_bf16 a[24:27], v[44:47], v[160:163], a[24:27]
    v_exp_f32 v158, v142
    v_mfma_f32_16x16x32_bf16 a[28:31], v[44:47], v[164:167], a[28:31]
    v_exp_f32 v159, v143
    v_cvt_pk_bf16_f32 v173, v154, v155
    v_smfmac_f32_16x16x64_bf16 a[192:195], v[176:179], v[160:167], v180
    v_cvt_pk_bf16_f32 v174, v156, v157
    v_cvt_pk_bf16_f32 v175, v158, v159
    v_mfma_f32_16x16x32_bf16 v[128:131], v[16:19], a[176:179], v[104:107]
    v_exp_f32 v144, v112
    v_mfma_f32_16x16x32_bf16 v[136:139], v[16:19], a[184:187], v[108:111]
    s_sub_u32 s32, s32, 1
    v_exp_f32 v145, v113
    v_mfma_f32_16x16x32_bf16 v[132:135], v[24:27], a[176:179], v[104:107]
    v_exp_f32 v146, v114
    v_mfma_f32_16x16x32_bf16 v[140:143], v[24:27], a[184:187], v[108:111]
    v_exp_f32 v147, v115
    v_cvt_pk_bf16_f32 v160, v144, v145
    v_mfma_f32_16x16x32_bf16 v[128:131], v[20:23], a[180:183], v[128:131]
    v_exp_f32 v148, v116
    v_mfma_f32_16x16x32_bf16 v[136:139], v[20:23], a[188:191], v[136:139]
    v_exp_f32 v149, v117
    v_cvt_pk_bf16_f32 v161, v146, v147
    v_mfma_f32_16x16x32_bf16 v[132:135], v[28:31], a[180:183], v[132:135]
    v_exp_f32 v150, v118
    v_mfma_f32_16x16x32_bf16 v[140:143], v[28:31], a[188:191], v[140:143]
    v_exp_f32 v151, v119
    v_cvt_pk_bf16_f32 v162, v148, v149
    v_mfma_f32_16x16x32_bf16 a[32:35], v[32:35], v[168:171], a[32:35]
    v_exp_f32 v152, v120
    v_mfma_f32_16x16x32_bf16 a[36:39], v[32:35], v[172:175], a[36:39]
    v_exp_f32 v153, v121
    v_mfma_f32_16x16x32_bf16 a[40:43], v[36:39], v[168:171], a[40:43]
    v_exp_f32 v154, v122
    v_cvt_pk_bf16_f32 v163, v150, v151
    v_mfma_f32_16x16x32_bf16 a[44:47], v[36:39], v[172:175], a[44:47]
    v_exp_f32 v155, v123
    v_mfma_f32_16x16x32_bf16 a[48:51], v[40:43], v[168:171], a[48:51]
    v_exp_f32 v156, v124
    v_mfma_f32_16x16x32_bf16 a[52:55], v[40:43], v[172:175], a[52:55]
    v_exp_f32 v157, v125
    v_cvt_pk_bf16_f32 v164, v152, v153
    v_mfma_f32_16x16x32_bf16 a[56:59], v[44:47], v[168:171], a[56:59]
    v_exp_f32 v158, v126
    v_mfma_f32_16x16x32_bf16 a[60:63], v[44:47], v[172:175], a[60:63]
    v_exp_f32 v159, v127
    v_cvt_pk_bf16_f32 v165, v154, v155
    v_smfmac_f32_16x16x64_bf16 a[196:199], v[176:179], v[168:175], v180
    s_waitcnt vmcnt(4)
    v_cvt_pk_bf16_f32 v166, v156, v157
    v_cvt_pk_bf16_f32 v167, v158, v159
    s_cbranch_scc0 standalone__conformer_family_zipformer__speech_kernel_loop
    v_mfma_f32_16x16x32_bf16 v[112:115], v[48:51], a[128:131], v[80:83]
    v_exp_f32 v144, v128
    v_mfma_f32_16x16x32_bf16 v[120:123], v[48:51], a[136:139], v[84:87]
    buffer_load_dwordx4 v[16:19], v2, s[8:11], s31 offen offset:0
    v_exp_f32 v145, v129
    v_mfma_f32_16x16x32_bf16 v[116:119], v[56:59], a[128:131], v[80:83]
    v_exp_f32 v146, v130
    v_mfma_f32_16x16x32_bf16 v[124:127], v[56:59], a[136:139], v[84:87]
    buffer_load_dwordx4 v[20:23], v2, s[8:11], s31 offen offset:1024
    v_exp_f32 v147, v131
    v_cvt_pk_bf16_f32 v168, v144, v145
    v_mfma_f32_16x16x32_bf16 v[112:115], v[52:55], a[132:135], v[112:115]
    v_exp_f32 v148, v132
    v_mfma_f32_16x16x32_bf16 v[120:123], v[52:55], a[140:143], v[120:123]
    buffer_load_dwordx4 v[24:27], v2, s[8:11], s31 offen offset:2048
    v_exp_f32 v149, v133
    v_cvt_pk_bf16_f32 v169, v146, v147
    v_mfma_f32_16x16x32_bf16 v[116:119], v[60:63], a[132:135], v[116:119]
    v_exp_f32 v150, v134
    v_mfma_f32_16x16x32_bf16 v[124:127], v[60:63], a[140:143], v[124:127]
    buffer_load_dwordx4 v[28:31], v2, s[8:11], s31 offen offset:3072
    v_exp_f32 v151, v135
    v_cvt_pk_bf16_f32 v170, v148, v149
    v_mfma_f32_16x16x32_bf16 a[64:67], v[32:35], v[160:163], a[64:67]
    v_exp_f32 v152, v136
    v_mfma_f32_16x16x32_bf16 a[68:71], v[32:35], v[164:167], a[68:71]
    v_exp_f32 v153, v137
    v_mfma_f32_16x16x32_bf16 a[72:75], v[36:39], v[160:163], a[72:75]
    v_exp_f32 v154, v138
    v_cvt_pk_bf16_f32 v171, v150, v151
    v_mfma_f32_16x16x32_bf16 a[76:79], v[36:39], v[164:167], a[76:79]
    v_exp_f32 v155, v139
    v_mfma_f32_16x16x32_bf16 a[80:83], v[40:43], v[160:163], a[80:83]
    v_exp_f32 v156, v140
    v_mfma_f32_16x16x32_bf16 a[84:87], v[40:43], v[164:167], a[84:87]
    v_exp_f32 v157, v141
    v_cvt_pk_bf16_f32 v172, v152, v153
    v_mfma_f32_16x16x32_bf16 a[88:91], v[44:47], v[160:163], a[88:91]
    v_exp_f32 v158, v142
    v_mfma_f32_16x16x32_bf16 a[92:95], v[44:47], v[164:167], a[92:95]
    v_exp_f32 v159, v143
    v_cvt_pk_bf16_f32 v173, v154, v155
    v_smfmac_f32_16x16x64_bf16 a[200:203], v[176:179], v[160:167], v180
    v_cvt_pk_bf16_f32 v174, v156, v157
    v_cvt_pk_bf16_f32 v175, v158, v159
    v_mfma_f32_16x16x32_bf16 v[128:131], v[48:51], a[144:147], v[88:91]
    v_exp_f32 v144, v112
    v_mfma_f32_16x16x32_bf16 v[136:139], v[48:51], a[152:155], v[92:95]
    v_exp_f32 v145, v113
    v_mfma_f32_16x16x32_bf16 v[132:135], v[56:59], a[144:147], v[88:91]
    v_exp_f32 v146, v114
    v_mfma_f32_16x16x32_bf16 v[140:143], v[56:59], a[152:155], v[92:95]
    v_exp_f32 v147, v115
    v_cvt_pk_bf16_f32 v160, v144, v145
    v_mfma_f32_16x16x32_bf16 v[128:131], v[52:55], a[148:151], v[128:131]
    v_exp_f32 v148, v116
    v_mfma_f32_16x16x32_bf16 v[136:139], v[52:55], a[156:159], v[136:139]
    v_exp_f32 v149, v117
    v_cvt_pk_bf16_f32 v161, v146, v147
    v_mfma_f32_16x16x32_bf16 v[132:135], v[60:63], a[148:151], v[132:135]
    v_exp_f32 v150, v118
    v_mfma_f32_16x16x32_bf16 v[140:143], v[60:63], a[156:159], v[140:143]
    v_exp_f32 v151, v119
    v_cvt_pk_bf16_f32 v162, v148, v149
    v_mfma_f32_16x16x32_bf16 a[96:99], v[32:35], v[168:171], a[96:99]
    v_exp_f32 v152, v120
    v_mfma_f32_16x16x32_bf16 a[100:103], v[32:35], v[172:175], a[100:103]
    v_exp_f32 v153, v121
    v_mfma_f32_16x16x32_bf16 a[104:107], v[36:39], v[168:171], a[104:107]
    v_exp_f32 v154, v122
    v_cvt_pk_bf16_f32 v163, v150, v151
    v_mfma_f32_16x16x32_bf16 a[108:111], v[36:39], v[172:175], a[108:111]
    v_exp_f32 v155, v123
    v_mfma_f32_16x16x32_bf16 a[112:115], v[40:43], v[168:171], a[112:115]
    v_exp_f32 v156, v124
    v_mfma_f32_16x16x32_bf16 a[116:119], v[40:43], v[172:175], a[116:119]
    v_exp_f32 v157, v125
    v_cvt_pk_bf16_f32 v164, v152, v153
    v_mfma_f32_16x16x32_bf16 a[120:123], v[44:47], v[168:171], a[120:123]
    v_exp_f32 v158, v126
    v_mfma_f32_16x16x32_bf16 a[124:127], v[44:47], v[172:175], a[124:127]
    v_exp_f32 v159, v127
    v_cvt_pk_bf16_f32 v165, v154, v155
    v_smfmac_f32_16x16x64_bf16 a[204:207], v[176:179], v[168:175], v180
    s_waitcnt vmcnt(4)
    v_cvt_pk_bf16_f32 v166, v156, v157
    v_cvt_pk_bf16_f32 v167, v158, v159
    v_mfma_f32_16x16x32_bf16 v[112:115], v[48:51], a[160:163], v[96:99]
    v_exp_f32 v144, v128
    v_mfma_f32_16x16x32_bf16 v[120:123], v[48:51], a[168:171], v[100:103]
    buffer_load_dwordx4 v[32:35], v13, s[8:11], s31 offen offset:0
    v_exp_f32 v145, v129
    v_mfma_f32_16x16x32_bf16 v[116:119], v[56:59], a[160:163], v[96:99]
    v_exp_f32 v146, v130
    v_mfma_f32_16x16x32_bf16 v[124:127], v[56:59], a[168:171], v[100:103]
    buffer_load_dwordx4 v[36:39], v13, s[8:11], s31 offen offset:1024
    v_exp_f32 v147, v131
    v_cvt_pk_bf16_f32 v168, v144, v145
    v_mfma_f32_16x16x32_bf16 v[112:115], v[52:55], a[164:167], v[112:115]
    v_exp_f32 v148, v132
    v_mfma_f32_16x16x32_bf16 v[120:123], v[52:55], a[172:175], v[120:123]
    buffer_load_dwordx4 v[40:43], v13, s[8:11], s31 offen offset:2048
    v_exp_f32 v149, v133
    v_cvt_pk_bf16_f32 v169, v146, v147
    v_mfma_f32_16x16x32_bf16 v[116:119], v[60:63], a[164:167], v[116:119]
    v_exp_f32 v150, v134
    v_mfma_f32_16x16x32_bf16 v[124:127], v[60:63], a[172:175], v[124:127]
    buffer_load_dwordx4 v[44:47], v13, s[8:11], s31 offen offset:3072
    v_exp_f32 v151, v135
    v_cvt_pk_bf16_f32 v170, v148, v149
    v_mfma_f32_16x16x32_bf16 a[0:3], v[64:67], v[160:163], a[0:3]
    v_exp_f32 v152, v136
    v_mfma_f32_16x16x32_bf16 a[4:7], v[64:67], v[164:167], a[4:7]
    s_add_u32 s31, s31, 8192
    v_exp_f32 v153, v137
    v_mfma_f32_16x16x32_bf16 a[8:11], v[68:71], v[160:163], a[8:11]
    v_exp_f32 v154, v138
    v_cvt_pk_bf16_f32 v171, v150, v151
    v_mfma_f32_16x16x32_bf16 a[12:15], v[68:71], v[164:167], a[12:15]
    v_exp_f32 v155, v139
    v_mfma_f32_16x16x32_bf16 a[16:19], v[72:75], v[160:163], a[16:19]
    v_exp_f32 v156, v140
    v_mfma_f32_16x16x32_bf16 a[20:23], v[72:75], v[164:167], a[20:23]
    v_exp_f32 v157, v141
    v_cvt_pk_bf16_f32 v172, v152, v153
    v_mfma_f32_16x16x32_bf16 a[24:27], v[76:79], v[160:163], a[24:27]
    v_exp_f32 v158, v142
    v_mfma_f32_16x16x32_bf16 a[28:31], v[76:79], v[164:167], a[28:31]
    v_exp_f32 v159, v143
    v_cvt_pk_bf16_f32 v173, v154, v155
    v_smfmac_f32_16x16x64_bf16 a[192:195], v[176:179], v[160:167], v180
    v_cvt_pk_bf16_f32 v174, v156, v157
    v_cvt_pk_bf16_f32 v175, v158, v159
    v_mfma_f32_16x16x32_bf16 v[128:131], v[48:51], a[176:179], v[104:107]
    v_exp_f32 v144, v112
    v_mfma_f32_16x16x32_bf16 v[136:139], v[48:51], a[184:187], v[108:111]
    v_exp_f32 v145, v113
    v_mfma_f32_16x16x32_bf16 v[132:135], v[56:59], a[176:179], v[104:107]
    v_exp_f32 v146, v114
    v_mfma_f32_16x16x32_bf16 v[140:143], v[56:59], a[184:187], v[108:111]
    v_exp_f32 v147, v115
    v_cvt_pk_bf16_f32 v160, v144, v145
    v_mfma_f32_16x16x32_bf16 v[128:131], v[52:55], a[180:183], v[128:131]
    v_exp_f32 v148, v116
    v_mfma_f32_16x16x32_bf16 v[136:139], v[52:55], a[188:191], v[136:139]
    v_exp_f32 v149, v117
    v_cvt_pk_bf16_f32 v161, v146, v147
    v_mfma_f32_16x16x32_bf16 v[132:135], v[60:63], a[180:183], v[132:135]
    v_exp_f32 v150, v118
    v_mfma_f32_16x16x32_bf16 v[140:143], v[60:63], a[188:191], v[140:143]
    v_exp_f32 v151, v119
    v_cvt_pk_bf16_f32 v162, v148, v149
    v_mfma_f32_16x16x32_bf16 a[32:35], v[64:67], v[168:171], a[32:35]
    v_exp_f32 v152, v120
    v_mfma_f32_16x16x32_bf16 a[36:39], v[64:67], v[172:175], a[36:39]
    v_exp_f32 v153, v121
    v_mfma_f32_16x16x32_bf16 a[40:43], v[68:71], v[168:171], a[40:43]
    v_exp_f32 v154, v122
    v_cvt_pk_bf16_f32 v163, v150, v151
    v_mfma_f32_16x16x32_bf16 a[44:47], v[68:71], v[172:175], a[44:47]
    v_exp_f32 v155, v123
    v_mfma_f32_16x16x32_bf16 a[48:51], v[72:75], v[168:171], a[48:51]
    v_exp_f32 v156, v124
    v_mfma_f32_16x16x32_bf16 a[52:55], v[72:75], v[172:175], a[52:55]
    v_exp_f32 v157, v125
    v_cvt_pk_bf16_f32 v164, v152, v153
    v_mfma_f32_16x16x32_bf16 a[56:59], v[76:79], v[168:171], a[56:59]
    v_exp_f32 v158, v126
    v_mfma_f32_16x16x32_bf16 a[60:63], v[76:79], v[172:175], a[60:63]
    v_exp_f32 v159, v127
    v_cvt_pk_bf16_f32 v165, v154, v155
    v_smfmac_f32_16x16x64_bf16 a[196:199], v[176:179], v[168:175], v180
    s_waitcnt vmcnt(4)
    v_cvt_pk_bf16_f32 v166, v156, v157
    v_cvt_pk_bf16_f32 v167, v158, v159
    v_mfma_f32_16x16x32_bf16 v[112:115], v[16:19], a[128:131], v[80:83]
    v_exp_f32 v144, v128
    v_mfma_f32_16x16x32_bf16 v[120:123], v[16:19], a[136:139], v[84:87]
    buffer_load_dwordx4 v[48:51], v2, s[8:11], s28 offen offset:0
    v_exp_f32 v145, v129
    v_mfma_f32_16x16x32_bf16 v[116:119], v[24:27], a[128:131], v[80:83]
    v_exp_f32 v146, v130
    v_mfma_f32_16x16x32_bf16 v[124:127], v[24:27], a[136:139], v[84:87]
    buffer_load_dwordx4 v[52:55], v2, s[8:11], s28 offen offset:1024
    v_exp_f32 v147, v131
    v_cvt_pk_bf16_f32 v168, v144, v145
    v_mfma_f32_16x16x32_bf16 v[112:115], v[20:23], a[132:135], v[112:115]
    v_exp_f32 v148, v132
    v_mfma_f32_16x16x32_bf16 v[120:123], v[20:23], a[140:143], v[120:123]
    buffer_load_dwordx4 v[56:59], v2, s[8:11], s28 offen offset:2048
    v_exp_f32 v149, v133
    v_cvt_pk_bf16_f32 v169, v146, v147
    v_mfma_f32_16x16x32_bf16 v[116:119], v[28:31], a[132:135], v[116:119]
    v_exp_f32 v150, v134
    v_mfma_f32_16x16x32_bf16 v[124:127], v[28:31], a[140:143], v[124:127]
    buffer_load_dwordx4 v[60:63], v2, s[8:11], s28 offen offset:3072
    v_exp_f32 v151, v135
    v_cvt_pk_bf16_f32 v170, v148, v149
    v_mfma_f32_16x16x32_bf16 a[64:67], v[64:67], v[160:163], a[64:67]
    v_exp_f32 v152, v136
    v_mfma_f32_16x16x32_bf16 a[68:71], v[64:67], v[164:167], a[68:71]
    v_exp_f32 v153, v137
    v_mfma_f32_16x16x32_bf16 a[72:75], v[68:71], v[160:163], a[72:75]
    v_exp_f32 v154, v138
    v_cvt_pk_bf16_f32 v171, v150, v151
    v_mfma_f32_16x16x32_bf16 a[76:79], v[68:71], v[164:167], a[76:79]
    v_exp_f32 v155, v139
    v_mfma_f32_16x16x32_bf16 a[80:83], v[72:75], v[160:163], a[80:83]
    v_exp_f32 v156, v140
    v_mfma_f32_16x16x32_bf16 a[84:87], v[72:75], v[164:167], a[84:87]
    v_exp_f32 v157, v141
    v_cvt_pk_bf16_f32 v172, v152, v153
    v_mfma_f32_16x16x32_bf16 a[88:91], v[76:79], v[160:163], a[88:91]
    v_exp_f32 v158, v142
    v_mfma_f32_16x16x32_bf16 a[92:95], v[76:79], v[164:167], a[92:95]
    v_exp_f32 v159, v143
    v_cvt_pk_bf16_f32 v173, v154, v155
    v_smfmac_f32_16x16x64_bf16 a[200:203], v[176:179], v[160:167], v180
    v_cvt_pk_bf16_f32 v174, v156, v157
    v_cvt_pk_bf16_f32 v175, v158, v159
    v_mfma_f32_16x16x32_bf16 v[128:131], v[16:19], a[144:147], v[88:91]
    v_exp_f32 v144, v112
    v_mfma_f32_16x16x32_bf16 v[136:139], v[16:19], a[152:155], v[92:95]
    v_exp_f32 v145, v113
    v_mfma_f32_16x16x32_bf16 v[132:135], v[24:27], a[144:147], v[88:91]
    v_exp_f32 v146, v114
    v_mfma_f32_16x16x32_bf16 v[140:143], v[24:27], a[152:155], v[92:95]
    v_exp_f32 v147, v115
    v_cvt_pk_bf16_f32 v160, v144, v145
    v_mfma_f32_16x16x32_bf16 v[128:131], v[20:23], a[148:151], v[128:131]
    v_exp_f32 v148, v116
    v_mfma_f32_16x16x32_bf16 v[136:139], v[20:23], a[156:159], v[136:139]
    v_exp_f32 v149, v117
    v_cvt_pk_bf16_f32 v161, v146, v147
    v_mfma_f32_16x16x32_bf16 v[132:135], v[28:31], a[148:151], v[132:135]
    v_exp_f32 v150, v118
    v_mfma_f32_16x16x32_bf16 v[140:143], v[28:31], a[156:159], v[140:143]
    v_exp_f32 v151, v119
    v_cvt_pk_bf16_f32 v162, v148, v149
    v_mfma_f32_16x16x32_bf16 a[96:99], v[64:67], v[168:171], a[96:99]
    v_exp_f32 v152, v120
    v_mfma_f32_16x16x32_bf16 a[100:103], v[64:67], v[172:175], a[100:103]
    v_exp_f32 v153, v121
    v_mfma_f32_16x16x32_bf16 a[104:107], v[68:71], v[168:171], a[104:107]
    v_exp_f32 v154, v122
    v_cvt_pk_bf16_f32 v163, v150, v151
    v_mfma_f32_16x16x32_bf16 a[108:111], v[68:71], v[172:175], a[108:111]
    v_exp_f32 v155, v123
    v_mfma_f32_16x16x32_bf16 a[112:115], v[72:75], v[168:171], a[112:115]
    v_exp_f32 v156, v124
    v_mfma_f32_16x16x32_bf16 a[116:119], v[72:75], v[172:175], a[116:119]
    v_exp_f32 v157, v125
    v_cvt_pk_bf16_f32 v164, v152, v153
    v_mfma_f32_16x16x32_bf16 a[120:123], v[76:79], v[168:171], a[120:123]
    v_exp_f32 v158, v126
    v_mfma_f32_16x16x32_bf16 a[124:127], v[76:79], v[172:175], a[124:127]
    v_exp_f32 v159, v127
    v_cvt_pk_bf16_f32 v165, v154, v155
    v_smfmac_f32_16x16x64_bf16 a[204:207], v[176:179], v[168:175], v180
    s_waitcnt vmcnt(4)
    v_cvt_pk_bf16_f32 v166, v156, v157
    v_cvt_pk_bf16_f32 v167, v158, v159
    v_mfma_f32_16x16x32_bf16 v[112:115], v[16:19], a[160:163], v[96:99]
    v_exp_f32 v144, v128
    v_mfma_f32_16x16x32_bf16 v[120:123], v[16:19], a[168:171], v[100:103]
    buffer_load_dwordx4 v[64:67], v13, s[8:11], s28 offen offset:0
    v_exp_f32 v145, v129
    v_mfma_f32_16x16x32_bf16 v[116:119], v[24:27], a[160:163], v[96:99]
    v_exp_f32 v146, v130
    v_mfma_f32_16x16x32_bf16 v[124:127], v[24:27], a[168:171], v[100:103]
    buffer_load_dwordx4 v[68:71], v13, s[8:11], s28 offen offset:1024
    v_exp_f32 v147, v131
    v_cvt_pk_bf16_f32 v168, v144, v145
    v_mfma_f32_16x16x32_bf16 v[112:115], v[20:23], a[164:167], v[112:115]
    v_exp_f32 v148, v132
    v_mfma_f32_16x16x32_bf16 v[120:123], v[20:23], a[172:175], v[120:123]
    buffer_load_dwordx4 v[72:75], v13, s[8:11], s28 offen offset:2048
    v_exp_f32 v149, v133
    v_cvt_pk_bf16_f32 v169, v146, v147
    v_mfma_f32_16x16x32_bf16 v[116:119], v[28:31], a[164:167], v[116:119]
    v_exp_f32 v150, v134
    v_mfma_f32_16x16x32_bf16 v[124:127], v[28:31], a[172:175], v[124:127]
    buffer_load_dwordx4 v[76:79], v13, s[8:11], s28 offen offset:3072
    v_exp_f32 v151, v135
    v_cvt_pk_bf16_f32 v170, v148, v149
    v_mfma_f32_16x16x32_bf16 a[0:3], v[32:35], v[160:163], a[0:3]
    v_exp_f32 v152, v136
    v_mfma_f32_16x16x32_bf16 a[4:7], v[32:35], v[164:167], a[4:7]
    s_add_u32 s31, s31, 8192
    v_exp_f32 v153, v137
    v_mfma_f32_16x16x32_bf16 a[8:11], v[36:39], v[160:163], a[8:11]
    v_exp_f32 v154, v138
    v_cvt_pk_bf16_f32 v171, v150, v151
    v_mfma_f32_16x16x32_bf16 a[12:15], v[36:39], v[164:167], a[12:15]
    v_exp_f32 v155, v139
    v_mfma_f32_16x16x32_bf16 a[16:19], v[40:43], v[160:163], a[16:19]
    v_exp_f32 v156, v140
    v_mfma_f32_16x16x32_bf16 a[20:23], v[40:43], v[164:167], a[20:23]
    v_exp_f32 v157, v141
    v_cvt_pk_bf16_f32 v172, v152, v153
    v_mfma_f32_16x16x32_bf16 a[24:27], v[44:47], v[160:163], a[24:27]
    v_exp_f32 v158, v142
    v_mfma_f32_16x16x32_bf16 a[28:31], v[44:47], v[164:167], a[28:31]
    v_exp_f32 v159, v143
    v_cvt_pk_bf16_f32 v173, v154, v155
    v_smfmac_f32_16x16x64_bf16 a[192:195], v[176:179], v[160:167], v180
    v_cvt_pk_bf16_f32 v174, v156, v157
    v_cvt_pk_bf16_f32 v175, v158, v159
    v_mfma_f32_16x16x32_bf16 v[128:131], v[16:19], a[176:179], v[104:107]
    v_exp_f32 v144, v112
    v_mfma_f32_16x16x32_bf16 v[136:139], v[16:19], a[184:187], v[108:111]
    buffer_store_dwordx4 a[232:235], v2, s[8:11], s91 offen offset:0 sc1
    v_exp_f32 v145, v113
    v_mfma_f32_16x16x32_bf16 v[132:135], v[24:27], a[176:179], v[104:107]
    v_exp_f32 v146, v114
    v_mfma_f32_16x16x32_bf16 v[140:143], v[24:27], a[184:187], v[108:111]
    buffer_store_dwordx4 a[236:239], v2, s[8:11], s91 offen offset:1024 sc1
    v_exp_f32 v147, v115
    v_cvt_pk_bf16_f32 v160, v144, v145
    v_mfma_f32_16x16x32_bf16 v[128:131], v[20:23], a[180:183], v[128:131]
    v_exp_f32 v148, v116
    v_mfma_f32_16x16x32_bf16 v[136:139], v[20:23], a[188:191], v[136:139]
    buffer_load_dwordx4 a[208:211], v2, s[8:11], s93 offen offset:0
    v_exp_f32 v149, v117
    v_cvt_pk_bf16_f32 v161, v146, v147
    v_mfma_f32_16x16x32_bf16 v[132:135], v[28:31], a[180:183], v[132:135]
    v_exp_f32 v150, v118
    v_mfma_f32_16x16x32_bf16 v[140:143], v[28:31], a[188:191], v[140:143]
    buffer_load_dwordx4 a[212:215], v2, s[8:11], s93 offen offset:1024
    v_exp_f32 v151, v119
    v_cvt_pk_bf16_f32 v162, v148, v149
    v_mfma_f32_16x16x32_bf16 a[32:35], v[32:35], v[168:171], a[32:35]
    v_exp_f32 v152, v120
    v_mfma_f32_16x16x32_bf16 a[36:39], v[32:35], v[172:175], a[36:39]
    buffer_load_dwordx4 a[216:219], v2, s[8:11], s93 offen offset:2048
    v_exp_f32 v153, v121
    v_mfma_f32_16x16x32_bf16 a[40:43], v[36:39], v[168:171], a[40:43]
    v_exp_f32 v154, v122
    v_cvt_pk_bf16_f32 v163, v150, v151
    v_mfma_f32_16x16x32_bf16 a[44:47], v[36:39], v[172:175], a[44:47]
    buffer_load_dwordx4 a[220:223], v2, s[8:11], s93 offen offset:3072
    v_exp_f32 v155, v123
    v_mfma_f32_16x16x32_bf16 a[48:51], v[40:43], v[168:171], a[48:51]
    v_exp_f32 v156, v124
    v_mfma_f32_16x16x32_bf16 a[52:55], v[40:43], v[172:175], a[52:55]
    v_exp_f32 v157, v125
    v_cvt_pk_bf16_f32 v164, v152, v153
    v_mfma_f32_16x16x32_bf16 a[56:59], v[44:47], v[168:171], a[56:59]
    v_exp_f32 v158, v126
    v_mfma_f32_16x16x32_bf16 a[60:63], v[44:47], v[172:175], a[60:63]
    v_exp_f32 v159, v127
    v_cvt_pk_bf16_f32 v165, v154, v155
    v_smfmac_f32_16x16x64_bf16 a[196:199], v[176:179], v[168:175], v180
    s_waitcnt vmcnt(10)
    v_cvt_pk_bf16_f32 v166, v156, v157
    v_cvt_pk_bf16_f32 v167, v158, v159
    v_mfma_f32_16x16x32_bf16 v[112:115], v[48:51], a[128:131], v[80:83]
    v_exp_f32 v144, v128
    v_mfma_f32_16x16x32_bf16 v[120:123], v[48:51], a[136:139], v[84:87]
    buffer_load_dword v181, v14, s[8:11], s38 offen sc1
    v_exp_f32 v145, v129
    v_mfma_f32_16x16x32_bf16 v[116:119], v[56:59], a[128:131], v[80:83]
    v_exp_f32 v146, v130
    v_mfma_f32_16x16x32_bf16 v[124:127], v[56:59], a[136:139], v[84:87]
    buffer_load_dword v181, v15, s[8:11], s39 offen sc1
    v_exp_f32 v147, v131
    v_cvt_pk_bf16_f32 v168, v144, v145
    v_mfma_f32_16x16x32_bf16 v[112:115], v[52:55], a[132:135], v[112:115]
    v_exp_f32 v148, v132
    v_mfma_f32_16x16x32_bf16 v[120:123], v[52:55], a[140:143], v[120:123]
    ds_write_b128 v7, a[32:35] offset:0
    v_exp_f32 v149, v133
    v_cvt_pk_bf16_f32 v169, v146, v147
    v_mfma_f32_16x16x32_bf16 v[116:119], v[60:63], a[132:135], v[116:119]
    v_exp_f32 v150, v134
    v_mfma_f32_16x16x32_bf16 v[124:127], v[60:63], a[140:143], v[124:127]
    ds_write_b128 v7, a[36:39] offset:1024
    v_exp_f32 v151, v135
    v_cvt_pk_bf16_f32 v170, v148, v149
    v_mfma_f32_16x16x32_bf16 a[64:67], v[32:35], v[160:163], a[64:67]
    v_exp_f32 v152, v136
    v_mfma_f32_16x16x32_bf16 a[68:71], v[32:35], v[164:167], a[68:71]
    ds_write_b128 v7, a[40:43] offset:2048
    v_exp_f32 v153, v137
    v_mfma_f32_16x16x32_bf16 a[72:75], v[36:39], v[160:163], a[72:75]
    v_exp_f32 v154, v138
    v_cvt_pk_bf16_f32 v171, v150, v151
    v_mfma_f32_16x16x32_bf16 a[76:79], v[36:39], v[164:167], a[76:79]
    ds_write_b128 v7, a[44:47] offset:3072
    v_exp_f32 v155, v139
    v_mfma_f32_16x16x32_bf16 a[80:83], v[40:43], v[160:163], a[80:83]
    v_exp_f32 v156, v140
    v_mfma_f32_16x16x32_bf16 a[84:87], v[40:43], v[164:167], a[84:87]
    ds_write_b128 v7, a[48:51] offset:4096
    v_exp_f32 v157, v141
    v_cvt_pk_bf16_f32 v172, v152, v153
    v_mfma_f32_16x16x32_bf16 a[88:91], v[44:47], v[160:163], a[88:91]
    v_exp_f32 v158, v142
    v_mfma_f32_16x16x32_bf16 a[92:95], v[44:47], v[164:167], a[92:95]
    ds_write_b128 v7, a[52:55] offset:5120
    v_exp_f32 v159, v143
    v_cvt_pk_bf16_f32 v173, v154, v155
    v_smfmac_f32_16x16x64_bf16 a[200:203], v[176:179], v[160:167], v180
    v_cvt_pk_bf16_f32 v174, v156, v157
    v_cvt_pk_bf16_f32 v175, v158, v159
    v_mfma_f32_16x16x32_bf16 a[96:99], v[32:35], v[168:171], a[96:99]
    v_exp_f32 v144, v112
    v_exp_f32 v145, v113
    v_mfma_f32_16x16x32_bf16 a[100:103], v[32:35], v[172:175], a[100:103]
    ds_write_b128 v7, a[56:59] offset:6144
    ds_write_b128 v7, a[60:63] offset:7168
    v_exp_f32 v146, v114
    v_exp_f32 v147, v115
    v_cvt_pk_bf16_f32 v160, v144, v145
    v_mfma_f32_16x16x32_bf16 a[104:107], v[36:39], v[168:171], a[104:107]
    v_exp_f32 v148, v116
    v_exp_f32 v149, v117
    v_cvt_pk_bf16_f32 v161, v146, v147
    v_mfma_f32_16x16x32_bf16 a[108:111], v[36:39], v[172:175], a[108:111]
    ds_write_b128 v7, a[196:199] offset:8192
    ds_write_b128 v8, a[64:67] offset:0
    v_exp_f32 v150, v118
    v_exp_f32 v151, v119
    v_cvt_pk_bf16_f32 v162, v148, v149
    v_mfma_f32_16x16x32_bf16 a[112:115], v[40:43], v[168:171], a[112:115]
    v_exp_f32 v152, v120
    v_exp_f32 v153, v121
    v_mfma_f32_16x16x32_bf16 a[116:119], v[40:43], v[172:175], a[116:119]
    ds_write_b128 v8, a[68:71] offset:1024
    ds_write_b128 v8, a[72:75] offset:2048
    v_exp_f32 v154, v122
    v_exp_f32 v155, v123
    v_cvt_pk_bf16_f32 v163, v150, v151
    v_mfma_f32_16x16x32_bf16 a[120:123], v[44:47], v[168:171], a[120:123]
    v_exp_f32 v156, v124
    v_exp_f32 v157, v125
    v_cvt_pk_bf16_f32 v164, v152, v153
    v_mfma_f32_16x16x32_bf16 a[124:127], v[44:47], v[172:175], a[124:127]
    ds_write_b128 v8, a[76:79] offset:3072
    ds_write_b128 v8, a[80:83] offset:4096
    v_exp_f32 v158, v126
    v_exp_f32 v159, v127
    v_cvt_pk_bf16_f32 v165, v154, v155
    v_smfmac_f32_16x16x64_bf16 a[204:207], v[176:179], v[168:175], v180
    s_waitcnt vmcnt(8)
    v_cvt_pk_bf16_f32 v166, v156, v157
    v_cvt_pk_bf16_f32 v167, v158, v159
    v_mfma_f32_16x16x32_bf16 a[0:3], v[64:67], v[160:163], a[0:3]
    v_accvgpr_read_b32 v188, a196
    v_accvgpr_read_b32 v189, a197
    v_mfma_f32_16x16x32_bf16 a[4:7], v[64:67], v[164:167], a[4:7]
    ds_write_b128 v8, a[84:87] offset:5120
    v_accvgpr_read_b32 v190, a198
    v_mfma_f32_16x16x32_bf16 a[8:11], v[68:71], v[160:163], a[8:11]
    ds_write_b128 v8, a[88:91] offset:6144
    v_mfma_f32_16x16x32_bf16 a[12:15], v[68:71], v[164:167], a[12:15]
    ds_write_b128 v8, a[92:95] offset:7168
    v_accvgpr_read_b32 v191, a199
    v_mfma_f32_16x16x32_bf16 a[16:19], v[72:75], v[160:163], a[16:19]
    ds_write_b128 v8, a[200:203] offset:8192
    v_accvgpr_read_b32 v192, a200
    v_mfma_f32_16x16x32_bf16 a[20:23], v[72:75], v[164:167], a[20:23]
    ds_write_b128 v9, a[96:99] offset:0
    v_accvgpr_read_b32 v193, a201
    v_mfma_f32_16x16x32_bf16 a[24:27], v[76:79], v[160:163], a[24:27]
    ds_write_b128 v9, a[100:103] offset:1024
    v_mfma_f32_16x16x32_bf16 a[28:31], v[76:79], v[164:167], a[28:31]
    ds_write_b128 v9, a[104:107] offset:2048
    v_accvgpr_read_b32 v194, a202
    v_smfmac_f32_16x16x64_bf16 a[192:195], v[176:179], v[160:167], v180
    ds_write_b128 v9, a[108:111] offset:3072
    v_accvgpr_read_b32 v195, a203
    ds_write_b128 v9, a[112:115] offset:4096
    ds_write_b128 v9, a[116:119] offset:5120
    ds_write_b128 v9, a[120:123] offset:6144
    ds_write_b128 v9, a[124:127] offset:7168
    ds_write_b128 v9, a[204:207] offset:8192
    v_accvgpr_read_b32 v196, a204
    v_accvgpr_read_b32 v197, a205
    v_accvgpr_read_b32 v198, a206
    v_accvgpr_read_b32 v199, a207
    v_accvgpr_read_b32 v80, a0
    v_accvgpr_read_b32 v81, a1
    v_accvgpr_read_b32 v82, a2
    v_accvgpr_read_b32 v83, a3
    v_accvgpr_read_b32 v84, a4
    v_accvgpr_read_b32 v85, a5
    v_accvgpr_read_b32 v86, a6
    v_accvgpr_read_b32 v87, a7
    v_accvgpr_read_b32 v88, a8
    v_accvgpr_read_b32 v89, a9
    v_accvgpr_read_b32 v90, a10
    v_accvgpr_read_b32 v91, a11
    v_accvgpr_read_b32 v92, a12
    v_accvgpr_read_b32 v93, a13
    v_accvgpr_read_b32 v94, a14
    v_accvgpr_read_b32 v95, a15
    v_accvgpr_read_b32 v96, a16
    v_accvgpr_read_b32 v97, a17
    v_accvgpr_read_b32 v98, a18
    v_accvgpr_read_b32 v99, a19
    v_accvgpr_read_b32 v100, a20
    v_accvgpr_read_b32 v101, a21
    v_accvgpr_read_b32 v102, a22
    v_accvgpr_read_b32 v103, a23
    v_accvgpr_read_b32 v104, a24
    v_accvgpr_read_b32 v105, a25
    v_accvgpr_read_b32 v106, a26
    v_accvgpr_read_b32 v107, a27
    v_accvgpr_read_b32 v108, a28
    v_accvgpr_read_b32 v109, a29
    v_accvgpr_read_b32 v110, a30
    v_accvgpr_read_b32 v111, a31
standalone__conformer_family_zipformer__speech_kernel_join:
    v_accvgpr_read_b32 v184, a192
    v_accvgpr_read_b32 v185, a193
    v_accvgpr_read_b32 v186, a194
    v_accvgpr_read_b32 v187, a195
    v_pk_add_f32 v[200:201], v[184:185], v[186:187]
    v_pk_add_f32 v[200:201], v[200:201], v[188:189]
    v_pk_add_f32 v[200:201], v[200:201], v[190:191]
    v_pk_add_f32 v[200:201], v[200:201], v[192:193]
    v_pk_add_f32 v[200:201], v[200:201], v[194:195]
    v_pk_add_f32 v[200:201], v[200:201], v[196:197]
    v_pk_add_f32 v[200:201], v[200:201], v[198:199]
    v_add_f32 v200, v200, v201
    v_cmp_nge_f32 vcc, 0x4e800000, v200
    s_nop 0
    s_cmp_lg_u64 vcc, 0
    s_cselect_b32 s14, 1, 0
    v_mov_b32 v201, s14
    ds_write_b32 v11, v201
    s_waitcnt lgkmcnt(0)
    s_barrier
    ds_read_b128 v[204:207], v12
    ds_read_b128 v[16:19], v10 offset:0
    ds_read_b128 v[20:23], v10 offset:1024
    ds_read_b128 v[24:27], v10 offset:2048
    ds_read_b128 v[28:31], v10 offset:3072
    ds_read_b128 v[32:35], v10 offset:4096
    ds_read_b128 v[36:39], v10 offset:5120
    ds_read_b128 v[40:43], v10 offset:6144
    ds_read_b128 v[44:47], v10 offset:7168
    ds_read_b128 v[48:51], v10 offset:8192
    ds_read_b128 v[52:55], v10 offset:9216
    ds_read_b128 v[56:59], v10 offset:10240
    ds_read_b128 v[60:63], v10 offset:11264
    ds_read_b128 v[64:67], v10 offset:12288
    ds_read_b128 v[68:71], v10 offset:13312
    ds_read_b128 v[72:75], v10 offset:14336
    ds_read_b128 v[76:79], v10 offset:15360
    ds_read_b128 v[112:115], v10 offset:16384
    ds_read_b128 v[116:119], v10 offset:17408
    ds_read_b128 v[120:123], v10 offset:18432
    ds_read_b128 v[124:127], v10 offset:19456
    ds_read_b128 v[128:131], v10 offset:20480
    ds_read_b128 v[132:135], v10 offset:21504
    ds_read_b128 v[136:139], v10 offset:22528
    ds_read_b128 v[140:143], v10 offset:23552
    ds_read_b128 v[144:147], v10 offset:24576
    ds_read_b128 v[148:151], v10 offset:25600
    ds_read_b128 v[152:155], v10 offset:26624
    s_waitcnt lgkmcnt(15)
    v_or_b32 v204, v204, v205
    v_or3_b32 v204, v204, v206, v207
    s_nop 0
    v_readfirstlane_b32 s14, v204
    s_nop 0
    s_andn2_b32 s14, s14, s37
    s_cmp_lg_u32 s14, 0
    s_cbranch_scc1 standalone__conformer_family_zipformer__speech_kernel_slow
    v_pk_add_f32 v[80:81], v[80:81], v[16:17]
    v_pk_add_f32 v[82:83], v[82:83], v[18:19]
    v_pk_add_f32 v[84:85], v[84:85], v[20:21]
    v_pk_add_f32 v[86:87], v[86:87], v[22:23]
    v_pk_add_f32 v[88:89], v[88:89], v[24:25]
    v_pk_add_f32 v[90:91], v[90:91], v[26:27]
    v_pk_add_f32 v[92:93], v[92:93], v[28:29]
    v_pk_add_f32 v[94:95], v[94:95], v[30:31]
    v_pk_add_f32 v[96:97], v[96:97], v[32:33]
    v_pk_add_f32 v[98:99], v[98:99], v[34:35]
    v_pk_add_f32 v[100:101], v[100:101], v[36:37]
    v_pk_add_f32 v[102:103], v[102:103], v[38:39]
    v_pk_add_f32 v[104:105], v[104:105], v[40:41]
    v_pk_add_f32 v[106:107], v[106:107], v[42:43]
    v_pk_add_f32 v[108:109], v[108:109], v[44:45]
    v_pk_add_f32 v[110:111], v[110:111], v[46:47]
    v_pk_add_f32 v[184:185], v[184:185], v[48:49]
    v_pk_add_f32 v[186:187], v[186:187], v[50:51]
    v_pk_add_f32 v[80:81], v[80:81], v[52:53]
    v_pk_add_f32 v[82:83], v[82:83], v[54:55]
    v_pk_add_f32 v[84:85], v[84:85], v[56:57]
    v_pk_add_f32 v[86:87], v[86:87], v[58:59]
    v_pk_add_f32 v[88:89], v[88:89], v[60:61]
    v_pk_add_f32 v[90:91], v[90:91], v[62:63]
    s_waitcnt lgkmcnt(14)
    v_pk_add_f32 v[92:93], v[92:93], v[64:65]
    v_pk_add_f32 v[94:95], v[94:95], v[66:67]
    s_waitcnt lgkmcnt(13)
    v_pk_add_f32 v[96:97], v[96:97], v[68:69]
    v_pk_add_f32 v[98:99], v[98:99], v[70:71]
    s_waitcnt lgkmcnt(12)
    v_pk_add_f32 v[100:101], v[100:101], v[72:73]
    v_pk_add_f32 v[102:103], v[102:103], v[74:75]
    s_waitcnt lgkmcnt(11)
    v_pk_add_f32 v[104:105], v[104:105], v[76:77]
    v_pk_add_f32 v[106:107], v[106:107], v[78:79]
    s_waitcnt lgkmcnt(10)
    v_pk_add_f32 v[108:109], v[108:109], v[112:113]
    v_pk_add_f32 v[110:111], v[110:111], v[114:115]
    s_waitcnt lgkmcnt(9)
    v_pk_add_f32 v[184:185], v[184:185], v[116:117]
    v_pk_add_f32 v[186:187], v[186:187], v[118:119]
    s_waitcnt lgkmcnt(8)
    v_pk_add_f32 v[80:81], v[80:81], v[120:121]
    v_pk_add_f32 v[82:83], v[82:83], v[122:123]
    s_waitcnt lgkmcnt(7)
    v_pk_add_f32 v[84:85], v[84:85], v[124:125]
    v_pk_add_f32 v[86:87], v[86:87], v[126:127]
    s_waitcnt lgkmcnt(6)
    v_pk_add_f32 v[88:89], v[88:89], v[128:129]
    v_pk_add_f32 v[90:91], v[90:91], v[130:131]
    s_waitcnt lgkmcnt(5)
    v_pk_add_f32 v[92:93], v[92:93], v[132:133]
    v_pk_add_f32 v[94:95], v[94:95], v[134:135]
    s_waitcnt lgkmcnt(4)
    v_pk_add_f32 v[96:97], v[96:97], v[136:137]
    v_pk_add_f32 v[98:99], v[98:99], v[138:139]
    s_waitcnt lgkmcnt(3)
    v_pk_add_f32 v[100:101], v[100:101], v[140:141]
    v_pk_add_f32 v[102:103], v[102:103], v[142:143]
    s_waitcnt lgkmcnt(2)
    v_pk_add_f32 v[104:105], v[104:105], v[144:145]
    v_pk_add_f32 v[106:107], v[106:107], v[146:147]
    s_waitcnt lgkmcnt(1)
    v_pk_add_f32 v[108:109], v[108:109], v[148:149]
    v_pk_add_f32 v[110:111], v[110:111], v[150:151]
    s_waitcnt lgkmcnt(0)
    v_pk_add_f32 v[184:185], v[184:185], v[152:153]
    v_pk_add_f32 v[186:187], v[186:187], v[154:155]
    v_add_f32 v184, v184, v185
    v_rcp_f32 v184, v184
    v_add_f32 v186, v186, v187
    v_rcp_f32 v186, v186
    s_cmp_ge_u32 s33, 250
    s_cbranch_scc1 standalone__conformer_family_zipformer__speech_kernel_fin
    v_pk_mul_f32 v[80:81], v[80:81], v[184:185] op_sel_hi:[1,0]
    v_pk_mul_f32 v[82:83], v[82:83], v[184:185] op_sel_hi:[1,0]
    v_cvt_pk_bf16_f32 v16, v80, v81
    v_cvt_pk_bf16_f32 v17, v82, v83
    v_pk_mul_f32 v[88:89], v[88:89], v[184:185] op_sel_hi:[1,0]
    v_pk_mul_f32 v[90:91], v[90:91], v[184:185] op_sel_hi:[1,0]
    v_cvt_pk_bf16_f32 v18, v88, v89
    v_cvt_pk_bf16_f32 v19, v90, v91
    buffer_store_dwordx4 v[16:19], v2, s[8:11], s88 offen offset:0 sc1
    v_pk_mul_f32 v[96:97], v[96:97], v[184:185] op_sel_hi:[1,0]
    v_pk_mul_f32 v[98:99], v[98:99], v[184:185] op_sel_hi:[1,0]
    v_cvt_pk_bf16_f32 v20, v96, v97
    v_cvt_pk_bf16_f32 v21, v98, v99
    v_pk_mul_f32 v[104:105], v[104:105], v[184:185] op_sel_hi:[1,0]
    v_pk_mul_f32 v[106:107], v[106:107], v[184:185] op_sel_hi:[1,0]
    v_cvt_pk_bf16_f32 v22, v104, v105
    v_cvt_pk_bf16_f32 v23, v106, v107
    buffer_store_dwordx4 v[20:23], v2, s[8:11], s88 offen offset:1024 sc1
    v_pk_mul_f32 v[84:85], v[84:85], v[186:187] op_sel_hi:[1,0]
    v_pk_mul_f32 v[86:87], v[86:87], v[186:187] op_sel_hi:[1,0]
    v_cvt_pk_bf16_f32 v24, v84, v85
    v_cvt_pk_bf16_f32 v25, v86, v87
    v_pk_mul_f32 v[92:93], v[92:93], v[186:187] op_sel_hi:[1,0]
    v_pk_mul_f32 v[94:95], v[94:95], v[186:187] op_sel_hi:[1,0]
    v_cvt_pk_bf16_f32 v26, v92, v93
    v_cvt_pk_bf16_f32 v27, v94, v95
    buffer_store_dwordx4 v[24:27], v2, s[8:11], s89 offen offset:0 sc1
    v_pk_mul_f32 v[100:101], v[100:101], v[186:187] op_sel_hi:[1,0]
    v_pk_mul_f32 v[102:103], v[102:103], v[186:187] op_sel_hi:[1,0]
    v_cvt_pk_bf16_f32 v28, v100, v101
    v_cvt_pk_bf16_f32 v29, v102, v103
    v_pk_mul_f32 v[108:109], v[108:109], v[186:187] op_sel_hi:[1,0]
    v_pk_mul_f32 v[110:111], v[110:111], v[186:187] op_sel_hi:[1,0]
    v_cvt_pk_bf16_f32 v30, v108, v109
    v_cvt_pk_bf16_f32 v31, v110, v111
    buffer_store_dwordx4 v[28:31], v2, s[8:11], s89 offen offset:1024 sc1
standalone__conformer_family_zipformer__speech_kernel_fin:
    s_mov_b32 s24, s4
    s_and_b32 s25, s5, 0xffff
    s_mov_b32 s26, 0x10000000
    s_mov_b32 s27, 0x20000
    s_mov_b32 s52, s6
    s_and_b32 s53, s7, 0xffff
    s_mov_b32 s54, 0x3e8000
    s_mov_b32 s55, 0x20000
    s_mov_b32 s16, s48
    s_and_b32 s17, s49, 0xffff
    s_mov_b32 s18, 0x100
    s_mov_b32 s19, 0x20000
    v_lshlrev_b32 v31, 4, v1
    s_lshl_b32 s6, s3, 15
    s_add_u32 s30, s6, 23068672
    s_add_u32 s29, s30, 0
    buffer_load_dwordx4 a[128:131], v31, s[24:27], s29 offen offset:0
    buffer_load_dwordx4 a[132:135], v31, s[24:27], s29 offen offset:1024
    buffer_load_dwordx4 a[136:139], v31, s[24:27], s29 offen offset:2048
    buffer_load_dwordx4 a[140:143], v31, s[24:27], s29 offen offset:3072
    s_add_u32 s29, s30, 4096
    buffer_load_dwordx4 a[144:147], v31, s[24:27], s29 offen offset:0
    buffer_load_dwordx4 a[148:151], v31, s[24:27], s29 offen offset:1024
    buffer_load_dwordx4 a[152:155], v31, s[24:27], s29 offen offset:2048
    buffer_load_dwordx4 a[156:159], v31, s[24:27], s29 offen offset:3072
    s_lshl_b32 s31, s65, 18
    s_add_u32 s31, s31, s30
    v_mov_b32 v21, 0
    s_lshl_b32 s44, s3, 7
    v_add_u32 v26, 65536, v31
    s_mul_i32 s29, s3, 8192
    v_add_u32 v27, s29, v26
    s_lshl_b32 s29, s3, 2
    s_add_u32 s29, s29, 98304
    v_add_u32 v29, s29, v31
    v_and_b32 v2, 15, v1
    v_lshlrev_b32 v2, 4, v2
    v_add_u32 v30, 98304, v2
    s_lshl_b32 s4, s66, 14
    s_lshl_b32 s5, s3, 12
    s_add_u32 s12, s4, s5
    s_xor_b32 s13, s12, 16384
    s_mul_i32 s45, s3, 10240
    v_min_u32 v2, 1, v1
    v_mul_i32_i24 v2, s59, v2
    v_add_u32 v2, s50, v2
    v_lshlrev_b32 v25, 7, v2
    s_cmp_ge_u32 s66, 125
    s_cselect_b32 s5, 512, 0
    s_lshl_b32 s6, s3, 7
    s_add_u32 s5, s5, s6
    s_lshl_b32 s5, s5, 7
    s_add_u32 s6, s66, s59
    s_lshr_b32 s15, s6, 5
    s_lshl_b32 s15, s15, 7
    s_and_b32 s6, s6, 31
    s_lshl_b32 s6, s6, 2
    s_add_u32 s6, s6, s15
    s_add_u32 s6, s6, s3
    s_lshl_b32 s6, s6, 7
    v_add_u32 v25, s5, v25
    v_mov_b32 v2, s6
    v_cmp_lt_u32 vcc, 1, v1
    s_nop 1
    v_cndmask_b32 v25, v25, v2, vcc
    s_mov_b32 s14, 27262976
    s_lshl_b32 s7, s3, 13
    s_add_u32 s7, s7, 65536
    s_waitcnt vmcnt(8)
    v_mov_b32 v22, 1
    buffer_store_dword v22, v21, s[24:27], s94 offen sc1
    s_cmp_ge_u32 s67, 125
    s_cbranch_scc1 standalone__conformer_family_zipformer__speech_kernel_end
    s_barrier
    s_mov_b32 s85, 0x40000
standalone__conformer_family_zipformer__speech_kernel_aw:
    buffer_load_dword v22, v25, s[24:27], s14 offen sc1
    s_waitcnt vmcnt(0)
    s_sub_u32 s85, s85, 1
    s_cbranch_scc1 standalone__conformer_family_zipformer__speech_kernel_awx
    v_cmp_eq_u32 vcc, 0, v22
    s_nop 0
    s_cmp_eq_u64 vcc, 0
    s_cbranch_scc1 standalone__conformer_family_zipformer__speech_kernel_awx
    s_mov_b64 exec, vcc
    s_sleep 2
    s_branch standalone__conformer_family_zipformer__speech_kernel_aw
standalone__conformer_family_zipformer__speech_kernel_awx:
    s_mov_b64 exec, -1
    s_add_u32 m0, s7, 0
    s_nop 0
    buffer_load_dwordx4 v31, s[24:27], s56 offen offset:0 sc1 lds
    s_add_u32 m0, s7, 3072
    s_nop 0
    buffer_load_dwordx4 v31, s[24:27], s56 offen offset:1024 sc1 lds
    s_add_u32 m0, s7, 1024
    s_nop 0
    buffer_load_dwordx4 v31, s[24:27], s57 offen offset:0 sc1 lds
    s_add_u32 m0, s7, 4096
    s_nop 0
    buffer_load_dwordx4 v31, s[24:27], s57 offen offset:1024 sc1 lds
    s_add_u32 m0, s7, 2048
    s_nop 0
    buffer_load_dwordx4 v31, s[24:27], s58 offen offset:0 sc1 lds
    s_add_u32 m0, s7, 5120
    s_nop 0
    buffer_load_dwordx4 v31, s[24:27], s58 offen offset:1024 sc1 lds
    buffer_load_dwordx4 a[224:227], v31, s[24:27], s90 offen offset:0 sc1
    buffer_load_dwordx4 a[228:231], v31, s[24:27], s90 offen offset:1024 sc1
    s_add_u32 s29, s30, 8192
    buffer_load_dwordx4 a[160:163], v31, s[24:27], s29 offen offset:0
    buffer_load_dwordx4 a[164:167], v31, s[24:27], s29 offen offset:1024
    buffer_load_dwordx4 a[168:171], v31, s[24:27], s29 offen offset:2048
    buffer_load_dwordx4 a[172:175], v31, s[24:27], s29 offen offset:3072
    s_add_u32 s29, s30, 12288
    buffer_load_dwordx4 a[176:179], v31, s[24:27], s29 offen offset:0
    buffer_load_dwordx4 a[180:183], v31, s[24:27], s29 offen offset:1024
    buffer_load_dwordx4 a[184:187], v31, s[24:27], s29 offen offset:2048
    buffer_load_dwordx4 a[188:191], v31, s[24:27], s29 offen offset:3072
    s_waitcnt vmcnt(10)
    s_barrier
    ds_read_b128 a[0:3], v26 offset:0
    ds_read_b128 a[4:7], v26 offset:1024
    ds_read_b128 a[8:11], v26 offset:2048
    s_waitcnt lgkmcnt(2)
    v_mfma_f32_16x16x32_bf16 v[64:67], a[128:131], a[0:3], 0
    s_add_u32 s28, s30, 16384
    s_add_u32 s29, s30, 24576
    ds_read_b128 a[16:19], v26 offset:4096
    s_waitcnt lgkmcnt(2)
    v_mfma_f32_16x16x32_bf16 v[68:71], a[128:131], a[4:7], 0
    s_waitcnt lgkmcnt(1)
    v_mfma_f32_16x16x32_bf16 v[72:75], a[128:131], a[8:11], 0
    buffer_load_dwordx4 a[192:195], v31, s[24:27], s28 offen offset:0
    buffer_load_dwordx4 a[128:131], v31, s[24:27], s29 offen offset:0
    v_mfma_f32_16x16x32_bf16 v[80:83], a[132:135], a[0:3], 0
    ds_read_b128 a[20:23], v26 offset:5120
    v_mfma_f32_16x16x32_bf16 v[84:87], a[132:135], a[4:7], 0
    buffer_load_dwordx4 a[196:199], v31, s[24:27], s28 offen offset:1024
    v_mfma_f32_16x16x32_bf16 v[88:91], a[132:135], a[8:11], 0
    buffer_load_dwordx4 a[132:135], v31, s[24:27], s29 offen offset:1024
    v_mfma_f32_16x16x32_bf16 v[96:99], a[136:139], a[0:3], 0
    buffer_load_dwordx4 a[200:203], v31, s[24:27], s28 offen offset:2048
    ds_read_b128 a[24:27], v26 offset:6144
    v_mfma_f32_16x16x32_bf16 v[100:103], a[136:139], a[4:7], 0
    v_and_b32 v24, 31, v1
    v_mfma_f32_16x16x32_bf16 v[104:107], a[136:139], a[8:11], 0
    buffer_load_dwordx4 a[204:207], v31, s[24:27], s28 offen offset:3072
    buffer_load_dwordx4 a[136:139], v31, s[24:27], s29 offen offset:2048
    v_mfma_f32_16x16x32_bf16 v[112:115], a[140:143], a[0:3], 0
    v_mfma_f32_16x16x32_bf16 v[116:119], a[140:143], a[4:7], 0
    v_lshlrev_b32 v24, 7, v24
    v_lshrrev_b32 v2, 4, v1
    v_mfma_f32_16x16x32_bf16 v[120:123], a[140:143], a[8:11], 0
    buffer_load_dwordx4 a[140:143], v31, s[24:27], s29 offen offset:3072
    s_waitcnt lgkmcnt(2)
    v_mfma_f32_16x16x32_bf16 v[64:67], a[144:147], a[16:19], v[64:67]
    s_add_u32 s29, s30, 28672
    ds_read_b128 a[32:35], v26 offset:8192
    s_waitcnt lgkmcnt(2)
    v_mfma_f32_16x16x32_bf16 v[68:71], a[144:147], a[20:23], v[68:71]
    s_waitcnt lgkmcnt(1)
    v_mfma_f32_16x16x32_bf16 v[72:75], a[144:147], a[24:27], v[72:75]
    buffer_load_dwordx4 a[144:147], v31, s[24:27], s29 offen offset:0
    v_mfma_f32_16x16x32_bf16 v[80:83], a[148:151], a[16:19], v[80:83]
    ds_read_b128 a[36:39], v26 offset:9216
    v_mfma_f32_16x16x32_bf16 v[84:87], a[148:151], a[20:23], v[84:87]
    v_mfma_f32_16x16x32_bf16 v[88:91], a[148:151], a[24:27], v[88:91]
    buffer_load_dwordx4 a[148:151], v31, s[24:27], s29 offen offset:1024
    v_mfma_f32_16x16x32_bf16 v[96:99], a[152:155], a[16:19], v[96:99]
    ds_read_b128 a[40:43], v26 offset:10240
    v_mfma_f32_16x16x32_bf16 v[100:103], a[152:155], a[20:23], v[100:103]
    v_bfe_u32 v3, v1, 2, 2
    v_mfma_f32_16x16x32_bf16 v[104:107], a[152:155], a[24:27], v[104:107]
    buffer_load_dwordx4 a[152:155], v31, s[24:27], s29 offen offset:2048
    v_mfma_f32_16x16x32_bf16 v[112:115], a[156:159], a[16:19], v[112:115]
    v_mfma_f32_16x16x32_bf16 v[116:119], a[156:159], a[20:23], v[116:119]
    v_cmp_eq_u32 vcc, v2, v3
    v_mfma_f32_16x16x32_bf16 v[120:123], a[156:159], a[24:27], v[120:123]
    buffer_load_dwordx4 a[156:159], v31, s[24:27], s29 offen offset:3072
    s_waitcnt vmcnt(16) lgkmcnt(2)
    v_mfma_f32_16x16x32_bf16 v[64:67], a[160:163], a[32:35], v[64:67]
    ds_read_b128 a[48:51], v26 offset:12288
    buffer_load_dword v22, v21, s[24:27], s80 offen sc1
    s_waitcnt lgkmcnt(2)
    v_mfma_f32_16x16x32_bf16 v[68:71], a[160:163], a[36:39], v[68:71]
    s_waitcnt lgkmcnt(1)
    v_mfma_f32_16x16x32_bf16 v[72:75], a[160:163], a[40:43], v[72:75]
    v_mfma_f32_16x16x32_bf16 v[80:83], a[164:167], a[32:35], v[80:83]
    ds_read_b128 a[52:55], v26 offset:13312
    v_mfma_f32_16x16x32_bf16 v[84:87], a[164:167], a[36:39], v[84:87]
    v_mfma_f32_16x16x32_bf16 v[88:91], a[164:167], a[40:43], v[88:91]
    v_mov_b32 v4, 0x3f80
    v_mfma_f32_16x16x32_bf16 v[96:99], a[168:171], a[32:35], v[96:99]
    ds_read_b128 a[56:59], v26 offset:14336
    v_mfma_f32_16x16x32_bf16 v[100:103], a[168:171], a[36:39], v[100:103]
    v_mfma_f32_16x16x32_bf16 v[104:107], a[168:171], a[40:43], v[104:107]
    v_mfma_f32_16x16x32_bf16 v[112:115], a[172:175], a[32:35], v[112:115]
    v_cndmask_b32 v4, 0, v4, vcc
    v_mfma_f32_16x16x32_bf16 v[116:119], a[172:175], a[36:39], v[116:119]
    v_mfma_f32_16x16x32_bf16 v[120:123], a[172:175], a[40:43], v[120:123]
    s_waitcnt vmcnt(13) lgkmcnt(2)
    v_and_b32 v2, 1, v1
    v_mfma_f32_16x16x32_bf16 v[64:67], a[176:179], a[48:51], v[64:67]
    s_add_u32 s28, s30, 131072
    ds_read_b128 a[64:67], v26 offset:16384
    s_waitcnt lgkmcnt(2)
    v_mfma_f32_16x16x32_bf16 v[68:71], a[176:179], a[52:55], v[68:71]
    s_waitcnt lgkmcnt(1)
    v_mfma_f32_16x16x32_bf16 v[72:75], a[176:179], a[56:59], v[72:75]
    buffer_load_dwordx4 a[160:163], v31, s[24:27], s28 offen offset:0
    v_mfma_f32_16x16x32_bf16 v[80:83], a[180:183], a[48:51], v[80:83]
    ds_read_b128 a[68:71], v26 offset:17408
    v_mfma_f32_16x16x32_bf16 v[84:87], a[180:183], a[52:55], v[84:87]
    buffer_load_dwordx4 a[164:167], v31, s[24:27], s28 offen offset:1024
    v_mfma_f32_16x16x32_bf16 v[88:91], a[180:183], a[56:59], v[88:91]
    v_mfma_f32_16x16x32_bf16 v[96:99], a[184:187], a[48:51], v[96:99]
    buffer_load_dwordx4 a[168:171], v31, s[24:27], s28 offen offset:2048
    ds_read_b128 a[72:75], v26 offset:18432
    v_mfma_f32_16x16x32_bf16 v[100:103], a[184:187], a[52:55], v[100:103]
    v_mfma_f32_16x16x32_bf16 v[104:107], a[184:187], a[56:59], v[104:107]
    buffer_load_dwordx4 a[172:175], v31, s[24:27], s28 offen offset:3072
    v_mfma_f32_16x16x32_bf16 v[112:115], a[188:191], a[48:51], v[112:115]
    v_mfma_f32_16x16x32_bf16 v[116:119], a[188:191], a[52:55], v[116:119]
    v_lshlrev_b32 v2, 4, v2
    v_mfma_f32_16x16x32_bf16 v[120:123], a[188:191], a[56:59], v[120:123]
    s_waitcnt vmcnt(11) lgkmcnt(2)
    v_lshlrev_b32 v4, v2, v4
    v_mfma_f32_16x16x32_bf16 v[64:67], a[192:195], a[64:67], v[64:67]
    s_add_u32 s28, s30, 135168
    ds_read_b128 a[80:83], v26 offset:20480
    s_waitcnt lgkmcnt(2)
    v_mfma_f32_16x16x32_bf16 v[68:71], a[192:195], a[68:71], v[68:71]
    s_waitcnt lgkmcnt(1)
    v_mfma_f32_16x16x32_bf16 v[72:75], a[192:195], a[72:75], v[72:75]
    buffer_load_dwordx4 a[176:179], v31, s[24:27], s28 offen offset:0
    v_mfma_f32_16x16x32_bf16 v[80:83], a[196:199], a[64:67], v[80:83]
    ds_read_b128 a[84:87], v26 offset:21504
    v_mfma_f32_16x16x32_bf16 v[84:87], a[196:199], a[68:71], v[84:87]
    buffer_load_dwordx4 a[180:183], v31, s[24:27], s28 offen offset:1024
    v_mfma_f32_16x16x32_bf16 v[88:91], a[196:199], a[72:75], v[88:91]
    v_and_b32 v2, 2, v1
    v_mfma_f32_16x16x32_bf16 v[96:99], a[200:203], a[64:67], v[96:99]
    buffer_load_dwordx4 a[184:187], v31, s[24:27], s28 offen offset:2048
    ds_read_b128 a[88:91], v26 offset:22528
    v_mfma_f32_16x16x32_bf16 v[100:103], a[200:203], a[68:71], v[100:103]
    v_mfma_f32_16x16x32_bf16 v[104:107], a[200:203], a[72:75], v[104:107]
    buffer_load_dwordx4 a[188:191], v31, s[24:27], s28 offen offset:3072
    v_mfma_f32_16x16x32_bf16 v[112:115], a[204:207], a[64:67], v[112:115]
    v_mfma_f32_16x16x32_bf16 v[116:119], a[204:207], a[68:71], v[116:119]
    v_cmp_eq_u32 vcc, 0, v2
    v_mfma_f32_16x16x32_bf16 v[120:123], a[204:207], a[72:75], v[120:123]
    s_waitcnt lgkmcnt(2)
    v_mov_b32 v192, 0
    v_mfma_f32_16x16x32_bf16 v[64:67], a[208:211], a[80:83], v[64:67]
    ds_read_b128 a[96:99], v26 offset:24576
    buffer_load_dword v20, v24, s[52:55], s12 offen sc1
    s_waitcnt lgkmcnt(2)
    v_mfma_f32_16x16x32_bf16 v[68:71], a[208:211], a[84:87], v[68:71]
    s_waitcnt lgkmcnt(1)
    v_mfma_f32_16x16x32_bf16 v[72:75], a[208:211], a[88:91], v[72:75]
    v_mfma_f32_16x16x32_bf16 v[80:83], a[212:215], a[80:83], v[80:83]
    ds_read_b128 a[100:103], v26 offset:25600
    v_mfma_f32_16x16x32_bf16 v[84:87], a[212:215], a[84:87], v[84:87]
    v_mfma_f32_16x16x32_bf16 v[88:91], a[212:215], a[88:91], v[88:91]
    v_mfma_f32_16x16x32_bf16 v[96:99], a[216:219], a[80:83], v[96:99]
    ds_read_b128 a[104:107], v26 offset:26624
    v_mfma_f32_16x16x32_bf16 v[100:103], a[216:219], a[84:87], v[100:103]
    v_mfma_f32_16x16x32_bf16 v[104:107], a[216:219], a[88:91], v[104:107]
    v_mov_b32 v193, 0
    v_mfma_f32_16x16x32_bf16 v[112:115], a[220:223], a[80:83], v[112:115]
    v_mfma_f32_16x16x32_bf16 v[116:119], a[220:223], a[84:87], v[116:119]
    v_cndmask_b32 v194, 0, v4, vcc
    v_mfma_f32_16x16x32_bf16 v[120:123], a[220:223], a[88:91], v[120:123]
    s_waitcnt vmcnt(14) lgkmcnt(2)
    v_mfma_f32_16x16x32_bf16 v[64:67], a[128:131], a[96:99], v[64:67]
    s_add_u32 s28, s30, 139264
    ds_read_b128 a[112:115], v26 offset:28672
    s_waitcnt lgkmcnt(2)
    v_mfma_f32_16x16x32_bf16 v[68:71], a[128:131], a[100:103], v[68:71]
    s_waitcnt lgkmcnt(1)
    v_mfma_f32_16x16x32_bf16 v[72:75], a[128:131], a[104:107], v[72:75]
    buffer_load_dwordx4 a[192:195], v31, s[24:27], s28 offen offset:0
    v_mfma_f32_16x16x32_bf16 v[80:83], a[132:135], a[96:99], v[80:83]
    ds_read_b128 a[116:119], v26 offset:29696
    v_mfma_f32_16x16x32_bf16 v[84:87], a[132:135], a[100:103], v[84:87]
    buffer_load_dwordx4 a[196:199], v31, s[24:27], s28 offen offset:1024
    v_mfma_f32_16x16x32_bf16 v[88:91], a[132:135], a[104:107], v[88:91]
    v_sub_u32 v195, v4, v194
    v_mfma_f32_16x16x32_bf16 v[96:99], a[136:139], a[96:99], v[96:99]
    buffer_load_dwordx4 a[200:203], v31, s[24:27], s28 offen offset:2048
    ds_read_b128 a[120:123], v26 offset:30720
    v_mfma_f32_16x16x32_bf16 v[100:103], a[136:139], a[100:103], v[100:103]
    v_mfma_f32_16x16x32_bf16 v[104:107], a[136:139], a[104:107], v[104:107]
    buffer_load_dwordx4 a[204:207], v31, s[24:27], s28 offen offset:3072
    v_mfma_f32_16x16x32_bf16 v[112:115], a[140:143], a[96:99], v[112:115]
    v_mfma_f32_16x16x32_bf16 v[116:119], a[140:143], a[100:103], v[116:119]
    v_mov_b32 v196, 0
    v_mfma_f32_16x16x32_bf16 v[120:123], a[140:143], a[104:107], v[120:123]
    s_waitcnt vmcnt(14) lgkmcnt(2)
    v_mov_b32 v197, 0
    v_mfma_f32_16x16x32_bf16 v[64:67], a[144:147], a[112:115], v[64:67]
    s_lshl_b32 s5, s3, 13
    s_waitcnt lgkmcnt(1)
    v_mfma_f32_16x16x32_bf16 v[68:71], a[144:147], a[116:119], v[68:71]
    s_waitcnt lgkmcnt(0)
    v_mfma_f32_16x16x32_bf16 v[72:75], a[144:147], a[120:123], v[72:75]
    v_mfma_f32_16x16x32_bf16 v[80:83], a[148:151], a[112:115], v[80:83]
    v_mfma_f32_16x16x32_bf16 v[84:87], a[148:151], a[116:119], v[84:87]
    v_mfma_f32_16x16x32_bf16 v[88:91], a[148:151], a[120:123], v[88:91]
    v_mfma_f32_16x16x32_bf16 v[96:99], a[152:155], a[112:115], v[96:99]
    v_mfma_f32_16x16x32_bf16 v[100:103], a[152:155], a[116:119], v[100:103]
    v_mfma_f32_16x16x32_bf16 v[104:107], a[152:155], a[120:123], v[104:107]
    v_add_u32 v23, s5, v31
    v_mfma_f32_16x16x32_bf16 v[112:115], a[156:159], a[112:115], v[112:115]
    v_mfma_f32_16x16x32_bf16 v[116:119], a[156:159], a[116:119], v[116:119]
    v_mfma_f32_16x16x32_bf16 v[120:123], a[156:159], a[120:123], v[120:123]
    v_mfma_f32_16x16x32_bf16 v[64:67], v[194:197], a[224:227], v[64:67]
    v_mfma_f32_16x16x32_bf16 v[68:71], v[194:197], a[232:235], v[68:71]
    v_mfma_f32_16x16x32_bf16 v[72:75], v[194:197], a[240:243], v[72:75]
    v_mfma_f32_16x16x32_bf16 v[80:83], v[192:195], a[224:227], v[80:83]
    v_mfma_f32_16x16x32_bf16 v[84:87], v[192:195], a[232:235], v[84:87]
    v_mfma_f32_16x16x32_bf16 v[88:91], v[192:195], a[240:243], v[88:91]
    v_mfma_f32_16x16x32_bf16 v[96:99], v[194:197], a[228:231], v[96:99]
    v_mfma_f32_16x16x32_bf16 v[100:103], v[194:197], a[236:239], v[100:103]
    v_mfma_f32_16x16x32_bf16 v[104:107], v[194:197], a[244:247], v[104:107]
    v_mfma_f32_16x16x32_bf16 v[112:115], v[192:195], a[228:231], v[112:115]
    v_mfma_f32_16x16x32_bf16 v[116:119], v[192:195], a[236:239], v[116:119]
    v_mfma_f32_16x16x32_bf16 v[120:123], v[192:195], a[244:247], v[120:123]
    s_add_u32 s29, s30, 143360
    v_pk_add_f32 v[192:193], v[64:65], v[66:67]
    v_pk_mul_f32 v[194:195], v[64:65], v[64:65]
    v_pk_fma_f32 v[194:195], v[66:67], v[66:67], v[194:195]
    v_pk_add_f32 v[192:193], v[192:193], v[80:81]
    v_pk_fma_f32 v[194:195], v[80:81], v[80:81], v[194:195]
    v_pk_add_f32 v[192:193], v[192:193], v[82:83]
    v_pk_fma_f32 v[194:195], v[82:83], v[82:83], v[194:195]
    v_pk_add_f32 v[192:193], v[192:193], v[96:97]
    buffer_load_dwordx4 a[208:211], v31, s[24:27], s29 offen offset:0
    v_pk_fma_f32 v[194:195], v[96:97], v[96:97], v[194:195]
    v_pk_add_f32 v[192:193], v[192:193], v[98:99]
    v_pk_fma_f32 v[194:195], v[98:99], v[98:99], v[194:195]
    v_pk_add_f32 v[192:193], v[192:193], v[112:113]
    v_pk_fma_f32 v[194:195], v[112:113], v[112:113], v[194:195]
    v_pk_add_f32 v[192:193], v[192:193], v[114:115]
    v_pk_fma_f32 v[194:195], v[114:115], v[114:115], v[194:195]
    v_pk_add_f32 v[196:197], v[68:69], v[70:71]
    v_pk_mul_f32 v[198:199], v[68:69], v[68:69]
    v_pk_fma_f32 v[198:199], v[70:71], v[70:71], v[198:199]
    v_pk_add_f32 v[196:197], v[196:197], v[84:85]
    v_pk_fma_f32 v[198:199], v[84:85], v[84:85], v[198:199]
    v_pk_add_f32 v[196:197], v[196:197], v[86:87]
    v_pk_fma_f32 v[198:199], v[86:87], v[86:87], v[198:199]
    v_pk_add_f32 v[196:197], v[196:197], v[100:101]
    v_pk_fma_f32 v[198:199], v[100:101], v[100:101], v[198:199]
    buffer_load_dwordx4 a[212:215], v31, s[24:27], s29 offen offset:1024
    v_pk_add_f32 v[196:197], v[196:197], v[102:103]
    v_pk_fma_f32 v[198:199], v[102:103], v[102:103], v[198:199]
    v_pk_add_f32 v[196:197], v[196:197], v[116:117]
    v_pk_fma_f32 v[198:199], v[116:117], v[116:117], v[198:199]
    v_pk_add_f32 v[196:197], v[196:197], v[118:119]
    v_pk_fma_f32 v[198:199], v[118:119], v[118:119], v[198:199]
    v_pk_add_f32 v[200:201], v[72:73], v[74:75]
    v_pk_mul_f32 v[202:203], v[72:73], v[72:73]
    v_pk_fma_f32 v[202:203], v[74:75], v[74:75], v[202:203]
    v_pk_add_f32 v[200:201], v[200:201], v[88:89]
    v_pk_fma_f32 v[202:203], v[88:89], v[88:89], v[202:203]
    v_pk_add_f32 v[200:201], v[200:201], v[90:91]
    v_pk_fma_f32 v[202:203], v[90:91], v[90:91], v[202:203]
    v_pk_add_f32 v[200:201], v[200:201], v[104:105]
    v_pk_fma_f32 v[202:203], v[104:105], v[104:105], v[202:203]
    v_pk_add_f32 v[200:201], v[200:201], v[106:107]
    buffer_load_dwordx4 a[216:219], v31, s[24:27], s29 offen offset:2048
    v_pk_fma_f32 v[202:203], v[106:107], v[106:107], v[202:203]
    v_pk_add_f32 v[200:201], v[200:201], v[120:121]
    v_pk_fma_f32 v[202:203], v[120:121], v[120:121], v[202:203]
    v_pk_add_f32 v[200:201], v[200:201], v[122:123]
    v_pk_fma_f32 v[202:203], v[122:123], v[122:123], v[202:203]
    v_add_f32 v192, v192, v193
    v_add_f32 v194, v194, v195
    v_add_f32 v196, v196, v197
    v_add_f32 v198, v198, v199
    v_add_f32 v200, v200, v201
    v_add_f32 v202, v202, v203
    v_permlane32_swap_b32 v192, v194
    v_permlane32_swap_b32 v196, v198
    v_permlane32_swap_b32 v200, v202
    v_add_f32 v192, v192, v194
    v_add_f32 v196, v196, v198
    buffer_load_dwordx4 a[220:223], v31, s[24:27], s29 offen offset:3072
    v_add_f32 v200, v200, v202
    v_mov_b32 v204, v200
    v_permlane16_swap_b32 v192, v196
    s_nop 0
    v_permlane16_swap_b32 v200, v204
    v_add_f32 v192, v192, v196
    ds_write_b32 v29, v192 offset:0
    v_add_f32 v200, v200, v204
    ds_write_b32 v29, v200 offset:1024
    s_waitcnt lgkmcnt(0)
    s_barrier
    ds_read_b128 v[208:211], v30 offset:0
    ds_read_b128 v[216:219], v30 offset:512
    ds_read_b128 v[212:215], v30 offset:256
    ds_read_b128 v[220:223], v30 offset:768
    ds_read_b128 v[224:227], v30 offset:1024
    ds_read_b128 v[232:235], v30 offset:1536
    s_waitcnt lgkmcnt(5)
    v_pk_add_f32 v[208:209], v[208:209], v[210:211]
    s_waitcnt lgkmcnt(4)
    v_pk_add_f32 v[216:217], v[216:217], v[218:219]
    s_waitcnt lgkmcnt(3)
    v_pk_add_f32 v[212:213], v[212:213], v[214:215]
    s_waitcnt lgkmcnt(2)
    v_pk_add_f32 v[220:221], v[220:221], v[222:223]
    s_waitcnt lgkmcnt(1)
    v_pk_add_f32 v[224:225], v[224:225], v[226:227]
    s_waitcnt lgkmcnt(0)
    v_pk_add_f32 v[232:233], v[232:233], v[234:235]
    v_add_f32 v208, v208, v209
    v_add_f32 v216, v216, v217
    v_add_f32 v212, v212, v213
    v_add_f32 v220, v220, v221
    v_add_f32 v224, v224, v225
    v_add_f32 v232, v232, v233
    v_mul_f32 v208, 0x3b800000, v208
    v_mul_f32 v216, 0x3b800000, v216
    v_mul_f32 v212, 0x3b800000, v212
    v_mul_f32 v220, 0x3b800000, v220
    v_mul_f32 v224, 0x3b800000, v224
    v_mul_f32 v232, 0x3b800000, v232
    v_fma_f32 v216, -v208, v208, v216
    v_fma_f32 v220, -v212, v212, v220
    v_fma_f32 v232, -v224, v224, v232
    v_max_f32 v216, 0, v216
    v_max_f32 v220, 0, v220
    v_max_f32 v232, 0, v232
    v_add_f32 v216, 0x3727c5ac, v216
    v_add_f32 v220, 0x3727c5ac, v220
    v_add_f32 v232, 0x3727c5ac, v232
    v_rsq_f32 v192, v216
    v_rsq_f32 v196, v220
    v_rsq_f32 v200, v232
    v_mul_f32 v192, 0xbfb8aa3b, v192
    v_mul_f32 v196, 0xbfb8aa3b, v196
    v_mul_f32 v200, 0xbfb8aa3b, v200
    v_mul_f32 v194, -v208, v192
    v_mul_f32 v198, -v212, v196
    v_mul_f32 v202, -v224, v200
    v_pk_fma_f32 v[208:209], v[64:65], v[192:193], v[194:195] op_sel_hi:[1,0,0]
    v_pk_fma_f32 v[210:211], v[66:67], v[192:193], v[194:195] op_sel_hi:[1,0,0]
    v_pk_fma_f32 v[212:213], v[80:81], v[192:193], v[194:195] op_sel_hi:[1,0,0]
    v_pk_fma_f32 v[214:215], v[82:83], v[192:193], v[194:195] op_sel_hi:[1,0,0]
    v_cvt_pk_bf16_f32 v216, v208, v209
    v_cvt_pk_bf16_f32 v217, v210, v211
    v_cvt_pk_bf16_f32 v218, v212, v213
    s_add_u32 s29, s30, 147456
    buffer_load_dwordx4 a[128:131], v31, s[24:27], s29 offen offset:0
    v_cvt_pk_bf16_f32 v219, v214, v215
    ds_write_b128 v27, v[216:219] offset:0
    v_pk_fma_f32 v[220:221], v[96:97], v[192:193], v[194:195] op_sel_hi:[1,0,0]
    v_pk_fma_f32 v[222:223], v[98:99], v[192:193], v[194:195] op_sel_hi:[1,0,0]
    v_pk_fma_f32 v[224:225], v[112:113], v[192:193], v[194:195] op_sel_hi:[1,0,0]
    v_pk_fma_f32 v[226:227], v[114:115], v[192:193], v[194:195] op_sel_hi:[1,0,0]
    v_cvt_pk_bf16_f32 v228, v220, v221
    v_cvt_pk_bf16_f32 v229, v222, v223
    v_cvt_pk_bf16_f32 v230, v224, v225
    v_cvt_pk_bf16_f32 v231, v226, v227
    ds_write_b128 v27, v[228:231] offset:4096
    v_pk_fma_f32 v[208:209], v[68:69], v[196:197], v[198:199] op_sel_hi:[1,0,0]
    v_pk_fma_f32 v[210:211], v[70:71], v[196:197], v[198:199] op_sel_hi:[1,0,0]
    v_pk_fma_f32 v[212:213], v[84:85], v[196:197], v[198:199] op_sel_hi:[1,0,0]
    buffer_load_dwordx4 a[132:135], v31, s[24:27], s29 offen offset:1024
    v_pk_fma_f32 v[214:215], v[86:87], v[196:197], v[198:199] op_sel_hi:[1,0,0]
    v_cvt_pk_bf16_f32 v216, v208, v209
    v_cvt_pk_bf16_f32 v217, v210, v211
    v_cvt_pk_bf16_f32 v218, v212, v213
    v_cvt_pk_bf16_f32 v219, v214, v215
    ds_write_b128 v27, v[216:219] offset:1024
    v_pk_fma_f32 v[220:221], v[100:101], v[196:197], v[198:199] op_sel_hi:[1,0,0]
    v_pk_fma_f32 v[222:223], v[102:103], v[196:197], v[198:199] op_sel_hi:[1,0,0]
    v_pk_fma_f32 v[224:225], v[116:117], v[196:197], v[198:199] op_sel_hi:[1,0,0]
    v_pk_fma_f32 v[226:227], v[118:119], v[196:197], v[198:199] op_sel_hi:[1,0,0]
    v_cvt_pk_bf16_f32 v228, v220, v221
    v_cvt_pk_bf16_f32 v229, v222, v223
    v_cvt_pk_bf16_f32 v230, v224, v225
    buffer_load_dwordx4 a[136:139], v31, s[24:27], s29 offen offset:2048
    v_cvt_pk_bf16_f32 v231, v226, v227
    ds_write_b128 v27, v[228:231] offset:5120
    v_pk_fma_f32 v[208:209], v[72:73], v[200:201], v[202:203] op_sel_hi:[1,0,0]
    v_pk_fma_f32 v[210:211], v[74:75], v[200:201], v[202:203] op_sel_hi:[1,0,0]
    v_pk_fma_f32 v[212:213], v[88:89], v[200:201], v[202:203] op_sel_hi:[1,0,0]
    v_pk_fma_f32 v[214:215], v[90:91], v[200:201], v[202:203] op_sel_hi:[1,0,0]
    v_cvt_pk_bf16_f32 v216, v208, v209
    v_cvt_pk_bf16_f32 v217, v210, v211
    v_cvt_pk_bf16_f32 v218, v212, v213
    v_cvt_pk_bf16_f32 v219, v214, v215
    ds_write_b128 v27, v[216:219] offset:2048
    v_pk_fma_f32 v[220:221], v[104:105], v[200:201], v[202:203] op_sel_hi:[1,0,0]
    v_pk_fma_f32 v[222:223], v[106:107], v[200:201], v[202:203] op_sel_hi:[1,0,0]
    v_pk_fma_f32 v[224:225], v[120:121], v[200:201], v[202:203] op_sel_hi:[1,0,0]
    buffer_load_dwordx4 a[140:143], v31, s[24:27], s29 offen offset:3072
    v_pk_fma_f32 v[226:227], v[122:123], v[200:201], v[202:203] op_sel_hi:[1,0,0]
    v_cvt_pk_bf16_f32 v228, v220, v221
    v_cvt_pk_bf16_f32 v229, v222, v223
    v_cvt_pk_bf16_f32 v230, v224, v225
    v_cvt_pk_bf16_f32 v231, v226, v227
    ds_write_b128 v27, v[228:231] offset:6144
    s_add_u32 s29, s30, 151552
    buffer_load_dwordx4 a[144:147], v31, s[24:27], s29 offen offset:0
    buffer_load_dwordx4 a[148:151], v31, s[24:27], s29 offen offset:1024
    v_mov_b64 v[32:33], v[68:69]
    v_mov_b64 v[34:35], v[70:71]
    v_mov_b64 v[36:37], v[72:73]
    v_mov_b64 v[38:39], v[74:75]
    v_mov_b64 v[40:41], v[84:85]
    v_mov_b64 v[42:43], v[86:87]
    v_mov_b64 v[44:45], v[88:89]
    v_mov_b64 v[46:47], v[90:91]
    v_mov_b64 v[48:49], v[100:101]
    v_mov_b64 v[50:51], v[102:103]
    v_mov_b64 v[52:53], v[104:105]
    v_mov_b64 v[54:55], v[106:107]
    v_mov_b64 v[56:57], v[116:117]
    v_mov_b64 v[58:59], v[118:119]
    v_mov_b64 v[60:61], v[120:121]
    v_mov_b64 v[62:63], v[122:123]
    buffer_load_dwordx4 a[152:155], v31, s[24:27], s29 offen offset:2048
    buffer_load_dwordx4 a[156:159], v31, s[24:27], s29 offen offset:3072
    s_waitcnt lgkmcnt(0)
    s_barrier
    ds_read_b128 a[0:3], v26 offset:0
    ds_read_b128 a[4:7], v26 offset:1024
    ds_read_b128 a[8:11], v26 offset:2048
    s_waitcnt vmcnt(21) lgkmcnt(2)
    v_mfma_f32_16x16x32_bf16 v[64:67], a[0:3], a[160:163], 0
    s_add_u32 s7, s45, 122880
    s_add_u32 s29, s30, 155648
    ds_read_b128 a[16:19], v26 offset:4096
    s_waitcnt lgkmcnt(2)
    v_mfma_f32_16x16x32_bf16 v[68:71], a[4:7], a[160:163], 0
    s_waitcnt lgkmcnt(1)
    v_lshrrev_b32 v3, 2, v1
    v_mfma_f32_16x16x32_bf16 v[72:75], a[8:11], a[160:163], 0
    buffer_load_dwordx4 a[160:163], v31, s[24:27], s29 offen offset:0
    v_mfma_f32_16x16x32_bf16 v[80:83], a[0:3], a[164:167], 0
    ds_read_b128 a[20:23], v26 offset:5120
    v_mul_u32_u24 v3, 160, v3
    v_mfma_f32_16x16x32_bf16 v[84:87], a[4:7], a[164:167], 0
    v_add_u32 v3, s7, v3
    v_and_b32 v4, 1, v1
    v_mfma_f32_16x16x32_bf16 v[88:91], a[8:11], a[164:167], 0
    buffer_load_dwordx4 a[164:167], v31, s[24:27], s29 offen offset:1024
    v_xor_b32 v4, 1, v4
    v_mfma_f32_16x16x32_bf16 v[96:99], a[0:3], a[168:171], 0
    ds_read_b128 a[24:27], v26 offset:6144
    v_mfma_f32_16x16x32_bf16 v[100:103], a[4:7], a[168:171], 0
    v_mul_u32_u24 v4, 80, v4
    v_add_u32 v3, v3, v4
    v_mfma_f32_16x16x32_bf16 v[104:107], a[8:11], a[168:171], 0
    buffer_load_dwordx4 a[168:171], v31, s[24:27], s29 offen offset:2048
    v_and_b32 v4, 2, v1
    v_mfma_f32_16x16x32_bf16 v[112:115], a[0:3], a[172:175], 0
    v_xor_b32 v4, 2, v4
    v_lshl_add_u32 v12, v4, 1, v3
    v_mfma_f32_16x16x32_bf16 v[116:119], a[4:7], a[172:175], 0
    v_add_u32 v13, 2560, v12
    v_mfma_f32_16x16x32_bf16 v[120:123], a[8:11], a[172:175], 0
    buffer_load_dwordx4 a[172:175], v31, s[24:27], s29 offen offset:3072
    v_add_u32 v14, 5120, v12
    s_waitcnt vmcnt(21) lgkmcnt(2)
    v_mfma_f32_16x16x32_bf16 v[64:67], a[16:19], a[176:179], v[64:67]
    s_add_u32 s29, s30, 159744
    ds_read_b128 a[32:35], v26 offset:8192
    s_waitcnt lgkmcnt(2)
    v_mfma_f32_16x16x32_bf16 v[68:71], a[20:23], a[176:179], v[68:71]
    s_lshl_b32 s7, s3, 13
    v_add_u32 v15, 7680, v12
    s_waitcnt lgkmcnt(1)
    v_mfma_f32_16x16x32_bf16 v[72:75], a[24:27], a[176:179], v[72:75]
    s_mul_i32 s6, s65, 12
    buffer_load_dwordx4 a[176:179], v31, s[24:27], s29 offen offset:0
    v_mfma_f32_16x16x32_bf16 v[80:83], a[16:19], a[180:183], v[80:83]
    ds_read_b128 a[36:39], v26 offset:9216
    v_mfma_f32_16x16x32_bf16 v[84:87], a[20:23], a[180:183], v[84:87]
    v_and_b32 v2, 15, v1
    v_bfe_u32 v3, v2, 1, 2
    v_mfma_f32_16x16x32_bf16 v[88:91], a[24:27], a[180:183], v[88:91]
    buffer_load_dwordx4 a[180:183], v31, s[24:27], s29 offen offset:1024
    v_lshlrev_b32 v3, 2, v3
    v_mfma_f32_16x16x32_bf16 v[96:99], a[16:19], a[184:187], v[96:99]
    ds_read_b128 a[40:43], v26 offset:10240
    v_mfma_f32_16x16x32_bf16 v[100:103], a[20:23], a[184:187], v[100:103]
    v_and_b32 v4, 1, v2
    v_add_u32 v3, v3, v4
    v_mfma_f32_16x16x32_bf16 v[104:107], a[24:27], a[184:187], v[104:107]
    buffer_load_dwordx4 a[184:187], v31, s[24:27], s29 offen offset:2048
    v_bfe_u32 v4, v2, 3, 1
    v_mfma_f32_16x16x32_bf16 v[112:115], a[16:19], a[188:191], v[112:115]
    v_lshl_add_u32 v3, v4, 1, v3
    v_lshlrev_b32 v2, 7, v2
    v_mfma_f32_16x16x32_bf16 v[116:119], a[20:23], a[188:191], v[116:119]
    v_add_u32 v2, s7, v2
    v_mfma_f32_16x16x32_bf16 v[120:123], a[24:27], a[188:191], v[120:123]
    buffer_load_dwordx4 a[188:191], v31, s[24:27], s29 offen offset:3072
    v_lshrrev_b32 v4, 4, v1
    s_waitcnt vmcnt(20) lgkmcnt(2)
    v_mfma_f32_16x16x32_bf16 v[64:67], a[32:35], a[192:195], v[64:67]
    s_add_u32 s29, s30, 262144
    ds_read_b128 a[48:51], v26 offset:12288
    s_waitcnt lgkmcnt(2)
    v_mfma_f32_16x16x32_bf16 v[68:71], a[36:39], a[192:195], v[68:71]
    s_waitcnt lgkmcnt(1)
    v_xor_b32 v3, s6, v3
    v_mfma_f32_16x16x32_bf16 v[72:75], a[40:43], a[192:195], v[72:75]
    buffer_load_dwordx4 a[192:195], v31, s[24:27], s29 offen offset:0
    v_add_u32 v5, 0, v4
    v_mfma_f32_16x16x32_bf16 v[80:83], a[32:35], a[196:199], v[80:83]
    ds_read_b128 a[52:55], v26 offset:13312
    v_xor_b32 v5, v5, v3
    v_mfma_f32_16x16x32_bf16 v[84:87], a[36:39], a[196:199], v[84:87]
    v_lshl_add_u32 v8, v5, 3, v2
    v_mfma_f32_16x16x32_bf16 v[88:91], a[40:43], a[196:199], v[88:91]
    buffer_load_dwordx4 a[196:199], v31, s[24:27], s29 offen offset:1024
    v_add_u32 v5, 4, v4
    v_mfma_f32_16x16x32_bf16 v[96:99], a[32:35], a[200:203], v[96:99]
    ds_read_b128 a[56:59], v26 offset:14336
    v_xor_b32 v5, v5, v3
    v_mfma_f32_16x16x32_bf16 v[100:103], a[36:39], a[200:203], v[100:103]
    v_lshl_add_u32 v9, v5, 3, v2
    v_mfma_f32_16x16x32_bf16 v[104:107], a[40:43], a[200:203], v[104:107]
    buffer_load_dwordx4 a[200:203], v31, s[24:27], s29 offen offset:2048
    v_add_u32 v5, 8, v4
    v_mfma_f32_16x16x32_bf16 v[112:115], a[32:35], a[204:207], v[112:115]
    v_xor_b32 v5, v5, v3
    v_lshl_add_u32 v10, v5, 3, v2
    v_mfma_f32_16x16x32_bf16 v[116:119], a[36:39], a[204:207], v[116:119]
    v_add_u32 v5, 12, v4
    v_mfma_f32_16x16x32_bf16 v[120:123], a[40:43], a[204:207], v[120:123]
    buffer_load_dwordx4 a[204:207], v31, s[24:27], s29 offen offset:3072
    v_xor_b32 v5, v5, v3
    s_waitcnt vmcnt(20) lgkmcnt(2)
    v_mfma_f32_16x16x32_bf16 v[64:67], a[48:51], a[208:211], v[64:67]
    s_add_u32 s29, s30, 266240
    ds_read_b128 a[64:67], v26 offset:16384
    s_waitcnt lgkmcnt(2)
    v_mfma_f32_16x16x32_bf16 v[68:71], a[52:55], a[208:211], v[68:71]
    s_waitcnt lgkmcnt(1)
    v_lshl_add_u32 v11, v5, 3, v2
    v_lshrrev_b32 v2, 2, v1
    v_mfma_f32_16x16x32_bf16 v[72:75], a[56:59], a[208:211], v[72:75]
    buffer_load_dwordx4 a[208:211], v31, s[24:27], s29 offen offset:0
    v_mfma_f32_16x16x32_bf16 v[80:83], a[48:51], a[212:215], v[80:83]
    ds_read_b128 a[68:71], v26 offset:17408
    v_bfe_u32 v3, v2, 1, 2
    v_mfma_f32_16x16x32_bf16 v[84:87], a[52:55], a[212:215], v[84:87]
    v_lshlrev_b32 v3, 2, v3
    v_and_b32 v4, 1, v2
    v_mfma_f32_16x16x32_bf16 v[88:91], a[56:59], a[212:215], v[88:91]
    buffer_load_dwordx4 a[212:215], v31, s[24:27], s29 offen offset:1024
    v_add_u32 v3, v3, v4
    v_mfma_f32_16x16x32_bf16 v[96:99], a[48:51], a[216:219], v[96:99]
    ds_read_b128 a[72:75], v26 offset:18432
    v_mfma_f32_16x16x32_bf16 v[100:103], a[52:55], a[216:219], v[100:103]
    v_bfe_u32 v4, v2, 3, 1
    v_lshl_add_u32 v3, v4, 1, v3
    v_mfma_f32_16x16x32_bf16 v[104:107], a[56:59], a[216:219], v[104:107]
    buffer_load_dwordx4 a[216:219], v31, s[24:27], s29 offen offset:2048
    v_lshlrev_b32 v2, 7, v2
    v_mfma_f32_16x16x32_bf16 v[112:115], a[48:51], a[220:223], v[112:115]
    v_add_u32 v2, s7, v2
    v_and_b32 v4, 3, v1
    v_mfma_f32_16x16x32_bf16 v[116:119], a[52:55], a[220:223], v[116:119]
    v_add_u32 v5, 0, v4
    v_mfma_f32_16x16x32_bf16 v[120:123], a[56:59], a[220:223], v[120:123]
    buffer_load_dwordx4 a[220:223], v31, s[24:27], s29 offen offset:3072
    v_xor_b32 v5, v5, v3
    s_waitcnt vmcnt(20) lgkmcnt(2)
    v_mfma_f32_16x16x32_bf16 v[64:67], a[64:67], a[128:131], v[64:67]
    s_add_u32 s29, s30, 270336
    ds_read_b128 a[80:83], v26 offset:20480
    s_waitcnt lgkmcnt(2)
    v_mfma_f32_16x16x32_bf16 v[68:71], a[68:71], a[128:131], v[68:71]
    s_waitcnt lgkmcnt(1)
    v_lshl_add_u32 v232, v5, 3, v2
    v_add_u32 v5, 1, v4
    v_mfma_f32_16x16x32_bf16 v[72:75], a[72:75], a[128:131], v[72:75]
    buffer_load_dwordx4 a[128:131], v31, s[24:27], s29 offen offset:0
    v_mfma_f32_16x16x32_bf16 v[80:83], a[64:67], a[132:135], v[80:83]
    ds_read_b128 a[84:87], v26 offset:21504
    v_xor_b32 v5, v5, v3
    v_mfma_f32_16x16x32_bf16 v[84:87], a[68:71], a[132:135], v[84:87]
    v_lshl_add_u32 v233, v5, 3, v2
    v_add_u32 v5, 2, v4
    v_mfma_f32_16x16x32_bf16 v[88:91], a[72:75], a[132:135], v[88:91]
    buffer_load_dwordx4 a[132:135], v31, s[24:27], s29 offen offset:1024
    v_xor_b32 v5, v5, v3
    v_mfma_f32_16x16x32_bf16 v[96:99], a[64:67], a[136:139], v[96:99]
    ds_read_b128 a[88:91], v26 offset:22528
    v_mfma_f32_16x16x32_bf16 v[100:103], a[68:71], a[136:139], v[100:103]
    v_lshl_add_u32 v234, v5, 3, v2
    v_add_u32 v5, 3, v4
    v_mfma_f32_16x16x32_bf16 v[104:107], a[72:75], a[136:139], v[104:107]
    buffer_load_dwordx4 a[136:139], v31, s[24:27], s29 offen offset:2048
    v_xor_b32 v5, v5, v3
    v_mfma_f32_16x16x32_bf16 v[112:115], a[64:67], a[140:143], v[112:115]
    v_lshl_add_u32 v235, v5, 3, v2
    v_add_u32 v5, 4, v4
    v_mfma_f32_16x16x32_bf16 v[116:119], a[68:71], a[140:143], v[116:119]
    v_xor_b32 v5, v5, v3
    v_mfma_f32_16x16x32_bf16 v[120:123], a[72:75], a[140:143], v[120:123]
    buffer_load_dwordx4 a[140:143], v31, s[24:27], s29 offen offset:3072
    v_lshl_add_u32 v236, v5, 3, v2
    s_waitcnt vmcnt(20) lgkmcnt(2)
    v_mfma_f32_16x16x32_bf16 v[64:67], a[80:83], a[144:147], v[64:67]
    s_add_u32 s29, s30, 274432
    ds_read_b128 a[96:99], v26 offset:24576
    s_waitcnt lgkmcnt(2)
    v_mfma_f32_16x16x32_bf16 v[68:71], a[84:87], a[144:147], v[68:71]
    s_waitcnt lgkmcnt(1)
    v_add_u32 v5, 5, v4
    v_xor_b32 v5, v5, v3
    v_mfma_f32_16x16x32_bf16 v[72:75], a[88:91], a[144:147], v[72:75]
    buffer_load_dwordx4 a[144:147], v31, s[24:27], s29 offen offset:0
    v_mfma_f32_16x16x32_bf16 v[80:83], a[80:83], a[148:151], v[80:83]
    ds_read_b128 a[100:103], v26 offset:25600
    v_lshl_add_u32 v237, v5, 3, v2
    v_mfma_f32_16x16x32_bf16 v[84:87], a[84:87], a[148:151], v[84:87]
    v_add_u32 v5, 6, v4
    v_xor_b32 v5, v5, v3
    v_mfma_f32_16x16x32_bf16 v[88:91], a[88:91], a[148:151], v[88:91]
    buffer_load_dwordx4 a[148:151], v31, s[24:27], s29 offen offset:1024
    v_lshl_add_u32 v238, v5, 3, v2
    v_mfma_f32_16x16x32_bf16 v[96:99], a[80:83], a[152:155], v[96:99]
    ds_read_b128 a[104:107], v26 offset:26624
    v_mfma_f32_16x16x32_bf16 v[100:103], a[84:87], a[152:155], v[100:103]
    v_add_u32 v5, 7, v4
    v_xor_b32 v5, v5, v3
    v_mfma_f32_16x16x32_bf16 v[104:107], a[88:91], a[152:155], v[104:107]
    buffer_load_dwordx4 a[152:155], v31, s[24:27], s29 offen offset:2048
    v_lshl_add_u32 v239, v5, 3, v2
    v_mfma_f32_16x16x32_bf16 v[112:115], a[80:83], a[156:159], v[112:115]
    v_add_u32 v5, 8, v4
    v_xor_b32 v5, v5, v3
    v_mfma_f32_16x16x32_bf16 v[116:119], a[84:87], a[156:159], v[116:119]
    v_lshl_add_u32 v240, v5, 3, v2
    v_mfma_f32_16x16x32_bf16 v[120:123], a[88:91], a[156:159], v[120:123]
    buffer_load_dwordx4 a[156:159], v31, s[24:27], s29 offen offset:3072
    v_add_u32 v5, 9, v4
    s_waitcnt vmcnt(20) lgkmcnt(2)
    v_mfma_f32_16x16x32_bf16 v[64:67], a[96:99], a[160:163], v[64:67]
    ds_read_b128 a[112:115], v26 offset:28672
    s_waitcnt lgkmcnt(2)
    v_mfma_f32_16x16x32_bf16 v[68:71], a[100:103], a[160:163], v[68:71]
    s_waitcnt lgkmcnt(1)
    v_xor_b32 v5, v5, v3
    v_lshl_add_u32 v241, v5, 3, v2
    v_mfma_f32_16x16x32_bf16 v[72:75], a[104:107], a[160:163], v[72:75]
    v_add_u32 v5, 10, v4
    v_mfma_f32_16x16x32_bf16 v[80:83], a[96:99], a[164:167], v[80:83]
    ds_read_b128 a[116:119], v26 offset:29696
    v_mfma_f32_16x16x32_bf16 v[84:87], a[100:103], a[164:167], v[84:87]
    v_xor_b32 v5, v5, v3
    v_mfma_f32_16x16x32_bf16 v[88:91], a[104:107], a[164:167], v[88:91]
    v_lshl_add_u32 v242, v5, 3, v2
    v_add_u32 v5, 11, v4
    v_mfma_f32_16x16x32_bf16 v[96:99], a[96:99], a[168:171], v[96:99]
    ds_read_b128 a[120:123], v26 offset:30720
    v_mfma_f32_16x16x32_bf16 v[100:103], a[100:103], a[168:171], v[100:103]
    v_xor_b32 v5, v5, v3
    v_mfma_f32_16x16x32_bf16 v[104:107], a[104:107], a[168:171], v[104:107]
    v_lshl_add_u32 v243, v5, 3, v2
    v_mfma_f32_16x16x32_bf16 v[112:115], a[96:99], a[172:175], v[112:115]
    v_add_u32 v5, 12, v4
    v_xor_b32 v5, v5, v3
    v_mfma_f32_16x16x32_bf16 v[116:119], a[100:103], a[172:175], v[116:119]
    v_lshl_add_u32 v244, v5, 3, v2
    v_mfma_f32_16x16x32_bf16 v[120:123], a[104:107], a[172:175], v[120:123]
    s_lshl_b32 s7, s3, 12
    s_waitcnt vmcnt(16) lgkmcnt(2)
    v_mfma_f32_16x16x32_bf16 v[64:67], a[112:115], a[176:179], v[64:67]
    s_add_u32 s7, s7, 65536
    s_lshl_b32 s6, s65, 5
    s_waitcnt lgkmcnt(1)
    v_mfma_f32_16x16x32_bf16 v[68:71], a[116:119], a[176:179], v[68:71]
    s_waitcnt lgkmcnt(0)
    v_mfma_f32_16x16x32_bf16 v[72:75], a[120:123], a[176:179], v[72:75]
    v_lshrrev_b32 v2, 2, v1
    v_mfma_f32_16x16x32_bf16 v[80:83], a[112:115], a[180:183], v[80:83]
    v_lshlrev_b32 v2, 6, v2
    v_mfma_f32_16x16x32_bf16 v[84:87], a[116:119], a[180:183], v[84:87]
    v_and_b32 v3, 3, v1
    v_mfma_f32_16x16x32_bf16 v[88:91], a[120:123], a[180:183], v[88:91]
    v_lshl_add_u32 v2, v3, 3, v2
    v_bfe_u32 v3, v1, 4, 1
    v_mfma_f32_16x16x32_bf16 v[96:99], a[112:115], a[184:187], v[96:99]
    v_lshl_add_u32 v2, v3, 5, v2
    v_mfma_f32_16x16x32_bf16 v[100:103], a[116:119], a[184:187], v[100:103]
    v_add_u32 v16, s7, v2
    v_mfma_f32_16x16x32_bf16 v[104:107], a[120:123], a[184:187], v[104:107]
    v_xor_b32 v17, 32, v16
    v_mfma_f32_16x16x32_bf16 v[112:115], a[112:115], a[188:191], v[112:115]
    v_xor_b32 v2, s6, v2
    v_mfma_f32_16x16x32_bf16 v[116:119], a[116:119], a[188:191], v[116:119]
    v_add_u32 v18, 65536, v2
    v_mfma_f32_16x16x32_bf16 v[120:123], a[120:123], a[188:191], v[120:123]
    s_mov_b32 s85, 0x40000
    v_xor_b32 v19, 32, v18
    v_readfirstlane_b32 s84, v22
    s_nop 0
    s_cmp_ge_u32 s84, 2
    s_cbranch_scc1 standalone__conformer_family_zipformer__speech_kernel_spinv21_1x
standalone__conformer_family_zipformer__speech_kernel_spinv21_1:
    buffer_load_dword v22, v21, s[24:27], s80 offen sc1
    s_waitcnt vmcnt(0)
    s_sub_u32 s85, s85, 1
    s_cbranch_scc1 standalone__conformer_family_zipformer__speech_kernel_spinv21_1x
    v_readfirstlane_b32 s84, v22
    s_nop 0
    s_cmp_ge_u32 s84, 2
    s_cbranch_scc0 standalone__conformer_family_zipformer__speech_kernel_spinv21_1
standalone__conformer_family_zipformer__speech_kernel_spinv21_1x:
    s_barrier
    s_waitcnt vmcnt(12)
    v_mfma_f32_16x16x32_bf16 v[128:131], a[0:3], a[192:195], 0
    s_add_u32 s28, s30, 278528
    ds_read2_b32 v[192:193], v12 offset0:0 offset1:1
    v_mfma_f32_16x16x32_bf16 v[132:135], a[4:7], a[192:195], 0
    buffer_load_dwordx4 a[160:163], v31, s[24:27], s28 offen offset:0
    v_exp_f32 v64, v64
    v_mfma_f32_16x16x32_bf16 v[136:139], a[8:11], a[192:195], 0
    buffer_load_dwordx4 a[164:167], v31, s[24:27], s28 offen offset:1024
    ds_read2_b32 v[194:195], v12 offset0:2 offset1:3
    v_exp_f32 v65, v65
    v_mfma_f32_16x16x32_bf16 v[144:147], a[0:3], a[196:199], 0
    buffer_load_dwordx4 a[168:171], v31, s[24:27], s28 offen offset:2048
    v_exp_f32 v66, v66
    v_mfma_f32_16x16x32_bf16 v[148:151], a[4:7], a[196:199], 0
    buffer_load_dwordx4 a[172:175], v31, s[24:27], s28 offen offset:3072
    v_exp_f32 v67, v67
    v_mfma_f32_16x16x32_bf16 v[152:155], a[8:11], a[196:199], 0
    s_add_u32 s28, s30, 282624
    ds_read2_b32 v[196:197], v12 offset0:4 offset1:5
    v_add_f32 v64, 1.0, v64
    v_mfma_f32_16x16x32_bf16 v[160:163], a[0:3], a[200:203], 0
    buffer_load_dwordx4 a[176:179], v31, s[24:27], s28 offen offset:0
    v_add_f32 v65, 1.0, v65
    v_mfma_f32_16x16x32_bf16 v[164:167], a[4:7], a[200:203], 0
    buffer_load_dwordx4 a[180:183], v31, s[24:27], s28 offen offset:1024
    v_add_f32 v66, 1.0, v66
    v_add_f32 v67, 1.0, v67
    v_mfma_f32_16x16x32_bf16 v[168:171], a[8:11], a[200:203], 0
    buffer_load_dwordx4 a[184:187], v31, s[24:27], s28 offen offset:2048
    ds_read2_b32 v[198:199], v12 offset0:6 offset1:7
    v_rcp_f32 v64, v64
    v_mfma_f32_16x16x32_bf16 v[176:179], a[0:3], a[204:207], 0
    buffer_load_dwordx4 a[188:191], v31, s[24:27], s28 offen offset:3072
    v_rcp_f32 v65, v65
    v_mfma_f32_16x16x32_bf16 v[180:183], a[4:7], a[204:207], 0
    v_rcp_f32 v66, v66
    v_mfma_f32_16x16x32_bf16 v[184:187], a[8:11], a[204:207], 0
    s_waitcnt vmcnt(16)
    v_rcp_f32 v67, v67
    v_mul_f32 v96, v96, v64
    v_mfma_f32_16x16x32_bf16 v[128:131], a[16:19], a[208:211], v[128:131]
    s_add_u32 s28, s30, 286720
    ds_read2_b32 v[200:201], v12 offset0:8 offset1:9
    v_mul_f32 v97, v97, v65
    v_mfma_f32_16x16x32_bf16 v[132:135], a[20:23], a[208:211], v[132:135]
    v_mul_f32 v98, v98, v66
    v_mul_f32 v99, v99, v67
    v_mfma_f32_16x16x32_bf16 v[136:139], a[24:27], a[208:211], v[136:139]
    buffer_load_dwordx4 a[192:195], v31, s[24:27], s28 offen offset:0
    ds_read2_b32 v[202:203], v12 offset0:10 offset1:11
    v_cvt_pk_bf16_f32 v96, v96, v97
    v_mfma_f32_16x16x32_bf16 v[144:147], a[16:19], a[212:215], v[144:147]
    v_cvt_pk_bf16_f32 v97, v98, v99
    v_and_b32 v96, s60, v96
    v_mfma_f32_16x16x32_bf16 v[148:151], a[20:23], a[212:215], v[148:151]
    buffer_load_dwordx4 a[196:199], v31, s[24:27], s28 offen offset:1024
    ds_read2_b32 v[204:205], v12 offset0:12 offset1:13
    v_and_b32 v97, s60, v97
    v_mfma_f32_16x16x32_bf16 v[152:155], a[24:27], a[212:215], v[152:155]
    ds_write_b64 v8, v[96:97] offset:0
    v_exp_f32 v80, v80
    v_mfma_f32_16x16x32_bf16 v[160:163], a[16:19], a[216:219], v[160:163]
    buffer_load_dwordx4 a[200:203], v31, s[24:27], s28 offen offset:2048
    ds_read2_b32 v[206:207], v12 offset0:14 offset1:15
    v_mfma_f32_16x16x32_bf16 v[164:167], a[20:23], a[216:219], v[164:167]
    v_exp_f32 v81, v81
    v_mfma_f32_16x16x32_bf16 v[168:171], a[24:27], a[216:219], v[168:171]
    buffer_load_dwordx4 a[204:207], v31, s[24:27], s28 offen offset:3072
    ds_read2_b32 v[208:209], v12 offset0:16 offset1:17
    v_mfma_f32_16x16x32_bf16 v[176:179], a[16:19], a[220:223], v[176:179]
    v_exp_f32 v82, v82
    v_exp_f32 v83, v83
    v_mfma_f32_16x16x32_bf16 v[180:183], a[20:23], a[220:223], v[180:183]
    v_add_f32 v80, 1.0, v80
    v_add_f32 v81, 1.0, v81
    v_mfma_f32_16x16x32_bf16 v[184:187], a[24:27], a[220:223], v[184:187]
    s_waitcnt vmcnt(16)
    v_add_f32 v82, 1.0, v82
    v_add_f32 v83, 1.0, v83
    v_mfma_f32_16x16x32_bf16 v[128:131], a[32:35], a[128:131], v[128:131]
    s_add_u32 s28, s30, 290816
    ds_read2_b32 v[210:211], v13 offset0:0 offset1:1
    v_mfma_f32_16x16x32_bf16 v[132:135], a[36:39], a[128:131], v[132:135]
    v_rcp_f32 v80, v80
    v_rcp_f32 v81, v81
    v_mfma_f32_16x16x32_bf16 v[136:139], a[40:43], a[128:131], v[136:139]
    buffer_load_dwordx4 a[208:211], v31, s[24:27], s28 offen offset:0
    ds_read2_b32 v[212:213], v13 offset0:2 offset1:3
    v_mfma_f32_16x16x32_bf16 v[144:147], a[32:35], a[132:135], v[144:147]
    v_rcp_f32 v82, v82
    v_mfma_f32_16x16x32_bf16 v[148:151], a[36:39], a[132:135], v[148:151]
    buffer_load_dwordx4 a[212:215], v31, s[24:27], s28 offen offset:1024
    v_rcp_f32 v83, v83
    v_mfma_f32_16x16x32_bf16 v[152:155], a[40:43], a[132:135], v[152:155]
    ds_read2_b32 v[214:215], v13 offset0:4 offset1:5
    v_mul_f32 v112, v112, v80
    v_mfma_f32_16x16x32_bf16 v[160:163], a[32:35], a[136:139], v[160:163]
    buffer_load_dwordx4 a[216:219], v31, s[24:27], s28 offen offset:2048
    v_mul_f32 v113, v113, v81
    v_mul_f32 v114, v114, v82
    v_mfma_f32_16x16x32_bf16 v[164:167], a[36:39], a[136:139], v[164:167]
    v_mul_f32 v115, v115, v83
    v_cvt_pk_bf16_f32 v112, v112, v113
    v_mfma_f32_16x16x32_bf16 v[168:171], a[40:43], a[136:139], v[168:171]
    buffer_load_dwordx4 a[220:223], v31, s[24:27], s28 offen offset:3072
    ds_read2_b32 v[216:217], v13 offset0:6 offset1:7
    v_cvt_pk_bf16_f32 v113, v114, v115
    v_mfma_f32_16x16x32_bf16 v[176:179], a[32:35], a[140:143], v[176:179]
    v_and_b32 v112, s60, v112
    v_and_b32 v113, s60, v113
    v_mfma_f32_16x16x32_bf16 v[180:183], a[36:39], a[140:143], v[180:183]
    ds_write_b64 v8, v[112:113] offset:2048
    v_exp_f32 v68, v68
    v_mfma_f32_16x16x32_bf16 v[184:187], a[40:43], a[140:143], v[184:187]
    s_waitcnt vmcnt(16)
    v_exp_f32 v69, v69
    v_mfma_f32_16x16x32_bf16 v[128:131], a[48:51], a[144:147], v[128:131]
    ds_read2_b32 v[218:219], v13 offset0:8 offset1:9
    v_exp_f32 v70, v70
    v_mfma_f32_16x16x32_bf16 v[132:135], a[52:55], a[144:147], v[132:135]
    v_exp_f32 v71, v71
    v_mfma_f32_16x16x32_bf16 v[136:139], a[56:59], a[144:147], v[136:139]
    ds_read2_b32 v[220:221], v13 offset0:10 offset1:11
    v_add_f32 v68, 1.0, v68
    v_mfma_f32_16x16x32_bf16 v[144:147], a[48:51], a[148:151], v[144:147]
    v_add_f32 v69, 1.0, v69
    v_add_f32 v70, 1.0, v70
    v_mfma_f32_16x16x32_bf16 v[148:151], a[52:55], a[148:151], v[148:151]
    ds_read2_b32 v[222:223], v13 offset0:12 offset1:13
    v_add_f32 v71, 1.0, v71
    v_mfma_f32_16x16x32_bf16 v[152:155], a[56:59], a[148:151], v[152:155]
    v_rcp_f32 v68, v68
    v_mfma_f32_16x16x32_bf16 v[160:163], a[48:51], a[152:155], v[160:163]
    ds_read2_b32 v[224:225], v13 offset0:14 offset1:15
    v_rcp_f32 v69, v69
    v_mfma_f32_16x16x32_bf16 v[164:167], a[52:55], a[152:155], v[164:167]
    v_rcp_f32 v70, v70
    v_mfma_f32_16x16x32_bf16 v[168:171], a[56:59], a[152:155], v[168:171]
    ds_read2_b32 v[226:227], v13 offset0:16 offset1:17
    v_mfma_f32_16x16x32_bf16 v[176:179], a[48:51], a[156:159], v[176:179]
    v_rcp_f32 v71, v71
    v_mul_f32 v100, v100, v68
    v_mfma_f32_16x16x32_bf16 v[180:183], a[52:55], a[156:159], v[180:183]
    v_mul_f32 v101, v101, v69
    v_mul_f32 v102, v102, v70
    v_mfma_f32_16x16x32_bf16 v[184:187], a[56:59], a[156:159], v[184:187]
    s_waitcnt vmcnt(12)
    v_mul_f32 v103, v103, v71
    v_cvt_pk_bf16_f32 v100, v100, v101
    v_mfma_f32_16x16x32_bf16 v[128:131], a[64:67], a[160:163], v[128:131]
    s_add_u32 s28, s30, 393216
    ds_read2_b32 v[228:229], v14 offset0:0 offset1:1
    v_mfma_f32_16x16x32_bf16 v[132:135], a[68:71], a[160:163], v[132:135]
    v_cvt_pk_bf16_f32 v101, v102, v103
    v_mfma_f32_16x16x32_bf16 v[136:139], a[72:75], a[160:163], v[136:139]
    ds_write_b64 v9, v[100:101] offset:0
    buffer_load_dwordx4 a[128:131], v31, s[24:27], s28 offen offset:0
    ds_read2_b32 v[230:231], v14 offset0:2 offset1:3
    v_exp_f32 v84, v84
    v_mfma_f32_16x16x32_bf16 v[144:147], a[64:67], a[164:167], v[144:147]
    v_exp_f32 v85, v85
    v_mfma_f32_16x16x32_bf16 v[148:151], a[68:71], a[164:167], v[148:151]
    buffer_load_dwordx4 a[132:135], v31, s[24:27], s28 offen offset:1024
    v_exp_f32 v86, v86
    v_mfma_f32_16x16x32_bf16 v[152:155], a[72:75], a[164:167], v[152:155]
    ds_read2_b32 a[224:225], v14 offset0:4 offset1:5
    v_mfma_f32_16x16x32_bf16 v[160:163], a[64:67], a[168:171], v[160:163]
    buffer_load_dwordx4 a[136:139], v31, s[24:27], s28 offen offset:2048
    v_exp_f32 v87, v87
    v_mfma_f32_16x16x32_bf16 v[164:167], a[68:71], a[168:171], v[164:167]
    v_add_f32 v84, 1.0, v84
    v_add_f32 v85, 1.0, v85
    v_mfma_f32_16x16x32_bf16 v[168:171], a[72:75], a[168:171], v[168:171]
    buffer_load_dwordx4 a[140:143], v31, s[24:27], s28 offen offset:3072
    ds_read2_b32 a[226:227], v14 offset0:6 offset1:7
    v_add_f32 v86, 1.0, v86
    v_mfma_f32_16x16x32_bf16 v[176:179], a[64:67], a[172:175], v[176:179]
    v_add_f32 v87, 1.0, v87
    v_rcp_f32 v84, v84
    v_mfma_f32_16x16x32_bf16 v[180:183], a[68:71], a[172:175], v[180:183]
    v_rcp_f32 v85, v85
    v_mfma_f32_16x16x32_bf16 v[184:187], a[72:75], a[172:175], v[184:187]
    s_waitcnt vmcnt(12)
    v_rcp_f32 v86, v86
    v_mfma_f32_16x16x32_bf16 v[128:131], a[80:83], a[176:179], v[128:131]
    ds_read2_b32 a[228:229], v14 offset0:8 offset1:9
    v_rcp_f32 v87, v87
    v_mfma_f32_16x16x32_bf16 v[132:135], a[84:87], a[176:179], v[132:135]
    v_mul_f32 v116, v116, v84
    v_mfma_f32_16x16x32_bf16 v[136:139], a[88:91], a[176:179], v[136:139]
    ds_read2_b32 a[230:231], v14 offset0:10 offset1:11
    v_mul_f32 v117, v117, v85
    v_mul_f32 v118, v118, v86
    v_mfma_f32_16x16x32_bf16 v[144:147], a[80:83], a[180:183], v[144:147]
    v_mul_f32 v119, v119, v87
    v_cvt_pk_bf16_f32 v116, v116, v117
    v_mfma_f32_16x16x32_bf16 v[148:151], a[84:87], a[180:183], v[148:151]
    ds_read2_b32 a[232:233], v14 offset0:12 offset1:13
    v_cvt_pk_bf16_f32 v117, v118, v119
    v_mfma_f32_16x16x32_bf16 v[152:155], a[88:91], a[180:183], v[152:155]
    ds_write_b64 v9, v[116:117] offset:2048
    v_exp_f32 v72, v72
    v_mfma_f32_16x16x32_bf16 v[160:163], a[80:83], a[184:187], v[160:163]
    ds_read2_b32 a[234:235], v14 offset0:14 offset1:15
    v_mfma_f32_16x16x32_bf16 v[164:167], a[84:87], a[184:187], v[164:167]
    v_exp_f32 v73, v73
    v_mfma_f32_16x16x32_bf16 v[168:171], a[88:91], a[184:187], v[168:171]
    ds_read2_b32 a[236:237], v14 offset0:16 offset1:17
    v_exp_f32 v74, v74
    v_mfma_f32_16x16x32_bf16 v[176:179], a[80:83], a[188:191], v[176:179]
    v_exp_f32 v75, v75
    v_mfma_f32_16x16x32_bf16 v[180:183], a[84:87], a[188:191], v[180:183]
    v_add_f32 v72, 1.0, v72
    v_add_f32 v73, 1.0, v73
    v_mfma_f32_16x16x32_bf16 v[184:187], a[88:91], a[188:191], v[184:187]
    s_waitcnt vmcnt(8)
    v_add_f32 v74, 1.0, v74
    v_add_f32 v75, 1.0, v75
    v_mfma_f32_16x16x32_bf16 v[128:131], a[96:99], a[192:195], v[128:131]
    s_add_u32 s28, s30, 397312
    ds_read2_b32 a[238:239], v15 offset0:0 offset1:1
    v_mfma_f32_16x16x32_bf16 v[132:135], a[100:103], a[192:195], v[132:135]
    v_rcp_f32 v72, v72
    v_rcp_f32 v73, v73
    v_mfma_f32_16x16x32_bf16 v[136:139], a[104:107], a[192:195], v[136:139]
    buffer_load_dwordx4 a[144:147], v31, s[24:27], s28 offen offset:0
    ds_read2_b32 a[240:241], v15 offset0:2 offset1:3
    v_mfma_f32_16x16x32_bf16 v[144:147], a[96:99], a[196:199], v[144:147]
    v_rcp_f32 v74, v74
    v_mfma_f32_16x16x32_bf16 v[148:151], a[100:103], a[196:199], v[148:151]
    buffer_load_dwordx4 a[148:151], v31, s[24:27], s28 offen offset:1024
    v_rcp_f32 v75, v75
    v_mfma_f32_16x16x32_bf16 v[152:155], a[104:107], a[196:199], v[152:155]
    ds_read2_b32 a[242:243], v15 offset0:4 offset1:5
    v_mul_f32 v104, v104, v72
    v_mfma_f32_16x16x32_bf16 v[160:163], a[96:99], a[200:203], v[160:163]
    buffer_load_dwordx4 a[152:155], v31, s[24:27], s28 offen offset:2048
    v_mul_f32 v105, v105, v73
    v_mul_f32 v106, v106, v74
    v_mfma_f32_16x16x32_bf16 v[164:167], a[100:103], a[200:203], v[164:167]
    v_mul_f32 v107, v107, v75
    v_cvt_pk_bf16_f32 v76, v104, v105
    v_mfma_f32_16x16x32_bf16 v[168:171], a[104:107], a[200:203], v[168:171]
    buffer_load_dwordx4 a[156:159], v31, s[24:27], s28 offen offset:3072
    ds_read2_b32 a[244:245], v15 offset0:6 offset1:7
    v_cvt_pk_bf16_f32 v77, v106, v107
    v_mfma_f32_16x16x32_bf16 v[176:179], a[96:99], a[204:207], v[176:179]
    ds_write_b64 v10, v[76:77] offset:0
    v_exp_f32 v88, v88
    v_mfma_f32_16x16x32_bf16 v[180:183], a[100:103], a[204:207], v[180:183]
    v_exp_f32 v89, v89
    v_mfma_f32_16x16x32_bf16 v[184:187], a[104:107], a[204:207], v[184:187]
    s_waitcnt vmcnt(8)
    v_exp_f32 v90, v90
    v_mfma_f32_16x16x32_bf16 v[128:131], a[112:115], a[208:211], v[128:131]
    ds_read2_b32 a[246:247], v15 offset0:8 offset1:9
    v_exp_f32 v91, v91
    v_mfma_f32_16x16x32_bf16 v[132:135], a[116:119], a[208:211], v[132:135]
    v_add_f32 v88, 1.0, v88
    v_mfma_f32_16x16x32_bf16 v[136:139], a[120:123], a[208:211], v[136:139]
    ds_read2_b32 a[248:249], v15 offset0:10 offset1:11
    v_add_f32 v89, 1.0, v89
    v_add_f32 v90, 1.0, v90
    v_mfma_f32_16x16x32_bf16 v[144:147], a[112:115], a[212:215], v[144:147]
    v_add_f32 v91, 1.0, v91
    v_mfma_f32_16x16x32_bf16 v[148:151], a[116:119], a[212:215], v[148:151]
    ds_read2_b32 a[250:251], v15 offset0:12 offset1:13
    v_rcp_f32 v88, v88
    v_mfma_f32_16x16x32_bf16 v[152:155], a[120:123], a[212:215], v[152:155]
    v_rcp_f32 v89, v89
    v_mfma_f32_16x16x32_bf16 v[160:163], a[112:115], a[216:219], v[160:163]
    ds_read2_b32 a[252:253], v15 offset0:14 offset1:15
    v_rcp_f32 v90, v90
    v_mfma_f32_16x16x32_bf16 v[164:167], a[116:119], a[216:219], v[164:167]
    v_rcp_f32 v91, v91
    v_mfma_f32_16x16x32_bf16 v[168:171], a[120:123], a[216:219], v[168:171]
    ds_read2_b32 a[254:255], v15 offset0:16 offset1:17
    v_mul_f32 v120, v120, v88
    v_mfma_f32_16x16x32_bf16 v[176:179], a[112:115], a[220:223], v[176:179]
    v_mul_f32 v121, v121, v89
    v_mul_f32 v122, v122, v90
    v_mfma_f32_16x16x32_bf16 v[180:183], a[116:119], a[220:223], v[180:183]
    v_mul_f32 v123, v123, v91
    v_cvt_pk_bf16_f32 v78, v120, v121
    v_mfma_f32_16x16x32_bf16 v[184:187], a[120:123], a[220:223], v[184:187]
    v_cvt_pk_bf16_f32 v79, v122, v123
    ds_write_b64 v10, v[78:79] offset:2048
    v_exp_f32 v136, v136
    v_exp_f32 v137, v137
    v_exp_f32 v138, v138
    v_exp_f32 v139, v139
    v_pk_add_f32 v[136:137], v[136:137], 1.0 op_sel_hi:[1,0]
    v_pk_add_f32 v[138:139], v[138:139], 1.0 op_sel_hi:[1,0]
    v_rcp_f32 v136, v136
    v_rcp_f32 v137, v137
    v_rcp_f32 v138, v138
    v_rcp_f32 v139, v139
    v_pk_mul_f32 v[168:169], v[168:169], v[136:137]
    v_pk_mul_f32 v[170:171], v[170:171], v[138:139]
    v_cvt_pk_bf16_f32 v140, v168, v169
    v_cvt_pk_bf16_f32 v141, v170, v171
    v_exp_f32 v152, v152
    v_exp_f32 v153, v153
    v_exp_f32 v154, v154
    v_exp_f32 v155, v155
    v_pk_add_f32 v[152:153], v[152:153], 1.0 op_sel_hi:[1,0]
    v_pk_add_f32 v[154:155], v[154:155], 1.0 op_sel_hi:[1,0]
    v_rcp_f32 v152, v152
    v_rcp_f32 v153, v153
    v_rcp_f32 v154, v154
    v_rcp_f32 v155, v155
    v_pk_mul_f32 v[184:185], v[184:185], v[152:153]
    v_pk_mul_f32 v[186:187], v[186:187], v[154:155]
    v_cvt_pk_bf16_f32 v142, v184, v185
    v_cvt_pk_bf16_f32 v143, v186, v187
    s_cmp_eq_u32 s83, 0
    s_cbranch_scc1 standalone__conformer_family_zipformer__speech_kernel_sndv21_2s
    buffer_store_dwordx4 v[76:79], v31, s[52:55], s13 offen offset:0
    buffer_store_dwordx4 v[140:143], v31, s[52:55], s13 offen offset:1024
    s_branch standalone__conformer_family_zipformer__speech_kernel_sndv21_2e
standalone__conformer_family_zipformer__speech_kernel_sndv21_2s:
    buffer_store_dwordx4 v[76:79], v31, s[52:55], s13 offen offset:0 sc1
    buffer_store_dwordx4 v[140:143], v31, s[52:55], s13 offen offset:1024 sc1
standalone__conformer_family_zipformer__speech_kernel_sndv21_2e:
    ds_write_b64 v10, v[140:141] offset:4096
    ds_write_b64 v10, v[142:143] offset:6144
    v_exp_f32 v128, v128
    v_exp_f32 v129, v129
    v_exp_f32 v130, v130
    v_exp_f32 v131, v131
    v_pk_add_f32 v[128:129], v[128:129], 1.0 op_sel_hi:[1,0]
    v_pk_add_f32 v[130:131], v[130:131], 1.0 op_sel_hi:[1,0]
    v_rcp_f32 v128, v128
    v_rcp_f32 v129, v129
    v_rcp_f32 v130, v130
    v_rcp_f32 v131, v131
    v_pk_mul_f32 v[160:161], v[160:161], v[128:129]
    v_pk_mul_f32 v[162:163], v[162:163], v[130:131]
    v_cvt_pk_bf16_f32 v160, v160, v161
    v_cvt_pk_bf16_f32 v161, v162, v163
    v_and_b32 v160, s60, v160
    v_and_b32 v161, s60, v161
    v_exp_f32 v144, v144
    v_exp_f32 v145, v145
    v_exp_f32 v146, v146
    v_exp_f32 v147, v147
    v_pk_add_f32 v[144:145], v[144:145], 1.0 op_sel_hi:[1,0]
    v_pk_add_f32 v[146:147], v[146:147], 1.0 op_sel_hi:[1,0]
    v_rcp_f32 v144, v144
    v_rcp_f32 v145, v145
    v_rcp_f32 v146, v146
    v_rcp_f32 v147, v147
    v_pk_mul_f32 v[176:177], v[176:177], v[144:145]
    v_pk_mul_f32 v[178:179], v[178:179], v[146:147]
    v_cvt_pk_bf16_f32 v176, v176, v177
    v_cvt_pk_bf16_f32 v177, v178, v179
    v_and_b32 v176, s60, v176
    v_and_b32 v177, s60, v177
    v_exp_f32 v132, v132
    v_exp_f32 v133, v133
    v_exp_f32 v134, v134
    v_exp_f32 v135, v135
    v_pk_add_f32 v[132:133], v[132:133], 1.0 op_sel_hi:[1,0]
    buffer_load_dwordx4 v[156:159], v31, s[52:55], s12 offen offset:0 sc1
    buffer_load_dwordx4 v[172:175], v31, s[52:55], s12 offen offset:1024 sc1
    v_pk_add_f32 v[134:135], v[134:135], 1.0 op_sel_hi:[1,0]
    v_rcp_f32 v132, v132
    v_rcp_f32 v133, v133
    v_rcp_f32 v134, v134
    v_rcp_f32 v135, v135
    v_pk_mul_f32 v[164:165], v[164:165], v[132:133]
    v_pk_mul_f32 v[166:167], v[166:167], v[134:135]
    v_cvt_pk_bf16_f32 v164, v164, v165
    v_cvt_pk_bf16_f32 v165, v166, v167
    v_exp_f32 v148, v148
    v_exp_f32 v149, v149
    v_exp_f32 v150, v150
    v_exp_f32 v151, v151
    v_pk_add_f32 v[148:149], v[148:149], 1.0 op_sel_hi:[1,0]
    v_pk_add_f32 v[150:151], v[150:151], 1.0 op_sel_hi:[1,0]
    v_rcp_f32 v148, v148
    v_rcp_f32 v149, v149
    v_rcp_f32 v150, v150
    v_rcp_f32 v151, v151
    v_pk_mul_f32 v[180:181], v[180:181], v[148:149]
    v_pk_mul_f32 v[182:183], v[182:183], v[150:151]
    v_cvt_pk_bf16_f32 v180, v180, v181
    v_cvt_pk_bf16_f32 v181, v182, v183
    ds_write_b64 v8, v[160:161] offset:4096
    ds_write_b64 v8, v[176:177] offset:6144
    ds_write_b64 v9, v[164:165] offset:4096
    ds_write_b64 v9, v[180:181] offset:6144
    s_mov_b32 s85, 0x40000
    s_waitcnt vmcnt(0)
    s_branch standalone__conformer_family_zipformer__speech_kernel_rcvv21_3c
standalone__conformer_family_zipformer__speech_kernel_rcvv21_3:
    buffer_load_dwordx4 v[156:159], v31, s[52:55], s12 offen offset:0 sc1
    buffer_load_dwordx4 v[172:175], v31, s[52:55], s12 offen offset:1024 sc1
standalone__conformer_family_zipformer__speech_kernel_rcvv21_3c:
    s_waitcnt vmcnt(1)
    v_max3_u32 v20, v156, v157, v158
    s_waitcnt vmcnt(0)
    v_max3_u32 v20, v20, v159, v172
    v_max3_u32 v20, v20, v173, v174
    v_max_u32 v20, v20, v175
    s_sub_u32 s85, s85, 1
    s_cbranch_scc1 standalone__conformer_family_zipformer__speech_kernel_rcvv21_3x
    v_cmp_eq_u32 vcc, -1, v20
    s_nop 0
    s_cmp_lg_u64 vcc, 0
    s_cbranch_scc1 standalone__conformer_family_zipformer__speech_kernel_rcvv21_3
standalone__conformer_family_zipformer__speech_kernel_rcvv21_3x:
    v_and_b32 v156, s61, v156
    v_and_b32 v157, s61, v157
    v_and_b32 v158, s61, v158
    v_and_b32 v159, s61, v159
    v_and_b32 v172, s61, v172
    v_and_b32 v173, s61, v173
    v_and_b32 v174, s61, v174
    v_and_b32 v175, s61, v175
    ds_write_b64 v11, v[156:157] offset:0
    ds_write_b64 v11, v[158:159] offset:2048
    ds_write_b64 v11, v[172:173] offset:4096
    ds_write_b64 v11, v[174:175] offset:6144
    v_mov_b32 v188, -1
    v_mov_b32 v189, -1
    v_mov_b32 v190, -1
    v_mov_b32 v191, -1
    s_cmp_eq_u32 s83, 0
    s_cbranch_scc1 standalone__conformer_family_zipformer__speech_kernel_sndv21_4s
    buffer_store_dwordx4 v[188:191], v31, s[52:55], s12 offen offset:0
    buffer_store_dwordx4 v[188:191], v31, s[52:55], s12 offen offset:1024
    s_branch standalone__conformer_family_zipformer__speech_kernel_sndv21_4e
standalone__conformer_family_zipformer__speech_kernel_sndv21_4s:
    buffer_store_dwordx4 v[188:191], v31, s[52:55], s12 offen offset:0 sc1
    buffer_store_dwordx4 v[188:191], v31, s[52:55], s12 offen offset:1024 sc1
standalone__conformer_family_zipformer__speech_kernel_sndv21_4e:
    ds_read_b64 v[64:65], v232 offset:0
    ds_read_b64 v[80:81], v232 offset:2048
    ds_read_b64 v[96:97], v232 offset:4096
    ds_read_b64 v[112:113], v232 offset:6144
    ds_read_b64 v[72:73], v236 offset:0
    ds_read_b64 v[88:89], v236 offset:2048
    ds_read_b64 v[104:105], v236 offset:4096
    ds_read_b64 v[120:121], v236 offset:6144
    ds_read_b64 v[66:67], v233 offset:0
    ds_read_b64 v[82:83], v233 offset:2048
    ds_read_b64 v[98:99], v233 offset:4096
    ds_read_b64 v[114:115], v233 offset:6144
    ds_read_b64 v[74:75], v237 offset:0
    ds_read_b64 v[90:91], v237 offset:2048
    ds_read_b64 v[106:107], v237 offset:4096
    ds_read_b64 v[122:123], v237 offset:6144
    s_waitcnt lgkmcnt(15)
    v_mfma_f32_4x4x4_16b_bf16 v[128:131], v[192:193], v[64:65], 0
    ds_read_b64 v[68:69], v234 offset:0
    s_waitcnt lgkmcnt(15)
    v_mfma_f32_4x4x4_16b_bf16 v[136:139], v[210:211], v[80:81], 0
    ds_read_b64 v[84:85], v234 offset:2048
    s_waitcnt lgkmcnt(15)
    v_mfma_f32_4x4x4_16b_bf16 v[144:147], v[228:229], v[96:97], 0
    ds_read_b64 v[100:101], v234 offset:4096
    s_waitcnt lgkmcnt(15)
    v_mfma_f32_4x4x4_16b_bf16 v[152:155], a[238:239], v[112:113], 0
    ds_read_b64 v[116:117], v234 offset:6144
    s_waitcnt lgkmcnt(15)
    v_mfma_f32_4x4x4_16b_bf16 v[132:135], v[192:193], v[72:73], 0
    ds_read_b64 v[76:77], v238 offset:0
    s_waitcnt lgkmcnt(15)
    v_mfma_f32_4x4x4_16b_bf16 v[140:143], v[210:211], v[88:89], 0
    ds_read_b64 v[92:93], v238 offset:2048
    s_waitcnt lgkmcnt(15)
    v_mfma_f32_4x4x4_16b_bf16 v[148:151], v[228:229], v[104:105], 0
    ds_read_b64 v[108:109], v238 offset:4096
    s_waitcnt lgkmcnt(15)
    v_mfma_f32_4x4x4_16b_bf16 v[156:159], a[238:239], v[120:121], 0
    ds_read_b64 v[124:125], v238 offset:6144
    s_waitcnt lgkmcnt(15)
    v_mfma_f32_4x4x4_16b_bf16 v[128:131], v[194:195], v[66:67], v[128:131]
    ds_read_b64 v[70:71], v235 offset:0
    s_waitcnt lgkmcnt(15)
    v_mfma_f32_4x4x4_16b_bf16 v[136:139], v[212:213], v[82:83], v[136:139]
    ds_read_b64 v[86:87], v235 offset:2048
    s_waitcnt lgkmcnt(15)
    v_mfma_f32_4x4x4_16b_bf16 v[144:147], v[230:231], v[98:99], v[144:147]
    ds_read_b64 v[102:103], v235 offset:4096
    s_waitcnt lgkmcnt(15)
    v_mfma_f32_4x4x4_16b_bf16 v[152:155], a[240:241], v[114:115], v[152:155]
    ds_read_b64 v[118:119], v235 offset:6144
    ds_read_b64 v[78:79], v239 offset:0
    s_waitcnt lgkmcnt(15)
    v_mfma_f32_4x4x4_16b_bf16 v[132:135], v[194:195], v[74:75], v[132:135]
    ds_read_b64 v[94:95], v239 offset:2048
    v_mfma_f32_4x4x4_16b_bf16 v[140:143], v[212:213], v[90:91], v[140:143]
    ds_read_b64 v[110:111], v239 offset:4096
    s_waitcnt lgkmcnt(15)
    v_mfma_f32_4x4x4_16b_bf16 v[148:151], v[230:231], v[106:107], v[148:151]
    ds_read_b64 v[126:127], v239 offset:6144
    v_mfma_f32_4x4x4_16b_bf16 v[156:159], a[240:241], v[122:123], v[156:159]
    s_add_u32 s29, s30, 401408
    buffer_load_dwordx4 a[160:163], v31, s[24:27], s29 offen offset:0
    s_waitcnt lgkmcnt(15)
    v_mfma_f32_4x4x4_16b_bf16 v[128:131], v[196:197], v[68:69], v[128:131]
    s_waitcnt lgkmcnt(14)
    v_mfma_f32_4x4x4_16b_bf16 v[136:139], v[214:215], v[84:85], v[136:139]
    ds_read_b64 v[64:65], v240 offset:0
    s_waitcnt lgkmcnt(14)
    v_mfma_f32_4x4x4_16b_bf16 v[144:147], a[224:225], v[100:101], v[144:147]
    s_waitcnt lgkmcnt(13)
    v_mfma_f32_4x4x4_16b_bf16 v[152:155], a[242:243], v[116:117], v[152:155]
    ds_read_b64 v[80:81], v240 offset:2048
    s_waitcnt lgkmcnt(13)
    v_mfma_f32_4x4x4_16b_bf16 v[132:135], v[196:197], v[76:77], v[132:135]
    ds_read_b64 v[96:97], v240 offset:4096
    s_waitcnt lgkmcnt(13)
    v_mfma_f32_4x4x4_16b_bf16 v[140:143], v[214:215], v[92:93], v[140:143]
    s_waitcnt lgkmcnt(12)
    v_mfma_f32_4x4x4_16b_bf16 v[148:151], a[224:225], v[108:109], v[148:151]
    ds_read_b64 v[112:113], v240 offset:6144
    s_waitcnt lgkmcnt(12)
    v_mfma_f32_4x4x4_16b_bf16 v[156:159], a[242:243], v[124:125], v[156:159]
    buffer_load_dwordx4 a[164:167], v31, s[24:27], s29 offen offset:1024
    s_waitcnt lgkmcnt(11)
    v_mfma_f32_4x4x4_16b_bf16 v[128:131], v[198:199], v[70:71], v[128:131]
    s_waitcnt lgkmcnt(10)
    v_mfma_f32_4x4x4_16b_bf16 v[136:139], v[216:217], v[86:87], v[136:139]
    ds_read_b64 v[66:67], v241 offset:0
    s_waitcnt lgkmcnt(10)
    v_mfma_f32_4x4x4_16b_bf16 v[144:147], a[226:227], v[102:103], v[144:147]
    s_waitcnt lgkmcnt(9)
    v_mfma_f32_4x4x4_16b_bf16 v[152:155], a[244:245], v[118:119], v[152:155]
    ds_read_b64 v[82:83], v241 offset:2048
    s_waitcnt lgkmcnt(9)
    v_mfma_f32_4x4x4_16b_bf16 v[132:135], v[198:199], v[78:79], v[132:135]
    ds_read_b64 v[98:99], v241 offset:4096
    s_waitcnt lgkmcnt(9)
    v_mfma_f32_4x4x4_16b_bf16 v[140:143], v[216:217], v[94:95], v[140:143]
    s_waitcnt lgkmcnt(8)
    v_mfma_f32_4x4x4_16b_bf16 v[148:151], a[226:227], v[110:111], v[148:151]
    ds_read_b64 v[114:115], v241 offset:6144
    s_waitcnt lgkmcnt(8)
    v_mfma_f32_4x4x4_16b_bf16 v[156:159], a[244:245], v[126:127], v[156:159]
    buffer_load_dwordx4 a[168:171], v31, s[24:27], s29 offen offset:2048
    v_mfma_f32_4x4x4_16b_bf16 v[128:131], v[200:201], v[72:73], v[128:131]
    v_mfma_f32_4x4x4_16b_bf16 v[136:139], v[218:219], v[88:89], v[136:139]
    ds_read_b64 v[68:69], v242 offset:0
    v_mfma_f32_4x4x4_16b_bf16 v[144:147], a[228:229], v[104:105], v[144:147]
    v_mfma_f32_4x4x4_16b_bf16 v[152:155], a[246:247], v[120:121], v[152:155]
    ds_read_b64 v[84:85], v242 offset:2048
    s_waitcnt lgkmcnt(9)
    v_mfma_f32_4x4x4_16b_bf16 v[132:135], v[200:201], v[64:65], v[132:135]
    ds_read_b64 v[100:101], v242 offset:4096
    s_waitcnt lgkmcnt(9)
    v_mfma_f32_4x4x4_16b_bf16 v[140:143], v[218:219], v[80:81], v[140:143]
    s_waitcnt lgkmcnt(8)
    v_mfma_f32_4x4x4_16b_bf16 v[148:151], a[228:229], v[96:97], v[148:151]
    ds_read_b64 v[116:117], v242 offset:6144
    s_waitcnt lgkmcnt(8)
    v_mfma_f32_4x4x4_16b_bf16 v[156:159], a[246:247], v[112:113], v[156:159]
    buffer_load_dwordx4 a[172:175], v31, s[24:27], s29 offen offset:3072
    v_mfma_f32_4x4x4_16b_bf16 v[128:131], v[202:203], v[74:75], v[128:131]
    v_mfma_f32_4x4x4_16b_bf16 v[136:139], v[220:221], v[90:91], v[136:139]
    ds_read_b64 v[70:71], v243 offset:0
    v_mfma_f32_4x4x4_16b_bf16 v[144:147], a[230:231], v[106:107], v[144:147]
    ds_read_b64 v[86:87], v243 offset:2048
    v_mfma_f32_4x4x4_16b_bf16 v[152:155], a[248:249], v[122:123], v[152:155]
    ds_read_b64 v[102:103], v243 offset:4096
    s_waitcnt lgkmcnt(10)
    v_mfma_f32_4x4x4_16b_bf16 v[132:135], v[202:203], v[66:67], v[132:135]
    s_waitcnt lgkmcnt(9)
    v_mfma_f32_4x4x4_16b_bf16 v[140:143], v[220:221], v[82:83], v[140:143]
    ds_read_b64 v[118:119], v243 offset:6144
    s_waitcnt lgkmcnt(9)
    v_mfma_f32_4x4x4_16b_bf16 v[148:151], a[230:231], v[98:99], v[148:151]
    s_add_u32 s29, s30, 405504
    s_waitcnt lgkmcnt(8)
    v_mfma_f32_4x4x4_16b_bf16 v[156:159], a[248:249], v[114:115], v[156:159]
    buffer_load_dwordx4 a[176:179], v31, s[24:27], s29 offen offset:0
    v_mfma_f32_4x4x4_16b_bf16 v[128:131], v[204:205], v[76:77], v[128:131]
    v_mfma_f32_4x4x4_16b_bf16 v[136:139], v[222:223], v[92:93], v[136:139]
    ds_read_b64 v[72:73], v244 offset:0
    v_mfma_f32_4x4x4_16b_bf16 v[144:147], a[232:233], v[108:109], v[144:147]
    v_mfma_f32_4x4x4_16b_bf16 v[152:155], a[250:251], v[124:125], v[152:155]
    ds_read_b64 v[88:89], v244 offset:2048
    s_waitcnt lgkmcnt(9)
    v_mfma_f32_4x4x4_16b_bf16 v[132:135], v[204:205], v[68:69], v[132:135]
    ds_read_b64 v[104:105], v244 offset:4096
    s_waitcnt lgkmcnt(9)
    v_mfma_f32_4x4x4_16b_bf16 v[140:143], v[222:223], v[84:85], v[140:143]
    s_waitcnt lgkmcnt(8)
    v_mfma_f32_4x4x4_16b_bf16 v[148:151], a[232:233], v[100:101], v[148:151]
    ds_read_b64 v[120:121], v244 offset:6144
    s_waitcnt lgkmcnt(8)
    v_mfma_f32_4x4x4_16b_bf16 v[156:159], a[250:251], v[116:117], v[156:159]
    buffer_load_dwordx4 a[180:183], v31, s[24:27], s29 offen offset:1024
    v_mfma_f32_4x4x4_16b_bf16 v[128:131], v[206:207], v[78:79], v[128:131]
    v_mfma_f32_4x4x4_16b_bf16 v[136:139], v[224:225], v[94:95], v[136:139]
    v_mfma_f32_4x4x4_16b_bf16 v[144:147], a[234:235], v[110:111], v[144:147]
    v_mfma_f32_4x4x4_16b_bf16 v[152:155], a[252:253], v[126:127], v[152:155]
    s_waitcnt lgkmcnt(7)
    v_mfma_f32_4x4x4_16b_bf16 v[132:135], v[206:207], v[70:71], v[132:135]
    s_waitcnt lgkmcnt(6)
    v_mfma_f32_4x4x4_16b_bf16 v[140:143], v[224:225], v[86:87], v[140:143]
    s_waitcnt lgkmcnt(5)
    v_mfma_f32_4x4x4_16b_bf16 v[148:151], a[234:235], v[102:103], v[148:151]
    s_waitcnt lgkmcnt(4)
    v_mfma_f32_4x4x4_16b_bf16 v[156:159], a[252:253], v[118:119], v[156:159]
    buffer_load_dwordx4 a[184:187], v31, s[24:27], s29 offen offset:2048
    v_mfma_f32_4x4x4_16b_bf16 v[128:131], v[208:209], v[64:65], v[128:131]
    v_mfma_f32_4x4x4_16b_bf16 v[136:139], v[226:227], v[80:81], v[136:139]
    v_mfma_f32_4x4x4_16b_bf16 v[144:147], a[236:237], v[96:97], v[144:147]
    v_mfma_f32_4x4x4_16b_bf16 v[152:155], a[254:255], v[112:113], v[152:155]
    s_waitcnt lgkmcnt(3)
    v_mfma_f32_4x4x4_16b_bf16 v[132:135], v[208:209], v[72:73], v[132:135]
    s_waitcnt lgkmcnt(2)
    v_mfma_f32_4x4x4_16b_bf16 v[140:143], v[226:227], v[88:89], v[140:143]
    s_waitcnt lgkmcnt(1)
    v_mfma_f32_4x4x4_16b_bf16 v[148:151], a[236:237], v[104:105], v[148:151]
    s_waitcnt lgkmcnt(0)
    v_mfma_f32_4x4x4_16b_bf16 v[156:159], a[254:255], v[120:121], v[156:159]
    buffer_load_dwordx4 a[188:191], v31, s[24:27], s29 offen offset:3072
    s_waitcnt vmcnt(8)
    v_mov_b32 v22, 3
    s_cmp_eq_u32 s83, 0
    s_cbranch_scc1 standalone__conformer_family_zipformer__speech_kernel_sndv21_5s
    buffer_store_dword v22, v21, s[24:27], s81 offen
    s_branch standalone__conformer_family_zipformer__speech_kernel_sndv21_5e
standalone__conformer_family_zipformer__speech_kernel_sndv21_5s:
    buffer_store_dword v22, v21, s[24:27], s81 offen sc1
standalone__conformer_family_zipformer__speech_kernel_sndv21_5e:
    v_exp_f32 v168, v128
    v_exp_f32 v169, v129
    v_exp_f32 v170, v130
    v_exp_f32 v171, v131
    s_add_u32 s29, s30, 409600
    buffer_load_dwordx4 a[192:195], v31, s[24:27], s29 offen offset:0
    v_exp_f32 v172, v132
    v_exp_f32 v173, v133
    v_exp_f32 v174, v134
    v_exp_f32 v175, v135
    v_pk_add_f32 v[168:169], v[168:169], 1.0 op_sel_hi:[1,0]
    v_pk_add_f32 v[170:171], v[170:171], 1.0 op_sel_hi:[1,0]
    v_pk_add_f32 v[172:173], v[172:173], 1.0 op_sel_hi:[1,0]
    v_pk_add_f32 v[174:175], v[174:175], 1.0 op_sel_hi:[1,0]
    buffer_load_dwordx4 a[196:199], v31, s[24:27], s29 offen offset:1024
    v_rcp_f32 v168, v168
    v_rcp_f32 v169, v169
    v_rcp_f32 v170, v170
    v_rcp_f32 v171, v171
    v_rcp_f32 v172, v172
    v_rcp_f32 v173, v173
    v_rcp_f32 v174, v174
    buffer_load_dwordx4 a[200:203], v31, s[24:27], s29 offen offset:2048
    v_rcp_f32 v175, v175
    v_pk_mul_f32 v[168:169], v[128:129], v[168:169]
    v_pk_mul_f32 v[170:171], v[130:131], v[170:171]
    v_pk_mul_f32 v[172:173], v[132:133], v[172:173]
    v_pk_mul_f32 v[174:175], v[134:135], v[174:175]
    v_cvt_pk_bf16_f32 v176, v168, v169
    v_cvt_pk_bf16_f32 v177, v170, v171
    v_cvt_pk_bf16_f32 v178, v172, v173
    buffer_load_dwordx4 a[204:207], v31, s[24:27], s29 offen offset:3072
    v_cvt_pk_bf16_f32 v179, v174, v175
    ds_write_b64 v16, v[176:177] offset:0
    ds_write_b64 v17, v[178:179] offset:0
    v_exp_f32 v180, v136
    v_exp_f32 v181, v137
    v_exp_f32 v182, v138
    v_exp_f32 v183, v139
    s_add_u32 s29, s30, 413696
    buffer_load_dwordx4 a[208:211], v31, s[24:27], s29 offen offset:0
    v_exp_f32 v184, v140
    v_exp_f32 v185, v141
    v_exp_f32 v186, v142
    v_exp_f32 v187, v143
    v_pk_add_f32 v[180:181], v[180:181], 1.0 op_sel_hi:[1,0]
    v_pk_add_f32 v[182:183], v[182:183], 1.0 op_sel_hi:[1,0]
    v_pk_add_f32 v[184:185], v[184:185], 1.0 op_sel_hi:[1,0]
    v_pk_add_f32 v[186:187], v[186:187], 1.0 op_sel_hi:[1,0]
    buffer_load_dwordx4 a[212:215], v31, s[24:27], s29 offen offset:1024
    v_rcp_f32 v180, v180
    v_rcp_f32 v181, v181
    v_rcp_f32 v182, v182
    v_rcp_f32 v183, v183
    v_rcp_f32 v184, v184
    v_rcp_f32 v185, v185
    v_rcp_f32 v186, v186
    buffer_load_dwordx4 a[216:219], v31, s[24:27], s29 offen offset:2048
    v_rcp_f32 v187, v187
    v_pk_mul_f32 v[180:181], v[136:137], v[180:181]
    v_pk_mul_f32 v[182:183], v[138:139], v[182:183]
    v_pk_mul_f32 v[184:185], v[140:141], v[184:185]
    v_pk_mul_f32 v[186:187], v[142:143], v[186:187]
    v_cvt_pk_bf16_f32 v188, v180, v181
    v_cvt_pk_bf16_f32 v189, v182, v183
    v_cvt_pk_bf16_f32 v190, v184, v185
    buffer_load_dwordx4 a[220:223], v31, s[24:27], s29 offen offset:3072
    v_cvt_pk_bf16_f32 v191, v186, v187
    ds_write_b64 v16, v[188:189] offset:1024
    ds_write_b64 v17, v[190:191] offset:1024
    v_exp_f32 v168, v144
    v_exp_f32 v169, v145
    v_exp_f32 v170, v146
    v_exp_f32 v171, v147
    s_add_u32 s29, s30, 417792
    buffer_load_dwordx4 a[64:67], v31, s[24:27], s29 offen offset:0
    v_exp_f32 v172, v148
    v_exp_f32 v173, v149
    v_exp_f32 v174, v150
    v_exp_f32 v175, v151
    v_pk_add_f32 v[168:169], v[168:169], 1.0 op_sel_hi:[1,0]
    v_pk_add_f32 v[170:171], v[170:171], 1.0 op_sel_hi:[1,0]
    v_pk_add_f32 v[172:173], v[172:173], 1.0 op_sel_hi:[1,0]
    v_pk_add_f32 v[174:175], v[174:175], 1.0 op_sel_hi:[1,0]
    buffer_load_dwordx4 a[68:71], v31, s[24:27], s29 offen offset:1024
    v_rcp_f32 v168, v168
    v_rcp_f32 v169, v169
    v_rcp_f32 v170, v170
    v_rcp_f32 v171, v171
    v_rcp_f32 v172, v172
    v_rcp_f32 v173, v173
    v_rcp_f32 v174, v174
    buffer_load_dwordx4 a[72:75], v31, s[24:27], s29 offen offset:2048
    v_rcp_f32 v175, v175
    v_pk_mul_f32 v[168:169], v[144:145], v[168:169]
    v_pk_mul_f32 v[170:171], v[146:147], v[170:171]
    v_pk_mul_f32 v[172:173], v[148:149], v[172:173]
    v_pk_mul_f32 v[174:175], v[150:151], v[174:175]
    v_cvt_pk_bf16_f32 v176, v168, v169
    v_cvt_pk_bf16_f32 v177, v170, v171
    v_cvt_pk_bf16_f32 v178, v172, v173
    buffer_load_dwordx4 a[76:79], v31, s[24:27], s29 offen offset:3072
    v_cvt_pk_bf16_f32 v179, v174, v175
    ds_write_b64 v16, v[176:177] offset:2048
    ds_write_b64 v17, v[178:179] offset:2048
    v_exp_f32 v180, v152
    v_exp_f32 v181, v153
    v_exp_f32 v182, v154
    v_exp_f32 v183, v155
    s_add_u32 s29, s30, 421888
    buffer_load_dwordx4 a[80:83], v31, s[24:27], s29 offen offset:0
    v_exp_f32 v184, v156
    v_exp_f32 v185, v157
    v_exp_f32 v186, v158
    v_exp_f32 v187, v159
    v_pk_add_f32 v[180:181], v[180:181], 1.0 op_sel_hi:[1,0]
    v_pk_add_f32 v[182:183], v[182:183], 1.0 op_sel_hi:[1,0]
    v_pk_add_f32 v[184:185], v[184:185], 1.0 op_sel_hi:[1,0]
    v_pk_add_f32 v[186:187], v[186:187], 1.0 op_sel_hi:[1,0]
    buffer_load_dwordx4 a[84:87], v31, s[24:27], s29 offen offset:1024
    v_rcp_f32 v180, v180
    v_rcp_f32 v181, v181
    v_rcp_f32 v182, v182
    v_rcp_f32 v183, v183
    v_rcp_f32 v184, v184
    v_rcp_f32 v185, v185
    v_rcp_f32 v186, v186
    buffer_load_dwordx4 a[88:91], v31, s[24:27], s29 offen offset:2048
    v_rcp_f32 v187, v187
    v_pk_mul_f32 v[180:181], v[152:153], v[180:181]
    v_pk_mul_f32 v[182:183], v[154:155], v[182:183]
    v_pk_mul_f32 v[184:185], v[156:157], v[184:185]
    v_pk_mul_f32 v[186:187], v[158:159], v[186:187]
    v_cvt_pk_bf16_f32 v188, v180, v181
    v_cvt_pk_bf16_f32 v189, v182, v183
    v_cvt_pk_bf16_f32 v190, v184, v185
    buffer_load_dwordx4 a[92:95], v31, s[24:27], s29 offen offset:3072
    v_cvt_pk_bf16_f32 v191, v186, v187
    ds_write_b64 v16, v[188:189] offset:3072
    ds_write_b64 v17, v[190:191] offset:3072
    s_waitcnt lgkmcnt(0)
    s_barrier
    ds_read_b64_tr_b16 a[0:1], v18 offset:0
    ds_read_b64_tr_b16 a[2:3], v18 offset:1024
    ds_read_b64_tr_b16 a[4:5], v19 offset:0
    ds_read_b64_tr_b16 a[6:7], v19 offset:1024
    s_waitcnt lgkmcnt(2)
    v_mfma_f32_16x16x32_bf16 v[128:131], a[128:131], a[0:3], 0
    ds_read_b64_tr_b16 a[8:9], v18 offset:2048
    s_add_u32 s47, s31, 548864
    s_waitcnt lgkmcnt(1)
    v_mfma_f32_16x16x32_bf16 v[132:135], a[128:131], a[4:7], 0
    ds_read_b64_tr_b16 a[10:11], v18 offset:3072
    buffer_load_dwordx4 v[80:83], v31, s[24:27], s47 offen offset:0
    v_mfma_f32_16x16x32_bf16 v[136:139], a[132:135], a[0:3], 0
    buffer_load_dwordx4 v[84:87], v31, s[24:27], s47 offen offset:1024
    v_mfma_f32_16x16x32_bf16 v[140:143], a[132:135], a[4:7], 0
    ds_read_b64_tr_b16 a[12:13], v19 offset:2048
    v_mfma_f32_16x16x32_bf16 v[144:147], a[136:139], a[0:3], 0
    ds_read_b64_tr_b16 a[14:15], v19 offset:3072
    buffer_load_dwordx4 v[88:91], v31, s[24:27], s47 offen offset:2048
    v_mfma_f32_16x16x32_bf16 v[148:151], a[136:139], a[4:7], 0
    buffer_load_dwordx4 v[92:95], v31, s[24:27], s47 offen offset:3072
    v_mfma_f32_16x16x32_bf16 v[152:155], a[140:143], a[0:3], 0
    v_mfma_f32_16x16x32_bf16 v[156:159], a[140:143], a[4:7], 0
    s_waitcnt lgkmcnt(2)
    v_mfma_f32_16x16x32_bf16 v[128:131], a[144:147], a[8:11], v[128:131]
    ds_read_b64_tr_b16 a[16:17], v18 offset:4096
    s_waitcnt lgkmcnt(1)
    v_mfma_f32_16x16x32_bf16 v[132:135], a[144:147], a[12:15], v[132:135]
    ds_read_b64_tr_b16 a[18:19], v18 offset:5120
    v_mfma_f32_16x16x32_bf16 v[136:139], a[148:151], a[8:11], v[136:139]
    v_mfma_f32_16x16x32_bf16 v[140:143], a[148:151], a[12:15], v[140:143]
    ds_read_b64_tr_b16 a[20:21], v19 offset:4096
    v_mfma_f32_16x16x32_bf16 v[144:147], a[152:155], a[8:11], v[144:147]
    ds_read_b64_tr_b16 a[22:23], v19 offset:5120
    v_mfma_f32_16x16x32_bf16 v[148:151], a[152:155], a[12:15], v[148:151]
    v_mfma_f32_16x16x32_bf16 v[152:155], a[156:159], a[8:11], v[152:155]
    v_mfma_f32_16x16x32_bf16 v[156:159], a[156:159], a[12:15], v[156:159]
    s_waitcnt vmcnt(25) lgkmcnt(2)
    v_mfma_f32_16x16x32_bf16 v[128:131], a[160:163], a[16:19], v[128:131]
    s_add_u32 s29, s31, 524288
    ds_read_b64_tr_b16 a[24:25], v18 offset:6144
    s_waitcnt lgkmcnt(1)
    v_mfma_f32_16x16x32_bf16 v[132:135], a[160:163], a[20:23], v[132:135]
    buffer_load_dwordx4 a[160:163], v31, s[24:27], s29 offen offset:0
    ds_read_b64_tr_b16 a[26:27], v18 offset:7168
    v_mfma_f32_16x16x32_bf16 v[136:139], a[164:167], a[16:19], v[136:139]
    v_mfma_f32_16x16x32_bf16 v[140:143], a[164:167], a[20:23], v[140:143]
    buffer_load_dwordx4 a[164:167], v31, s[24:27], s29 offen offset:1024
    ds_read_b64_tr_b16 a[28:29], v19 offset:6144
    v_mfma_f32_16x16x32_bf16 v[144:147], a[168:171], a[16:19], v[144:147]
    ds_read_b64_tr_b16 a[30:31], v19 offset:7168
    v_mfma_f32_16x16x32_bf16 v[148:151], a[168:171], a[20:23], v[148:151]
    buffer_load_dwordx4 a[168:171], v31, s[24:27], s29 offen offset:2048
    v_mfma_f32_16x16x32_bf16 v[152:155], a[172:175], a[16:19], v[152:155]
    v_mfma_f32_16x16x32_bf16 v[156:159], a[172:175], a[20:23], v[156:159]
    buffer_load_dwordx4 a[172:175], v31, s[24:27], s29 offen offset:3072
    s_waitcnt vmcnt(25) lgkmcnt(2)
    v_mfma_f32_16x16x32_bf16 v[128:131], a[176:179], a[24:27], v[128:131]
    s_add_u32 s29, s31, 528384
    ds_read_b64_tr_b16 a[32:33], v18 offset:8192
    s_waitcnt lgkmcnt(1)
    v_mfma_f32_16x16x32_bf16 v[132:135], a[176:179], a[28:31], v[132:135]
    buffer_load_dwordx4 a[176:179], v31, s[24:27], s29 offen offset:0
    ds_read_b64_tr_b16 a[34:35], v18 offset:9216
    v_mfma_f32_16x16x32_bf16 v[136:139], a[180:183], a[24:27], v[136:139]
    v_mfma_f32_16x16x32_bf16 v[140:143], a[180:183], a[28:31], v[140:143]
    buffer_load_dwordx4 a[180:183], v31, s[24:27], s29 offen offset:1024
    ds_read_b64_tr_b16 a[36:37], v19 offset:8192
    v_mfma_f32_16x16x32_bf16 v[144:147], a[184:187], a[24:27], v[144:147]
    ds_read_b64_tr_b16 a[38:39], v19 offset:9216
    v_mfma_f32_16x16x32_bf16 v[148:151], a[184:187], a[28:31], v[148:151]
    buffer_load_dwordx4 a[184:187], v31, s[24:27], s29 offen offset:2048
    v_mfma_f32_16x16x32_bf16 v[152:155], a[188:191], a[24:27], v[152:155]
    v_mfma_f32_16x16x32_bf16 v[156:159], a[188:191], a[28:31], v[156:159]
    buffer_load_dwordx4 a[188:191], v31, s[24:27], s29 offen offset:3072
    s_waitcnt vmcnt(24) lgkmcnt(2)
    v_mfma_f32_16x16x32_bf16 v[128:131], a[192:195], a[32:35], v[128:131]
    s_add_u32 s29, s31, 532480
    ds_read_b64_tr_b16 a[40:41], v18 offset:10240
    s_waitcnt lgkmcnt(1)
    v_mfma_f32_16x16x32_bf16 v[132:135], a[192:195], a[36:39], v[132:135]
    buffer_load_dwordx4 a[192:195], v31, s[24:27], s29 offen offset:0
    ds_read_b64_tr_b16 a[42:43], v18 offset:11264
    v_mfma_f32_16x16x32_bf16 v[136:139], a[196:199], a[32:35], v[136:139]
    v_mfma_f32_16x16x32_bf16 v[140:143], a[196:199], a[36:39], v[140:143]
    buffer_load_dwordx4 a[196:199], v31, s[24:27], s29 offen offset:1024
    ds_read_b64_tr_b16 a[44:45], v19 offset:10240
    v_mfma_f32_16x16x32_bf16 v[144:147], a[200:203], a[32:35], v[144:147]
    ds_read_b64_tr_b16 a[46:47], v19 offset:11264
    v_mfma_f32_16x16x32_bf16 v[148:151], a[200:203], a[36:39], v[148:151]
    buffer_load_dwordx4 a[200:203], v31, s[24:27], s29 offen offset:2048
    v_mfma_f32_16x16x32_bf16 v[152:155], a[204:207], a[32:35], v[152:155]
    v_mfma_f32_16x16x32_bf16 v[156:159], a[204:207], a[36:39], v[156:159]
    buffer_load_dwordx4 a[204:207], v31, s[24:27], s29 offen offset:3072
    s_waitcnt vmcnt(24) lgkmcnt(2)
    v_mfma_f32_16x16x32_bf16 v[128:131], a[208:211], a[40:43], v[128:131]
    s_add_u32 s29, s31, 536576
    ds_read_b64_tr_b16 a[48:49], v18 offset:12288
    s_waitcnt lgkmcnt(1)
    v_mfma_f32_16x16x32_bf16 v[132:135], a[208:211], a[44:47], v[132:135]
    buffer_load_dwordx4 a[208:211], v31, s[24:27], s29 offen offset:0
    ds_read_b64_tr_b16 a[50:51], v18 offset:13312
    v_mfma_f32_16x16x32_bf16 v[136:139], a[212:215], a[40:43], v[136:139]
    v_mfma_f32_16x16x32_bf16 v[140:143], a[212:215], a[44:47], v[140:143]
    buffer_load_dwordx4 a[212:215], v31, s[24:27], s29 offen offset:1024
    ds_read_b64_tr_b16 a[52:53], v19 offset:12288
    v_mfma_f32_16x16x32_bf16 v[144:147], a[216:219], a[40:43], v[144:147]
    ds_read_b64_tr_b16 a[54:55], v19 offset:13312
    v_mfma_f32_16x16x32_bf16 v[148:151], a[216:219], a[44:47], v[148:151]
    buffer_load_dwordx4 a[216:219], v31, s[24:27], s29 offen offset:2048
    v_mfma_f32_16x16x32_bf16 v[152:155], a[220:223], a[40:43], v[152:155]
    v_mfma_f32_16x16x32_bf16 v[156:159], a[220:223], a[44:47], v[156:159]
    buffer_load_dwordx4 a[220:223], v31, s[24:27], s29 offen offset:3072
    s_waitcnt vmcnt(27) lgkmcnt(2)
    v_mfma_f32_16x16x32_bf16 v[128:131], a[64:67], a[48:51], v[128:131]
    ds_read_b64_tr_b16 a[56:57], v18 offset:14336
    buffer_load_dword v22, v21, s[24:27], s80 offen sc1
    s_waitcnt lgkmcnt(1)
    v_mfma_f32_16x16x32_bf16 v[132:135], a[64:67], a[52:55], v[132:135]
    ds_read_b64_tr_b16 a[58:59], v18 offset:15360
    s_waitcnt vmcnt(27)
    v_mfma_f32_16x16x32_bf16 v[136:139], a[68:71], a[48:51], v[136:139]
    v_mfma_f32_16x16x32_bf16 v[140:143], a[68:71], a[52:55], v[140:143]
    ds_read_b64_tr_b16 a[60:61], v19 offset:14336
    s_waitcnt vmcnt(26)
    v_mfma_f32_16x16x32_bf16 v[144:147], a[72:75], a[48:51], v[144:147]
    ds_read_b64_tr_b16 a[62:63], v19 offset:15360
    v_mfma_f32_16x16x32_bf16 v[148:151], a[72:75], a[52:55], v[148:151]
    s_waitcnt vmcnt(25)
    v_mfma_f32_16x16x32_bf16 v[152:155], a[76:79], a[48:51], v[152:155]
    v_mfma_f32_16x16x32_bf16 v[156:159], a[76:79], a[52:55], v[156:159]
    s_waitcnt vmcnt(24) lgkmcnt(2)
    v_mfma_f32_16x16x32_bf16 v[128:131], a[80:83], a[56:59], v[128:131]
    s_add_u32 s47, s31, 552960
    s_waitcnt lgkmcnt(0)
    v_mfma_f32_16x16x32_bf16 v[132:135], a[80:83], a[60:63], v[132:135]
    buffer_load_dwordx4 v[96:99], v31, s[24:27], s47 offen offset:0
    s_waitcnt vmcnt(24)
    v_mfma_f32_16x16x32_bf16 v[136:139], a[84:87], a[56:59], v[136:139]
    buffer_load_dwordx4 v[100:103], v31, s[24:27], s47 offen offset:1024
    v_mfma_f32_16x16x32_bf16 v[140:143], a[84:87], a[60:63], v[140:143]
    s_waitcnt vmcnt(24)
    v_mfma_f32_16x16x32_bf16 v[144:147], a[88:91], a[56:59], v[144:147]
    buffer_load_dwordx4 v[104:107], v31, s[24:27], s47 offen offset:2048
    v_mfma_f32_16x16x32_bf16 v[148:151], a[88:91], a[60:63], v[148:151]
    buffer_load_dwordx4 v[108:111], v31, s[24:27], s47 offen offset:3072
    s_waitcnt vmcnt(25)
    v_mfma_f32_16x16x32_bf16 v[152:155], a[92:95], a[56:59], v[152:155]
    v_mfma_f32_16x16x32_bf16 v[156:159], a[92:95], a[60:63], v[156:159]
    s_mov_b32 s42, 0xbf317218
    v_pk_fma_f32 v[32:33], v[128:129], s[42:43], v[32:33] op_sel_hi:[1,0,1]
    v_pk_fma_f32 v[34:35], v[130:131], s[42:43], v[34:35] op_sel_hi:[1,0,1]
    v_pk_fma_f32 v[36:37], v[132:133], s[42:43], v[36:37] op_sel_hi:[1,0,1]
    v_pk_fma_f32 v[38:39], v[134:135], s[42:43], v[38:39] op_sel_hi:[1,0,1]
    v_pk_fma_f32 v[40:41], v[136:137], s[42:43], v[40:41] op_sel_hi:[1,0,1]
    v_pk_fma_f32 v[42:43], v[138:139], s[42:43], v[42:43] op_sel_hi:[1,0,1]
    v_pk_fma_f32 v[44:45], v[140:141], s[42:43], v[44:45] op_sel_hi:[1,0,1]
    v_pk_fma_f32 v[46:47], v[142:143], s[42:43], v[46:47] op_sel_hi:[1,0,1]
    v_pk_fma_f32 v[48:49], v[144:145], s[42:43], v[48:49] op_sel_hi:[1,0,1]
    v_pk_fma_f32 v[50:51], v[146:147], s[42:43], v[50:51] op_sel_hi:[1,0,1]
    v_pk_fma_f32 v[52:53], v[148:149], s[42:43], v[52:53] op_sel_hi:[1,0,1]
    v_pk_fma_f32 v[54:55], v[150:151], s[42:43], v[54:55] op_sel_hi:[1,0,1]
    v_pk_fma_f32 v[56:57], v[152:153], s[42:43], v[56:57] op_sel_hi:[1,0,1]
    v_pk_fma_f32 v[58:59], v[154:155], s[42:43], v[58:59] op_sel_hi:[1,0,1]
    v_pk_fma_f32 v[60:61], v[156:157], s[42:43], v[60:61] op_sel_hi:[1,0,1]
    v_pk_fma_f32 v[62:63], v[158:159], s[42:43], v[62:63] op_sel_hi:[1,0,1]
    v_pk_add_f32 v[192:193], v[32:33], v[34:35]
    v_pk_mul_f32 v[194:195], v[32:33], v[32:33]
    v_pk_fma_f32 v[194:195], v[34:35], v[34:35], v[194:195]
    v_pk_add_f32 v[192:193], v[192:193], v[40:41]
    v_pk_fma_f32 v[194:195], v[40:41], v[40:41], v[194:195]
    v_pk_add_f32 v[192:193], v[192:193], v[42:43]
    s_add_u32 s29, s31, 540672
    buffer_load_dwordx4 a[128:131], v31, s[24:27], s29 offen offset:0
    v_pk_fma_f32 v[194:195], v[42:43], v[42:43], v[194:195]
    v_pk_add_f32 v[192:193], v[192:193], v[48:49]
    v_pk_fma_f32 v[194:195], v[48:49], v[48:49], v[194:195]
    v_pk_add_f32 v[192:193], v[192:193], v[50:51]
    v_pk_fma_f32 v[194:195], v[50:51], v[50:51], v[194:195]
    v_pk_add_f32 v[192:193], v[192:193], v[56:57]
    v_pk_fma_f32 v[194:195], v[56:57], v[56:57], v[194:195]
    v_pk_add_f32 v[192:193], v[192:193], v[58:59]
    v_pk_fma_f32 v[194:195], v[58:59], v[58:59], v[194:195]
    v_pk_add_f32 v[196:197], v[36:37], v[38:39]
    buffer_load_dwordx4 a[132:135], v31, s[24:27], s29 offen offset:1024
    v_pk_mul_f32 v[198:199], v[36:37], v[36:37]
    v_pk_fma_f32 v[198:199], v[38:39], v[38:39], v[198:199]
    v_pk_add_f32 v[196:197], v[196:197], v[44:45]
    v_pk_fma_f32 v[198:199], v[44:45], v[44:45], v[198:199]
    v_pk_add_f32 v[196:197], v[196:197], v[46:47]
    v_pk_fma_f32 v[198:199], v[46:47], v[46:47], v[198:199]
    v_pk_add_f32 v[196:197], v[196:197], v[52:53]
    v_pk_fma_f32 v[198:199], v[52:53], v[52:53], v[198:199]
    v_pk_add_f32 v[196:197], v[196:197], v[54:55]
    v_pk_fma_f32 v[198:199], v[54:55], v[54:55], v[198:199]
    buffer_load_dwordx4 a[136:139], v31, s[24:27], s29 offen offset:2048
    v_pk_add_f32 v[196:197], v[196:197], v[60:61]
    v_pk_fma_f32 v[198:199], v[60:61], v[60:61], v[198:199]
    v_pk_add_f32 v[196:197], v[196:197], v[62:63]
    v_pk_fma_f32 v[198:199], v[62:63], v[62:63], v[198:199]
    v_add_f32 v192, v192, v193
    v_add_f32 v194, v194, v195
    v_add_f32 v196, v196, v197
    v_add_f32 v198, v198, v199
    v_permlane32_swap_b32 v192, v194
    s_nop 0
    v_permlane32_swap_b32 v196, v198
    buffer_load_dwordx4 a[140:143], v31, s[24:27], s29 offen offset:3072
    v_add_f32 v192, v192, v194
    v_add_f32 v196, v196, v198
    s_nop 1
    v_permlane16_swap_b32 v192, v196
    v_add_f32 v192, v192, v196
    ds_write_b32 v29, v192 offset:0
    s_add_u32 s29, s31, 544768
    buffer_load_dwordx4 a[144:147], v31, s[24:27], s29 offen offset:0
    buffer_load_dwordx4 a[148:151], v31, s[24:27], s29 offen offset:1024
    buffer_load_dwordx4 a[152:155], v31, s[24:27], s29 offen offset:2048
    buffer_load_dwordx4 a[156:159], v31, s[24:27], s29 offen offset:3072
    s_waitcnt lgkmcnt(0)
    s_barrier
    ds_read_b128 v[208:211], v30 offset:0
    ds_read_b128 v[216:219], v30 offset:512
    ds_read_b128 v[212:215], v30 offset:256
    ds_read_b128 v[220:223], v30 offset:768
    s_waitcnt lgkmcnt(3)
    v_pk_add_f32 v[208:209], v[208:209], v[210:211]
    s_waitcnt lgkmcnt(2)
    v_pk_add_f32 v[216:217], v[216:217], v[218:219]
    s_waitcnt lgkmcnt(1)
    v_pk_add_f32 v[212:213], v[212:213], v[214:215]
    s_waitcnt lgkmcnt(0)
    v_pk_add_f32 v[220:221], v[220:221], v[222:223]
    v_add_f32 v208, v208, v209
    v_add_f32 v216, v216, v217
    v_add_f32 v212, v212, v213
    v_add_f32 v220, v220, v221
    v_mul_f32 v208, 0x3b800000, v208
    v_mul_f32 v216, 0x3b800000, v216
    v_mul_f32 v212, 0x3b800000, v212
    v_mul_f32 v220, 0x3b800000, v220
    v_fma_f32 v216, -v208, v208, v216
    v_fma_f32 v220, -v212, v212, v220
    v_max_f32 v216, 0, v216
    v_max_f32 v220, 0, v220
    v_add_f32 v216, 0x3727c5ac, v216
    v_add_f32 v220, 0x3727c5ac, v220
    v_rsq_f32 v192, v216
    v_rsq_f32 v196, v220
    v_mul_f32 v192, 0xbfb8aa3b, v192
    v_mul_f32 v196, 0xbfb8aa3b, v196
    v_mul_f32 v194, -v208, v192
    v_mul_f32 v198, -v212, v196
    v_pk_fma_f32 v[208:209], v[32:33], v[192:193], v[194:195] op_sel_hi:[1,0,0]
    v_pk_fma_f32 v[210:211], v[34:35], v[192:193], v[194:195] op_sel_hi:[1,0,0]
    v_pk_fma_f32 v[212:213], v[40:41], v[192:193], v[194:195] op_sel_hi:[1,0,0]
    v_pk_fma_f32 v[214:215], v[42:43], v[192:193], v[194:195] op_sel_hi:[1,0,0]
    v_cvt_pk_bf16_f32 v216, v208, v209
    v_cvt_pk_bf16_f32 v217, v210, v211
    v_cvt_pk_bf16_f32 v218, v212, v213
    v_cvt_pk_bf16_f32 v219, v214, v215
    v_pk_fma_f32 v[208:209], v[48:49], v[192:193], v[194:195] op_sel_hi:[1,0,0]
    v_pk_fma_f32 v[210:211], v[50:51], v[192:193], v[194:195] op_sel_hi:[1,0,0]
    v_pk_fma_f32 v[212:213], v[56:57], v[192:193], v[194:195] op_sel_hi:[1,0,0]
    v_pk_fma_f32 v[214:215], v[58:59], v[192:193], v[194:195] op_sel_hi:[1,0,0]
    v_cvt_pk_bf16_f32 v224, v208, v209
    v_cvt_pk_bf16_f32 v225, v210, v211
    v_cvt_pk_bf16_f32 v226, v212, v213
    v_cvt_pk_bf16_f32 v227, v214, v215
    v_pk_fma_f32 v[208:209], v[36:37], v[196:197], v[198:199] op_sel_hi:[1,0,0]
    v_pk_fma_f32 v[210:211], v[38:39], v[196:197], v[198:199] op_sel_hi:[1,0,0]
    v_pk_fma_f32 v[212:213], v[44:45], v[196:197], v[198:199] op_sel_hi:[1,0,0]
    v_pk_fma_f32 v[214:215], v[46:47], v[196:197], v[198:199] op_sel_hi:[1,0,0]
    v_cvt_pk_bf16_f32 v220, v208, v209
    v_cvt_pk_bf16_f32 v221, v210, v211
    v_cvt_pk_bf16_f32 v222, v212, v213
    v_cvt_pk_bf16_f32 v223, v214, v215
    v_pk_fma_f32 v[208:209], v[52:53], v[196:197], v[198:199] op_sel_hi:[1,0,0]
    v_pk_fma_f32 v[210:211], v[54:55], v[196:197], v[198:199] op_sel_hi:[1,0,0]
    v_pk_fma_f32 v[212:213], v[60:61], v[196:197], v[198:199] op_sel_hi:[1,0,0]
    v_pk_fma_f32 v[214:215], v[62:63], v[196:197], v[198:199] op_sel_hi:[1,0,0]
    v_cvt_pk_bf16_f32 v228, v208, v209
    v_cvt_pk_bf16_f32 v229, v210, v211
    v_cvt_pk_bf16_f32 v230, v212, v213
    v_cvt_pk_bf16_f32 v231, v214, v215
    s_mov_b32 s85, 0x40000
    s_waitcnt vmcnt(12)
    v_readfirstlane_b32 s84, v22
    s_nop 0
    s_cmp_ge_u32 s84, 3
    s_cbranch_scc1 standalone__conformer_family_zipformer__speech_kernel_spinv21_6x
standalone__conformer_family_zipformer__speech_kernel_spinv21_6:
    buffer_load_dword v22, v21, s[24:27], s80 offen sc1
    s_waitcnt vmcnt(0)
    s_sub_u32 s85, s85, 1
    s_cbranch_scc1 standalone__conformer_family_zipformer__speech_kernel_spinv21_6x
    v_readfirstlane_b32 s84, v22
    s_nop 0
    s_cmp_ge_u32 s84, 3
    s_cbranch_scc0 standalone__conformer_family_zipformer__speech_kernel_spinv21_6
standalone__conformer_family_zipformer__speech_kernel_spinv21_6x:
    s_cmp_eq_u32 s83, 0
    s_cbranch_scc1 standalone__conformer_family_zipformer__speech_kernel_sndv21_7s
    buffer_store_dwordx4 v[216:219], v31, s[52:55], s13 offen offset:0
    buffer_store_dwordx4 v[220:223], v31, s[52:55], s13 offen offset:1024
    buffer_store_dwordx4 v[224:227], v31, s[52:55], s13 offen offset:2048
    buffer_store_dwordx4 v[228:231], v31, s[52:55], s13 offen offset:3072
    s_branch standalone__conformer_family_zipformer__speech_kernel_sndv21_7e
standalone__conformer_family_zipformer__speech_kernel_sndv21_7s:
    buffer_store_dwordx4 v[216:219], v31, s[52:55], s13 offen offset:0 sc1
    buffer_store_dwordx4 v[220:223], v31, s[52:55], s13 offen offset:1024 sc1
    buffer_store_dwordx4 v[224:227], v31, s[52:55], s13 offen offset:2048 sc1
    buffer_store_dwordx4 v[228:231], v31, s[52:55], s13 offen offset:3072 sc1
standalone__conformer_family_zipformer__speech_kernel_sndv21_7e:
    ds_write_b128 v27, v[216:219] offset:0
    ds_write_b128 v27, v[220:223] offset:1024
    ds_write_b128 v27, v[224:227] offset:4096
    ds_write_b128 v27, v[228:231] offset:5120
    s_waitcnt lgkmcnt(0)
    s_barrier
    ds_read_b128 a[0:3], v26 offset:0
    ds_read_b128 a[4:7], v26 offset:1024
    ds_read_b128 a[16:19], v26 offset:4096
    ds_read_b128 a[20:23], v26 offset:5120
    ds_read_b128 a[32:35], v26 offset:8192
    ds_read_b128 a[36:39], v26 offset:9216
    ds_read_b128 a[48:51], v26 offset:12288
    ds_read_b128 a[52:55], v26 offset:13312
    ds_read_b128 a[64:67], v26 offset:16384
    ds_read_b128 a[68:71], v26 offset:17408
    ds_read_b128 a[80:83], v26 offset:20480
    ds_read_b128 a[84:87], v26 offset:21504
    ds_read_b128 a[96:99], v26 offset:24576
    ds_read_b128 a[100:103], v26 offset:25600
    ds_read_b128 a[112:115], v26 offset:28672
    ds_read_b128 a[116:119], v26 offset:29696
    s_waitcnt lgkmcnt(15)
    v_mfma_f32_16x16x32_bf16 v[128:131], a[160:163], a[0:3], 0
    s_waitcnt lgkmcnt(14)
    v_mfma_f32_16x16x32_bf16 v[132:135], a[160:163], a[4:7], 0
    v_mfma_f32_16x16x32_bf16 v[144:147], a[164:167], a[0:3], 0
    v_mfma_f32_16x16x32_bf16 v[148:151], a[164:167], a[4:7], 0
    s_waitcnt lgkmcnt(13)
    v_mfma_f32_16x16x32_bf16 v[128:131], a[168:171], a[16:19], v[128:131]
    s_waitcnt lgkmcnt(12)
    v_mfma_f32_16x16x32_bf16 v[132:135], a[168:171], a[20:23], v[132:135]
    v_mfma_f32_16x16x32_bf16 v[144:147], a[172:175], a[16:19], v[144:147]
    v_mfma_f32_16x16x32_bf16 v[148:151], a[172:175], a[20:23], v[148:151]
    s_waitcnt lgkmcnt(11)
    v_mfma_f32_16x16x32_bf16 v[128:131], a[176:179], a[32:35], v[128:131]
    s_waitcnt lgkmcnt(10)
    v_mfma_f32_16x16x32_bf16 v[132:135], a[176:179], a[36:39], v[132:135]
    v_mfma_f32_16x16x32_bf16 v[144:147], a[180:183], a[32:35], v[144:147]
    v_mfma_f32_16x16x32_bf16 v[148:151], a[180:183], a[36:39], v[148:151]
    s_waitcnt lgkmcnt(9)
    v_mfma_f32_16x16x32_bf16 v[128:131], a[184:187], a[48:51], v[128:131]
    s_waitcnt lgkmcnt(8)
    v_mfma_f32_16x16x32_bf16 v[132:135], a[184:187], a[52:55], v[132:135]
    v_mfma_f32_16x16x32_bf16 v[144:147], a[188:191], a[48:51], v[144:147]
    v_mfma_f32_16x16x32_bf16 v[148:151], a[188:191], a[52:55], v[148:151]
    s_waitcnt lgkmcnt(7)
    v_mfma_f32_16x16x32_bf16 v[128:131], a[192:195], a[64:67], v[128:131]
    s_waitcnt lgkmcnt(6)
    v_mfma_f32_16x16x32_bf16 v[132:135], a[192:195], a[68:71], v[132:135]
    v_mfma_f32_16x16x32_bf16 v[144:147], a[196:199], a[64:67], v[144:147]
    v_mfma_f32_16x16x32_bf16 v[148:151], a[196:199], a[68:71], v[148:151]
    s_waitcnt lgkmcnt(5)
    v_mfma_f32_16x16x32_bf16 v[128:131], a[200:203], a[80:83], v[128:131]
    s_waitcnt lgkmcnt(4)
    v_mfma_f32_16x16x32_bf16 v[132:135], a[200:203], a[84:87], v[132:135]
    v_mfma_f32_16x16x32_bf16 v[144:147], a[204:207], a[80:83], v[144:147]
    v_mfma_f32_16x16x32_bf16 v[148:151], a[204:207], a[84:87], v[148:151]
    s_waitcnt lgkmcnt(3)
    v_mfma_f32_16x16x32_bf16 v[128:131], a[208:211], a[96:99], v[128:131]
    s_waitcnt lgkmcnt(2)
    v_mfma_f32_16x16x32_bf16 v[132:135], a[208:211], a[100:103], v[132:135]
    v_mfma_f32_16x16x32_bf16 v[144:147], a[212:215], a[96:99], v[144:147]
    v_mfma_f32_16x16x32_bf16 v[148:151], a[212:215], a[100:103], v[148:151]
    s_waitcnt lgkmcnt(1)
    v_mfma_f32_16x16x32_bf16 v[128:131], a[216:219], a[112:115], v[128:131]
    s_waitcnt lgkmcnt(0)
    v_mfma_f32_16x16x32_bf16 v[132:135], a[216:219], a[116:119], v[132:135]
    v_mfma_f32_16x16x32_bf16 v[144:147], a[220:223], a[112:115], v[144:147]
    v_mfma_f32_16x16x32_bf16 v[148:151], a[220:223], a[116:119], v[148:151]
    s_waitcnt vmcnt(8)
    v_mfma_f32_16x16x32_bf16 v[160:163], a[128:131], a[0:3], 0
    v_mfma_f32_16x16x32_bf16 v[164:167], a[128:131], a[4:7], 0
    v_mfma_f32_16x16x32_bf16 v[176:179], a[132:135], a[0:3], 0
    v_mfma_f32_16x16x32_bf16 v[180:183], a[132:135], a[4:7], 0
    v_mfma_f32_16x16x32_bf16 v[160:163], a[136:139], a[16:19], v[160:163]
    v_mfma_f32_16x16x32_bf16 v[164:167], a[136:139], a[20:23], v[164:167]
    v_mfma_f32_16x16x32_bf16 v[176:179], a[140:143], a[16:19], v[176:179]
    v_mfma_f32_16x16x32_bf16 v[180:183], a[140:143], a[20:23], v[180:183]
    s_waitcnt vmcnt(4)
    v_mfma_f32_16x16x32_bf16 v[160:163], a[144:147], a[32:35], v[160:163]
    buffer_load_dwordx4 v[64:67], v31, s[52:55], s12 offen offset:0 sc1
    v_mfma_f32_16x16x32_bf16 v[164:167], a[144:147], a[36:39], v[164:167]
    buffer_load_dwordx4 v[68:71], v31, s[52:55], s12 offen offset:1024 sc1
    v_mfma_f32_16x16x32_bf16 v[176:179], a[148:151], a[32:35], v[176:179]
    v_mfma_f32_16x16x32_bf16 v[180:183], a[148:151], a[36:39], v[180:183]
    buffer_load_dwordx4 v[72:75], v31, s[52:55], s12 offen offset:2048 sc1
    v_mfma_f32_16x16x32_bf16 v[160:163], a[152:155], a[48:51], v[160:163]
    v_mfma_f32_16x16x32_bf16 v[164:167], a[152:155], a[52:55], v[164:167]
    buffer_load_dwordx4 v[76:79], v31, s[52:55], s12 offen offset:3072 sc1
    v_mfma_f32_16x16x32_bf16 v[176:179], a[156:159], a[48:51], v[176:179]
    v_mfma_f32_16x16x32_bf16 v[180:183], a[156:159], a[52:55], v[180:183]
    v_mfma_f32_16x16x32_bf16 v[160:163], v[80:83], a[64:67], v[160:163]
    v_mfma_f32_16x16x32_bf16 v[164:167], v[80:83], a[68:71], v[164:167]
    v_mfma_f32_16x16x32_bf16 v[176:179], v[84:87], a[64:67], v[176:179]
    v_mfma_f32_16x16x32_bf16 v[180:183], v[84:87], a[68:71], v[180:183]
    v_mfma_f32_16x16x32_bf16 v[160:163], v[88:91], a[80:83], v[160:163]
    v_mfma_f32_16x16x32_bf16 v[164:167], v[88:91], a[84:87], v[164:167]
    v_mfma_f32_16x16x32_bf16 v[176:179], v[92:95], a[80:83], v[176:179]
    v_mfma_f32_16x16x32_bf16 v[180:183], v[92:95], a[84:87], v[180:183]
    v_mfma_f32_16x16x32_bf16 v[160:163], v[96:99], a[96:99], v[160:163]
    v_mfma_f32_16x16x32_bf16 v[164:167], v[96:99], a[100:103], v[164:167]
    v_mfma_f32_16x16x32_bf16 v[176:179], v[100:103], a[96:99], v[176:179]
    v_mfma_f32_16x16x32_bf16 v[180:183], v[100:103], a[100:103], v[180:183]
    v_mfma_f32_16x16x32_bf16 v[160:163], v[104:107], a[112:115], v[160:163]
    v_mfma_f32_16x16x32_bf16 v[164:167], v[104:107], a[116:119], v[164:167]
    v_mfma_f32_16x16x32_bf16 v[176:179], v[108:111], a[112:115], v[176:179]
    v_mfma_f32_16x16x32_bf16 v[180:183], v[108:111], a[116:119], v[180:183]
    s_mov_b32 s85, 0x40000
    s_waitcnt vmcnt(0)
    s_branch standalone__conformer_family_zipformer__speech_kernel_rcvv21_8c
standalone__conformer_family_zipformer__speech_kernel_rcvv21_8:
    buffer_load_dwordx4 v[64:67], v31, s[52:55], s12 offen offset:0 sc1
    buffer_load_dwordx4 v[68:71], v31, s[52:55], s12 offen offset:1024 sc1
    buffer_load_dwordx4 v[72:75], v31, s[52:55], s12 offen offset:2048 sc1
    buffer_load_dwordx4 v[76:79], v31, s[52:55], s12 offen offset:3072 sc1
standalone__conformer_family_zipformer__speech_kernel_rcvv21_8c:
    s_waitcnt vmcnt(3)
    v_max3_u32 v192, v64, v65, v66
    s_waitcnt vmcnt(2)
    v_max3_u32 v192, v192, v67, v68
    v_max3_u32 v192, v192, v69, v70
    s_waitcnt vmcnt(1)
    v_max3_u32 v192, v192, v71, v72
    v_max3_u32 v192, v192, v73, v74
    s_waitcnt vmcnt(0)
    v_max3_u32 v192, v192, v75, v76
    v_max3_u32 v192, v192, v77, v78
    v_max_u32 v192, v192, v79
    s_sub_u32 s85, s85, 1
    s_cbranch_scc1 standalone__conformer_family_zipformer__speech_kernel_rcvv21_8x
    v_cmp_eq_u32 vcc, -1, v192
    s_nop 0
    s_cmp_lg_u64 vcc, 0
    s_cbranch_scc1 standalone__conformer_family_zipformer__speech_kernel_rcvv21_8
standalone__conformer_family_zipformer__speech_kernel_rcvv21_8x:
    ds_write_b128 v27, v[64:67] offset:2048
    ds_write_b128 v27, v[68:71] offset:3072
    ds_write_b128 v27, v[72:75] offset:6144
    ds_write_b128 v27, v[76:79] offset:7168
    v_mov_b32 v200, -1
    v_mov_b32 v201, -1
    v_mov_b32 v202, -1
    v_mov_b32 v203, -1
    s_cmp_eq_u32 s83, 0
    s_cbranch_scc1 standalone__conformer_family_zipformer__speech_kernel_sndv21_9s
    buffer_store_dwordx4 v[200:203], v31, s[52:55], s12 offen offset:0
    buffer_store_dwordx4 v[200:203], v31, s[52:55], s12 offen offset:1024
    buffer_store_dwordx4 v[200:203], v31, s[52:55], s12 offen offset:2048
    buffer_store_dwordx4 v[200:203], v31, s[52:55], s12 offen offset:3072
    s_branch standalone__conformer_family_zipformer__speech_kernel_sndv21_9e
standalone__conformer_family_zipformer__speech_kernel_sndv21_9s:
    buffer_store_dwordx4 v[200:203], v31, s[52:55], s12 offen offset:0 sc1
    buffer_store_dwordx4 v[200:203], v31, s[52:55], s12 offen offset:1024 sc1
    buffer_store_dwordx4 v[200:203], v31, s[52:55], s12 offen offset:2048 sc1
    buffer_store_dwordx4 v[200:203], v31, s[52:55], s12 offen offset:3072 sc1
standalone__conformer_family_zipformer__speech_kernel_sndv21_9e:
    s_waitcnt lgkmcnt(0)
    s_barrier
    ds_read_b128 a[8:11], v26 offset:2048
    ds_read_b128 a[12:15], v26 offset:3072
    ds_read_b128 a[24:27], v26 offset:6144
    ds_read_b128 a[28:31], v26 offset:7168
    s_waitcnt lgkmcnt(3)
    v_mfma_f32_16x16x32_bf16 v[136:139], a[160:163], a[8:11], 0
    ds_read_b128 a[40:43], v26 offset:10240
    v_exp_f32 v192, v128
    s_waitcnt lgkmcnt(3)
    v_mfma_f32_16x16x32_bf16 v[140:143], a[160:163], a[12:15], 0
    ds_read_b128 a[44:47], v26 offset:11264
    v_exp_f32 v193, v129
    v_mfma_f32_16x16x32_bf16 v[152:155], a[164:167], a[8:11], 0
    v_exp_f32 v194, v130
    v_exp_f32 v195, v131
    v_mfma_f32_16x16x32_bf16 v[156:159], a[164:167], a[12:15], 0
    ds_read_b128 a[56:59], v26 offset:14336
    v_add_f32 v192, 1.0, v192
    v_add_f32 v193, 1.0, v193
    s_waitcnt lgkmcnt(4)
    v_mfma_f32_16x16x32_bf16 v[136:139], a[168:171], a[24:27], v[136:139]
    ds_read_b128 a[60:63], v26 offset:15360
    v_add_f32 v194, 1.0, v194
    v_add_f32 v195, 1.0, v195
    s_waitcnt lgkmcnt(4)
    v_mfma_f32_16x16x32_bf16 v[140:143], a[168:171], a[28:31], v[140:143]
    v_rcp_f32 v192, v192
    v_mfma_f32_16x16x32_bf16 v[152:155], a[172:175], a[24:27], v[152:155]
    v_rcp_f32 v193, v193
    v_rcp_f32 v194, v194
    v_mfma_f32_16x16x32_bf16 v[156:159], a[172:175], a[28:31], v[156:159]
    s_waitcnt lgkmcnt(3)
    v_rcp_f32 v195, v195
    v_mul_f32 v192, v128, v192
    v_mfma_f32_16x16x32_bf16 v[136:139], a[176:179], a[40:43], v[136:139]
    ds_read_b128 a[72:75], v26 offset:18432
    v_mul_f32 v193, v129, v193
    v_mul_f32 v194, v130, v194
    s_waitcnt lgkmcnt(3)
    v_mfma_f32_16x16x32_bf16 v[140:143], a[176:179], a[44:47], v[140:143]
    ds_read_b128 a[76:79], v26 offset:19456
    v_mul_f32 v195, v131, v195
    v_cvt_pk_bf16_f32 v128, v192, v193
    v_mfma_f32_16x16x32_bf16 v[152:155], a[180:183], a[40:43], v[152:155]
    v_cvt_pk_bf16_f32 v129, v194, v195
    v_exp_f32 v196, v144
    v_mfma_f32_16x16x32_bf16 v[156:159], a[180:183], a[44:47], v[156:159]
    ds_read_b128 a[88:91], v26 offset:22528
    v_exp_f32 v197, v145
    s_waitcnt lgkmcnt(4)
    v_mfma_f32_16x16x32_bf16 v[136:139], a[184:187], a[56:59], v[136:139]
    ds_read_b128 a[92:95], v26 offset:23552
    v_exp_f32 v198, v146
    s_waitcnt lgkmcnt(4)
    v_mfma_f32_16x16x32_bf16 v[140:143], a[184:187], a[60:63], v[140:143]
    v_exp_f32 v199, v147
    v_add_f32 v196, 1.0, v196
    v_add_f32 v197, 1.0, v197
    v_mfma_f32_16x16x32_bf16 v[152:155], a[188:191], a[56:59], v[152:155]
    v_add_f32 v198, 1.0, v198
    v_add_f32 v199, 1.0, v199
    v_mfma_f32_16x16x32_bf16 v[156:159], a[188:191], a[60:63], v[156:159]
    s_waitcnt lgkmcnt(3)
    v_rcp_f32 v196, v196
    v_rcp_f32 v197, v197
    v_mfma_f32_16x16x32_bf16 v[136:139], a[192:195], a[72:75], v[136:139]
    s_add_u32 s29, s31, 655360
    ds_read_b128 a[104:107], v26 offset:26624
    v_rcp_f32 v198, v198
    s_waitcnt lgkmcnt(3)
    v_mfma_f32_16x16x32_bf16 v[140:143], a[192:195], a[76:79], v[140:143]
    buffer_load_dwordx4 a[192:195], v31, s[24:27], s29 offen offset:0
    ds_read_b128 a[108:111], v26 offset:27648
    v_rcp_f32 v199, v199
    v_mfma_f32_16x16x32_bf16 v[152:155], a[196:199], a[72:75], v[152:155]
    v_mul_f32 v196, v144, v196
    v_mul_f32 v197, v145, v197
    v_mul_f32 v198, v146, v198
    v_mul_f32 v199, v147, v199
    v_mfma_f32_16x16x32_bf16 v[156:159], a[196:199], a[76:79], v[156:159]
    buffer_load_dwordx4 a[196:199], v31, s[24:27], s29 offen offset:1024
    ds_read_b128 a[120:123], v26 offset:30720
    v_cvt_pk_bf16_f32 v130, v196, v197
    v_cvt_pk_bf16_f32 v131, v198, v199
    s_waitcnt lgkmcnt(4)
    v_mfma_f32_16x16x32_bf16 v[136:139], a[200:203], a[88:91], v[136:139]
    ds_write_b128 v23, v[128:131] offset:0
    ds_read_b128 a[124:127], v26 offset:31744
    s_waitcnt lgkmcnt(5)
    v_mfma_f32_16x16x32_bf16 v[140:143], a[200:203], a[92:95], v[140:143]
    buffer_load_dwordx4 a[200:203], v31, s[24:27], s29 offen offset:2048
    v_exp_f32 v192, v132
    v_mfma_f32_16x16x32_bf16 v[152:155], a[204:207], a[88:91], v[152:155]
    v_exp_f32 v193, v133
    v_exp_f32 v194, v134
    v_mfma_f32_16x16x32_bf16 v[156:159], a[204:207], a[92:95], v[156:159]
    buffer_load_dwordx4 a[204:207], v31, s[24:27], s29 offen offset:3072
    v_exp_f32 v195, v135
    s_waitcnt lgkmcnt(4)
    v_mfma_f32_16x16x32_bf16 v[136:139], a[208:211], a[104:107], v[136:139]
    s_add_u32 s29, s31, 659456
    v_add_f32 v192, 1.0, v192
    v_add_f32 v193, 1.0, v193
    s_waitcnt lgkmcnt(3)
    v_mfma_f32_16x16x32_bf16 v[140:143], a[208:211], a[108:111], v[140:143]
    buffer_load_dwordx4 a[208:211], v31, s[24:27], s29 offen offset:0
    v_add_f32 v194, 1.0, v194
    v_add_f32 v195, 1.0, v195
    v_mfma_f32_16x16x32_bf16 v[152:155], a[212:215], a[104:107], v[152:155]
    v_rcp_f32 v192, v192
    v_rcp_f32 v193, v193
    v_mfma_f32_16x16x32_bf16 v[156:159], a[212:215], a[108:111], v[156:159]
    buffer_load_dwordx4 a[212:215], v31, s[24:27], s29 offen offset:1024
    v_rcp_f32 v194, v194
    s_waitcnt lgkmcnt(2)
    v_mfma_f32_16x16x32_bf16 v[136:139], a[216:219], a[120:123], v[136:139]
    s_waitcnt lgkmcnt(0)
    v_rcp_f32 v195, v195
    v_mul_f32 v192, v132, v192
    v_mfma_f32_16x16x32_bf16 v[140:143], a[216:219], a[124:127], v[140:143]
    buffer_load_dwordx4 a[216:219], v31, s[24:27], s29 offen offset:2048
    v_mul_f32 v193, v133, v193
    v_mul_f32 v194, v134, v194
    v_mfma_f32_16x16x32_bf16 v[152:155], a[220:223], a[120:123], v[152:155]
    v_mul_f32 v195, v135, v195
    v_cvt_pk_bf16_f32 v132, v192, v193
    v_cvt_pk_bf16_f32 v133, v194, v195
    v_mfma_f32_16x16x32_bf16 v[156:159], a[220:223], a[124:127], v[156:159]
    buffer_load_dwordx4 a[220:223], v31, s[24:27], s29 offen offset:3072
    v_exp_f32 v196, v148
    v_mfma_f32_16x16x32_bf16 v[168:171], a[128:131], a[8:11], 0
    s_add_u32 s29, s31, 663552
    v_exp_f32 v197, v149
    v_mfma_f32_16x16x32_bf16 v[172:175], a[128:131], a[12:15], 0
    buffer_load_dwordx4 a[128:131], v31, s[24:27], s29 offen offset:0
    v_exp_f32 v198, v150
    v_mfma_f32_16x16x32_bf16 v[184:187], a[132:135], a[8:11], 0
    v_exp_f32 v199, v151
    v_add_f32 v196, 1.0, v196
    v_add_f32 v197, 1.0, v197
    v_mfma_f32_16x16x32_bf16 v[188:191], a[132:135], a[12:15], 0
    buffer_load_dwordx4 a[132:135], v31, s[24:27], s29 offen offset:1024
    v_add_f32 v198, 1.0, v198
    v_add_f32 v199, 1.0, v199
    v_mfma_f32_16x16x32_bf16 v[168:171], a[136:139], a[24:27], v[168:171]
    v_rcp_f32 v196, v196
    v_rcp_f32 v197, v197
    v_mfma_f32_16x16x32_bf16 v[172:175], a[136:139], a[28:31], v[172:175]
    buffer_load_dwordx4 a[136:139], v31, s[24:27], s29 offen offset:2048
    v_rcp_f32 v198, v198
    v_mfma_f32_16x16x32_bf16 v[184:187], a[140:143], a[24:27], v[184:187]
    v_rcp_f32 v199, v199
    v_mul_f32 v196, v148, v196
    v_mfma_f32_16x16x32_bf16 v[188:191], a[140:143], a[28:31], v[188:191]
    buffer_load_dwordx4 a[140:143], v31, s[24:27], s29 offen offset:3072
    v_mul_f32 v197, v149, v197
    v_mul_f32 v198, v150, v198
    v_mfma_f32_16x16x32_bf16 v[168:171], a[144:147], a[40:43], v[168:171]
    s_add_u32 s29, s31, 667648
    v_mul_f32 v199, v151, v199
    v_cvt_pk_bf16_f32 v134, v196, v197
    v_mfma_f32_16x16x32_bf16 v[172:175], a[144:147], a[44:47], v[172:175]
    buffer_load_dwordx4 a[144:147], v31, s[24:27], s29 offen offset:0
    v_cvt_pk_bf16_f32 v135, v198, v199
    v_mfma_f32_16x16x32_bf16 v[184:187], a[148:151], a[40:43], v[184:187]
    ds_write_b128 v23, v[132:135] offset:1024
    v_mfma_f32_16x16x32_bf16 v[188:191], a[148:151], a[44:47], v[188:191]
    buffer_load_dwordx4 a[148:151], v31, s[24:27], s29 offen offset:1024
    v_exp_f32 v192, v160
    v_exp_f32 v193, v161
    v_mfma_f32_16x16x32_bf16 v[168:171], a[152:155], a[56:59], v[168:171]
    v_exp_f32 v194, v162
    v_mfma_f32_16x16x32_bf16 v[172:175], a[152:155], a[60:63], v[172:175]
    buffer_load_dwordx4 a[152:155], v31, s[24:27], s29 offen offset:2048
    v_exp_f32 v195, v163
    v_add_f32 v192, 1.0, v192
    v_mfma_f32_16x16x32_bf16 v[184:187], a[156:159], a[56:59], v[184:187]
    v_add_f32 v193, 1.0, v193
    v_add_f32 v194, 1.0, v194
    v_add_f32 v195, 1.0, v195
    v_mfma_f32_16x16x32_bf16 v[188:191], a[156:159], a[60:63], v[188:191]
    buffer_load_dwordx4 a[156:159], v31, s[24:27], s29 offen offset:3072
    v_rcp_f32 v192, v192
    v_mfma_f32_16x16x32_bf16 v[168:171], v[80:83], a[72:75], v[168:171]
    s_add_u32 s29, s31, 1048576
    v_rcp_f32 v193, v193
    v_mfma_f32_16x16x32_bf16 v[172:175], v[80:83], a[76:79], v[172:175]
    buffer_load_dwordx4 a[160:163], v31, s[24:27], s29 offen offset:0
    v_rcp_f32 v194, v194
    v_mfma_f32_16x16x32_bf16 v[184:187], v[84:87], a[72:75], v[184:187]
    v_rcp_f32 v195, v195
    v_mul_f32 v192, v160, v192
    v_mul_f32 v193, v161, v193
    v_mfma_f32_16x16x32_bf16 v[188:191], v[84:87], a[76:79], v[188:191]
    buffer_load_dwordx4 a[164:167], v31, s[24:27], s29 offen offset:1024
    v_mul_f32 v194, v162, v194
    v_mul_f32 v195, v163, v195
    v_mfma_f32_16x16x32_bf16 v[168:171], v[88:91], a[88:91], v[168:171]
    v_cvt_pk_bf16_f32 v160, v192, v193
    v_cvt_pk_bf16_f32 v161, v194, v195
    v_exp_f32 v196, v176
    v_mfma_f32_16x16x32_bf16 v[172:175], v[88:91], a[92:95], v[172:175]
    buffer_load_dwordx4 a[168:171], v31, s[24:27], s29 offen offset:2048
    v_exp_f32 v197, v177
    v_mfma_f32_16x16x32_bf16 v[184:187], v[92:95], a[88:91], v[184:187]
    v_exp_f32 v198, v178
    v_mfma_f32_16x16x32_bf16 v[188:191], v[92:95], a[92:95], v[188:191]
    buffer_load_dwordx4 a[172:175], v31, s[24:27], s29 offen offset:3072
    v_exp_f32 v199, v179
    v_add_f32 v196, 1.0, v196
    v_mfma_f32_16x16x32_bf16 v[168:171], v[96:99], a[104:107], v[168:171]
    s_add_u32 s29, s31, 1056768
    v_add_f32 v197, 1.0, v197
    v_add_f32 v198, 1.0, v198
    v_mfma_f32_16x16x32_bf16 v[172:175], v[96:99], a[108:111], v[172:175]
    buffer_load_dwordx4 a[176:179], v31, s[24:27], s29 offen offset:0
    v_add_f32 v199, 1.0, v199
    v_rcp_f32 v196, v196
    v_mfma_f32_16x16x32_bf16 v[184:187], v[100:103], a[104:107], v[184:187]
    v_rcp_f32 v197, v197
    v_mfma_f32_16x16x32_bf16 v[188:191], v[100:103], a[108:111], v[188:191]
    buffer_load_dwordx4 a[180:183], v31, s[24:27], s29 offen offset:1024
    v_rcp_f32 v198, v198
    v_rcp_f32 v199, v199
    v_mfma_f32_16x16x32_bf16 v[168:171], v[104:107], a[120:123], v[168:171]
    v_mul_f32 v196, v176, v196
    v_mul_f32 v197, v177, v197
    v_mfma_f32_16x16x32_bf16 v[172:175], v[104:107], a[124:127], v[172:175]
    buffer_load_dwordx4 a[184:187], v31, s[24:27], s29 offen offset:2048
    v_mul_f32 v198, v178, v198
    v_mul_f32 v199, v179, v199
    v_cvt_pk_bf16_f32 v162, v196, v197
    v_mfma_f32_16x16x32_bf16 v[184:187], v[108:111], a[120:123], v[184:187]
    v_cvt_pk_bf16_f32 v163, v198, v199
    v_mfma_f32_16x16x32_bf16 v[188:191], v[108:111], a[124:127], v[188:191]
    ds_write_b128 v23, v[160:163] offset:4096
    buffer_load_dwordx4 a[188:191], v31, s[24:27], s29 offen offset:3072
    s_waitcnt vmcnt(24)
    v_mov_b32 v22, 4
    s_cmp_eq_u32 s83, 0
    s_cbranch_scc1 standalone__conformer_family_zipformer__speech_kernel_sndv21_10s
    buffer_store_dword v22, v21, s[24:27], s81 offen
    s_branch standalone__conformer_family_zipformer__speech_kernel_sndv21_10e
standalone__conformer_family_zipformer__speech_kernel_sndv21_10s:
    buffer_store_dword v22, v21, s[24:27], s81 offen sc1
standalone__conformer_family_zipformer__speech_kernel_sndv21_10e:
    s_waitcnt vmcnt(21)
    v_mfma_f32_16x16x32_bf16 v[208:211], a[192:195], a[0:3], 0
    s_add_u32 s29, s31, 1064960
    v_exp_f32 v192, v136
    v_mfma_f32_16x16x32_bf16 v[212:215], a[192:195], a[4:7], 0
    v_exp_f32 v193, v137
    v_mfma_f32_16x16x32_bf16 v[216:219], a[192:195], a[8:11], 0
    v_exp_f32 v194, v138
    v_exp_f32 v195, v139
    v_mfma_f32_16x16x32_bf16 v[220:223], a[192:195], a[12:15], 0
    buffer_load_dwordx4 a[192:195], v31, s[24:27], s29 offen offset:0
    v_add_f32 v192, 1.0, v192
    v_add_f32 v193, 1.0, v193
    v_mfma_f32_16x16x32_bf16 v[224:227], a[196:199], a[0:3], 0
    v_add_f32 v194, 1.0, v194
    v_add_f32 v195, 1.0, v195
    v_mfma_f32_16x16x32_bf16 v[228:231], a[196:199], a[4:7], 0
    v_rcp_f32 v192, v192
    v_rcp_f32 v193, v193
    v_mfma_f32_16x16x32_bf16 v[232:235], a[196:199], a[8:11], 0
    v_rcp_f32 v194, v194
    v_mfma_f32_16x16x32_bf16 v[236:239], a[196:199], a[12:15], 0
    buffer_load_dwordx4 a[196:199], v31, s[24:27], s29 offen offset:1024
    v_rcp_f32 v195, v195
    v_mul_f32 v192, v136, v192
    v_mfma_f32_16x16x32_bf16 v[208:211], a[200:203], a[16:19], v[208:211]
    v_mul_f32 v193, v137, v193
    v_mul_f32 v194, v138, v194
    v_mfma_f32_16x16x32_bf16 v[212:215], a[200:203], a[20:23], v[212:215]
    v_mul_f32 v195, v139, v195
    v_cvt_pk_bf16_f32 v136, v192, v193
    v_cvt_pk_bf16_f32 v137, v194, v195
    v_mfma_f32_16x16x32_bf16 v[216:219], a[200:203], a[24:27], v[216:219]
    v_exp_f32 v196, v152
    v_exp_f32 v197, v153
    v_mfma_f32_16x16x32_bf16 v[220:223], a[200:203], a[28:31], v[220:223]
    buffer_load_dwordx4 a[200:203], v31, s[24:27], s29 offen offset:2048
    v_exp_f32 v198, v154
    v_mfma_f32_16x16x32_bf16 v[224:227], a[204:207], a[16:19], v[224:227]
    v_exp_f32 v199, v155
    v_mfma_f32_16x16x32_bf16 v[228:231], a[204:207], a[20:23], v[228:231]
    v_add_f32 v196, 1.0, v196
    v_add_f32 v197, 1.0, v197
    v_add_f32 v198, 1.0, v198
    v_mfma_f32_16x16x32_bf16 v[232:235], a[204:207], a[24:27], v[232:235]
    v_add_f32 v199, 1.0, v199
    v_rcp_f32 v196, v196
    v_mfma_f32_16x16x32_bf16 v[236:239], a[204:207], a[28:31], v[236:239]
    buffer_load_dwordx4 a[204:207], v31, s[24:27], s29 offen offset:3072
    v_rcp_f32 v197, v197
    s_waitcnt vmcnt(21)
    v_mfma_f32_16x16x32_bf16 v[208:211], a[208:211], a[32:35], v[208:211]
    s_add_u32 s29, s31, 1073152
    v_rcp_f32 v198, v198
    v_mfma_f32_16x16x32_bf16 v[212:215], a[208:211], a[36:39], v[212:215]
    v_rcp_f32 v199, v199
    v_mul_f32 v196, v152, v196
    v_mfma_f32_16x16x32_bf16 v[216:219], a[208:211], a[40:43], v[216:219]
    v_mul_f32 v197, v153, v197
    v_mul_f32 v198, v154, v198
    v_mul_f32 v199, v155, v199
    v_mfma_f32_16x16x32_bf16 v[220:223], a[208:211], a[44:47], v[220:223]
    buffer_load_dwordx4 a[208:211], v31, s[24:27], s29 offen offset:0
    v_cvt_pk_bf16_f32 v138, v196, v197
    v_cvt_pk_bf16_f32 v139, v198, v199
    v_mfma_f32_16x16x32_bf16 v[224:227], a[212:215], a[32:35], v[224:227]
    ds_write_b128 v23, v[136:139] offset:2048
    v_mfma_f32_16x16x32_bf16 v[228:231], a[212:215], a[36:39], v[228:231]
    v_exp_f32 v192, v140
    v_mfma_f32_16x16x32_bf16 v[232:235], a[212:215], a[40:43], v[232:235]
    v_exp_f32 v193, v141
    v_mfma_f32_16x16x32_bf16 v[236:239], a[212:215], a[44:47], v[236:239]
    buffer_load_dwordx4 a[212:215], v31, s[24:27], s29 offen offset:1024
    v_exp_f32 v194, v142
    v_mfma_f32_16x16x32_bf16 v[208:211], a[216:219], a[48:51], v[208:211]
    v_exp_f32 v195, v143
    v_add_f32 v192, 1.0, v192
    v_mfma_f32_16x16x32_bf16 v[212:215], a[216:219], a[52:55], v[212:215]
    v_add_f32 v193, 1.0, v193
    v_add_f32 v194, 1.0, v194
    v_add_f32 v195, 1.0, v195
    v_mfma_f32_16x16x32_bf16 v[216:219], a[216:219], a[56:59], v[216:219]
    v_rcp_f32 v192, v192
    v_rcp_f32 v193, v193
    v_mfma_f32_16x16x32_bf16 v[220:223], a[216:219], a[60:63], v[220:223]
    buffer_load_dwordx4 a[216:219], v31, s[24:27], s29 offen offset:2048
    v_rcp_f32 v194, v194
    v_mfma_f32_16x16x32_bf16 v[224:227], a[220:223], a[48:51], v[224:227]
    v_rcp_f32 v195, v195
    v_mfma_f32_16x16x32_bf16 v[228:231], a[220:223], a[52:55], v[228:231]
    v_mul_f32 v192, v140, v192
    v_mul_f32 v193, v141, v193
    v_mul_f32 v194, v142, v194
    v_mfma_f32_16x16x32_bf16 v[232:235], a[220:223], a[56:59], v[232:235]
    v_mul_f32 v195, v143, v195
    v_cvt_pk_bf16_f32 v140, v192, v193
    v_cvt_pk_bf16_f32 v141, v194, v195
    v_mfma_f32_16x16x32_bf16 v[236:239], a[220:223], a[60:63], v[236:239]
    buffer_load_dwordx4 a[220:223], v31, s[24:27], s29 offen offset:3072
    v_exp_f32 v196, v156
    s_waitcnt vmcnt(21)
    v_mfma_f32_16x16x32_bf16 v[208:211], a[128:131], a[64:67], v[208:211]
    s_add_u32 s29, s31, 671744
    v_exp_f32 v197, v157
    v_mfma_f32_16x16x32_bf16 v[212:215], a[128:131], a[68:71], v[212:215]
    v_exp_f32 v198, v158
    v_mfma_f32_16x16x32_bf16 v[216:219], a[128:131], a[72:75], v[216:219]
    v_exp_f32 v199, v159
    v_add_f32 v196, 1.0, v196
    v_add_f32 v197, 1.0, v197
    v_mfma_f32_16x16x32_bf16 v[220:223], a[128:131], a[76:79], v[220:223]
    buffer_load_dwordx4 a[128:131], v31, s[24:27], s29 offen offset:0
    v_add_f32 v198, 1.0, v198
    v_add_f32 v199, 1.0, v199
    v_mfma_f32_16x16x32_bf16 v[224:227], a[132:135], a[64:67], v[224:227]
    v_rcp_f32 v196, v196
    v_mfma_f32_16x16x32_bf16 v[228:231], a[132:135], a[68:71], v[228:231]
    v_rcp_f32 v197, v197
    v_rcp_f32 v198, v198
    v_mfma_f32_16x16x32_bf16 v[232:235], a[132:135], a[72:75], v[232:235]
    v_rcp_f32 v199, v199
    v_mul_f32 v196, v156, v196
    v_mfma_f32_16x16x32_bf16 v[236:239], a[132:135], a[76:79], v[236:239]
    buffer_load_dwordx4 a[132:135], v31, s[24:27], s29 offen offset:1024
    v_mul_f32 v197, v157, v197
    v_mul_f32 v198, v158, v198
    v_mfma_f32_16x16x32_bf16 v[208:211], a[136:139], a[80:83], v[208:211]
    v_mul_f32 v199, v159, v199
    v_cvt_pk_bf16_f32 v142, v196, v197
    v_mfma_f32_16x16x32_bf16 v[212:215], a[136:139], a[84:87], v[212:215]
    v_cvt_pk_bf16_f32 v143, v198, v199
    v_mfma_f32_16x16x32_bf16 v[216:219], a[136:139], a[88:91], v[216:219]
    ds_write_b128 v23, v[140:143] offset:3072
    v_exp_f32 v192, v164
    v_mfma_f32_16x16x32_bf16 v[220:223], a[136:139], a[92:95], v[220:223]
    buffer_load_dwordx4 a[136:139], v31, s[24:27], s29 offen offset:2048
    v_exp_f32 v193, v165
    v_mfma_f32_16x16x32_bf16 v[224:227], a[140:143], a[80:83], v[224:227]
    v_exp_f32 v194, v166
    v_mfma_f32_16x16x32_bf16 v[228:231], a[140:143], a[84:87], v[228:231]
    v_exp_f32 v195, v167
    v_add_f32 v192, 1.0, v192
    v_mfma_f32_16x16x32_bf16 v[232:235], a[140:143], a[88:91], v[232:235]
    v_add_f32 v193, 1.0, v193
    v_add_f32 v194, 1.0, v194
    v_add_f32 v195, 1.0, v195
    v_mfma_f32_16x16x32_bf16 v[236:239], a[140:143], a[92:95], v[236:239]
    buffer_load_dwordx4 a[140:143], v31, s[24:27], s29 offen offset:3072
    v_rcp_f32 v192, v192
    s_waitcnt lgkmcnt(0)
    s_barrier
    s_waitcnt vmcnt(21)
    v_mfma_f32_16x16x32_bf16 v[208:211], a[144:147], a[96:99], v[208:211]
    s_add_u32 s29, s31, 675840
    ds_read_b128 a[224:227], v31 offset:0
    v_rcp_f32 v193, v193
    v_mfma_f32_16x16x32_bf16 v[212:215], a[144:147], a[100:103], v[212:215]
    v_rcp_f32 v194, v194
    v_mfma_f32_16x16x32_bf16 v[216:219], a[144:147], a[104:107], v[216:219]
    v_rcp_f32 v195, v195
    v_mul_f32 v192, v164, v192
    v_mul_f32 v193, v165, v193
    v_mfma_f32_16x16x32_bf16 v[220:223], a[144:147], a[108:111], v[220:223]
    buffer_load_dwordx4 a[144:147], v31, s[24:27], s29 offen offset:0
    ds_read_b128 a[228:231], v31 offset:1024
    v_mul_f32 v194, v166, v194
    v_mfma_f32_16x16x32_bf16 v[224:227], a[148:151], a[96:99], v[224:227]
    v_mul_f32 v195, v167, v195
    v_cvt_pk_bf16_f32 v164, v192, v193
    v_cvt_pk_bf16_f32 v165, v194, v195
    v_mfma_f32_16x16x32_bf16 v[228:231], a[148:151], a[100:103], v[228:231]
    v_exp_f32 v196, v180
    v_exp_f32 v197, v181
    v_mfma_f32_16x16x32_bf16 v[232:235], a[148:151], a[104:107], v[232:235]
    ds_read_b128 a[232:235], v31 offset:2048
    v_exp_f32 v198, v182
    v_mfma_f32_16x16x32_bf16 v[236:239], a[148:151], a[108:111], v[236:239]
    buffer_load_dwordx4 a[148:151], v31, s[24:27], s29 offen offset:1024
    v_exp_f32 v199, v183
    v_mfma_f32_16x16x32_bf16 v[208:211], a[152:155], a[112:115], v[208:211]
    v_add_f32 v196, 1.0, v196
    v_add_f32 v197, 1.0, v197
    v_add_f32 v198, 1.0, v198
    v_mfma_f32_16x16x32_bf16 v[212:215], a[152:155], a[116:119], v[212:215]
    ds_read_b128 a[236:239], v31 offset:3072
    v_add_f32 v199, 1.0, v199
    v_mfma_f32_16x16x32_bf16 v[216:219], a[152:155], a[120:123], v[216:219]
    v_rcp_f32 v196, v196
    v_rcp_f32 v197, v197
    v_mfma_f32_16x16x32_bf16 v[220:223], a[152:155], a[124:127], v[220:223]
    buffer_load_dwordx4 a[152:155], v31, s[24:27], s29 offen offset:2048
    v_rcp_f32 v198, v198
    v_mfma_f32_16x16x32_bf16 v[224:227], a[156:159], a[112:115], v[224:227]
    v_rcp_f32 v199, v199
    v_mul_f32 v196, v180, v196
    v_mfma_f32_16x16x32_bf16 v[228:231], a[156:159], a[116:119], v[228:231]
    v_mul_f32 v197, v181, v197
    v_mul_f32 v198, v182, v198
    v_mul_f32 v199, v183, v199
    v_cvt_pk_bf16_f32 v166, v196, v197
    v_mfma_f32_16x16x32_bf16 v[232:235], a[156:159], a[120:123], v[232:235]
    v_cvt_pk_bf16_f32 v167, v198, v199
    v_mfma_f32_16x16x32_bf16 v[236:239], a[156:159], a[124:127], v[236:239]
    ds_write_b128 v23, v[164:167] offset:5120
    buffer_load_dwordx4 a[156:159], v31, s[24:27], s29 offen offset:3072
    s_waitcnt vmcnt(21) lgkmcnt(4)
    v_mfma_f32_16x16x32_bf16 v[64:67], a[160:163], a[224:227], 0
    s_add_u32 s29, s31, 679936
    ds_read_b128 a[240:243], v31 offset:8192
    v_exp_f32 v192, v168
    s_waitcnt lgkmcnt(4)
    v_mfma_f32_16x16x32_bf16 v[68:71], a[160:163], a[228:231], 0
    s_waitcnt lgkmcnt(3)
    v_exp_f32 v193, v169
    v_mfma_f32_16x16x32_bf16 v[72:75], a[160:163], a[232:235], 0
    s_waitcnt lgkmcnt(2)
    v_exp_f32 v194, v170
    v_exp_f32 v195, v171
    v_mfma_f32_16x16x32_bf16 v[76:79], a[160:163], a[236:239], 0
    buffer_load_dwordx4 a[160:163], v31, s[24:27], s29 offen offset:0
    ds_read_b128 a[244:247], v31 offset:9216
    v_add_f32 v192, 1.0, v192
    v_mfma_f32_16x16x32_bf16 v[80:83], a[164:167], a[224:227], 0
    v_add_f32 v193, 1.0, v193
    v_add_f32 v194, 1.0, v194
    v_add_f32 v195, 1.0, v195
    v_mfma_f32_16x16x32_bf16 v[84:87], a[164:167], a[228:231], 0
    v_rcp_f32 v192, v192
    v_rcp_f32 v193, v193
    v_mfma_f32_16x16x32_bf16 v[88:91], a[164:167], a[232:235], 0
    ds_read_b128 a[248:251], v31 offset:10240
    v_rcp_f32 v194, v194
    v_mfma_f32_16x16x32_bf16 v[92:95], a[164:167], a[236:239], 0
    buffer_load_dwordx4 a[164:167], v31, s[24:27], s29 offen offset:1024
    v_rcp_f32 v195, v195
    v_mfma_f32_16x16x32_bf16 v[96:99], a[168:171], a[224:227], 0
    v_mul_f32 v192, v168, v192
    v_mul_f32 v193, v169, v193
    v_mul_f32 v194, v170, v194
    v_mfma_f32_16x16x32_bf16 v[100:103], a[168:171], a[228:231], 0
    ds_read_b128 a[252:255], v31 offset:11264
    v_mul_f32 v195, v171, v195
    v_cvt_pk_bf16_f32 v168, v192, v193
    v_mfma_f32_16x16x32_bf16 v[104:107], a[168:171], a[232:235], 0
    v_cvt_pk_bf16_f32 v169, v194, v195
    v_exp_f32 v196, v184
    v_mfma_f32_16x16x32_bf16 v[108:111], a[168:171], a[236:239], 0
    buffer_load_dwordx4 a[168:171], v31, s[24:27], s29 offen offset:2048
    v_exp_f32 v197, v185
    v_mfma_f32_16x16x32_bf16 v[112:115], a[172:175], a[224:227], 0
    v_exp_f32 v198, v186
    v_exp_f32 v199, v187
    v_mfma_f32_16x16x32_bf16 v[116:119], a[172:175], a[228:231], 0
    v_add_f32 v196, 1.0, v196
    v_add_f32 v197, 1.0, v197
    v_add_f32 v198, 1.0, v198
    v_mfma_f32_16x16x32_bf16 v[120:123], a[172:175], a[232:235], 0
    v_add_f32 v199, 1.0, v199
    v_rcp_f32 v196, v196
    v_mfma_f32_16x16x32_bf16 v[124:127], a[172:175], a[236:239], 0
    buffer_load_dwordx4 a[172:175], v31, s[24:27], s29 offen offset:3072
    v_rcp_f32 v197, v197
    s_waitcnt vmcnt(21) lgkmcnt(3)
    v_mfma_f32_16x16x32_bf16 v[64:67], a[176:179], a[240:243], v[64:67]
    s_add_u32 s29, s31, 684032
    ds_read_b128 a[224:227], v31 offset:16384
    v_rcp_f32 v198, v198
    s_waitcnt lgkmcnt(3)
    v_mfma_f32_16x16x32_bf16 v[68:71], a[176:179], a[244:247], v[68:71]
    s_waitcnt lgkmcnt(2)
    v_rcp_f32 v199, v199
    v_mfma_f32_16x16x32_bf16 v[72:75], a[176:179], a[248:251], v[72:75]
    s_waitcnt lgkmcnt(1)
    v_mul_f32 v196, v184, v196
    v_mul_f32 v197, v185, v197
    v_mul_f32 v198, v186, v198
    v_mul_f32 v199, v187, v199
    v_mfma_f32_16x16x32_bf16 v[76:79], a[176:179], a[252:255], v[76:79]
    buffer_load_dwordx4 a[176:179], v31, s[24:27], s29 offen offset:0
    ds_read_b128 a[228:231], v31 offset:17408
    v_cvt_pk_bf16_f32 v170, v196, v197
    v_mfma_f32_16x16x32_bf16 v[80:83], a[180:183], a[240:243], v[80:83]
    v_cvt_pk_bf16_f32 v171, v198, v199
    v_mfma_f32_16x16x32_bf16 v[84:87], a[180:183], a[244:247], v[84:87]
    ds_write_b128 v23, v[168:171] offset:6144
    v_exp_f32 v192, v172
    v_mfma_f32_16x16x32_bf16 v[88:91], a[180:183], a[248:251], v[88:91]
    ds_read_b128 a[232:235], v31 offset:18432
    v_exp_f32 v193, v173
    v_mfma_f32_16x16x32_bf16 v[92:95], a[180:183], a[252:255], v[92:95]
    buffer_load_dwordx4 a[180:183], v31, s[24:27], s29 offen offset:1024
    v_exp_f32 v194, v174
    v_mfma_f32_16x16x32_bf16 v[96:99], a[184:187], a[240:243], v[96:99]
    v_exp_f32 v195, v175
    v_add_f32 v192, 1.0, v192
    v_mfma_f32_16x16x32_bf16 v[100:103], a[184:187], a[244:247], v[100:103]
    ds_read_b128 a[236:239], v31 offset:19456
    v_add_f32 v193, 1.0, v193
    v_add_f32 v194, 1.0, v194
    v_mfma_f32_16x16x32_bf16 v[104:107], a[184:187], a[248:251], v[104:107]
    v_add_f32 v195, 1.0, v195
    v_rcp_f32 v192, v192
    v_mfma_f32_16x16x32_bf16 v[108:111], a[184:187], a[252:255], v[108:111]
    buffer_load_dwordx4 a[184:187], v31, s[24:27], s29 offen offset:2048
    v_rcp_f32 v193, v193
    v_mfma_f32_16x16x32_bf16 v[112:115], a[188:191], a[240:243], v[112:115]
    v_rcp_f32 v194, v194
    v_rcp_f32 v195, v195
    v_mfma_f32_16x16x32_bf16 v[116:119], a[188:191], a[244:247], v[116:119]
    v_mul_f32 v192, v172, v192
    v_mul_f32 v193, v173, v193
    v_mul_f32 v194, v174, v194
    v_mfma_f32_16x16x32_bf16 v[120:123], a[188:191], a[248:251], v[120:123]
    v_mul_f32 v195, v175, v195
    v_cvt_pk_bf16_f32 v172, v192, v193
    v_cvt_pk_bf16_f32 v173, v194, v195
    v_mfma_f32_16x16x32_bf16 v[124:127], a[188:191], a[252:255], v[124:127]
    buffer_load_dwordx4 a[188:191], v31, s[24:27], s29 offen offset:3072
    v_exp_f32 v196, v188
    s_waitcnt vmcnt(20) lgkmcnt(4)
    v_mfma_f32_16x16x32_bf16 v[64:67], a[192:195], a[224:227], v[64:67]
    s_add_u32 s29, s31, 1052672
    ds_read_b128 a[240:243], v31 offset:24576
    v_exp_f32 v197, v189
    s_waitcnt lgkmcnt(4)
    v_mfma_f32_16x16x32_bf16 v[68:71], a[192:195], a[228:231], v[68:71]
    s_waitcnt lgkmcnt(2)
    v_exp_f32 v198, v190
    v_mfma_f32_16x16x32_bf16 v[72:75], a[192:195], a[232:235], v[72:75]
    s_waitcnt lgkmcnt(1)
    v_exp_f32 v199, v191
    v_add_f32 v196, 1.0, v196
    v_add_f32 v197, 1.0, v197
    v_mfma_f32_16x16x32_bf16 v[76:79], a[192:195], a[236:239], v[76:79]
    buffer_load_dwordx4 a[192:195], v31, s[24:27], s29 offen offset:0
    ds_read_b128 a[244:247], v31 offset:25600
    v_add_f32 v198, 1.0, v198
    v_mfma_f32_16x16x32_bf16 v[80:83], a[196:199], a[224:227], v[80:83]
    v_add_f32 v199, 1.0, v199
    v_rcp_f32 v196, v196
    v_mfma_f32_16x16x32_bf16 v[84:87], a[196:199], a[228:231], v[84:87]
    v_rcp_f32 v197, v197
    v_rcp_f32 v198, v198
    v_mfma_f32_16x16x32_bf16 v[88:91], a[196:199], a[232:235], v[88:91]
    ds_read_b128 a[248:251], v31 offset:26624
    v_rcp_f32 v199, v199
    v_mfma_f32_16x16x32_bf16 v[92:95], a[196:199], a[236:239], v[92:95]
    buffer_load_dwordx4 a[196:199], v31, s[24:27], s29 offen offset:1024
    v_mul_f32 v196, v188, v196
    v_mul_f32 v197, v189, v197
    v_mfma_f32_16x16x32_bf16 v[96:99], a[200:203], a[224:227], v[96:99]
    v_mul_f32 v198, v190, v198
    v_mul_f32 v199, v191, v199
    v_cvt_pk_bf16_f32 v174, v196, v197
    v_mfma_f32_16x16x32_bf16 v[100:103], a[200:203], a[228:231], v[100:103]
    ds_read_b128 a[252:255], v31 offset:27648
    v_cvt_pk_bf16_f32 v175, v198, v199
    v_mfma_f32_16x16x32_bf16 v[104:107], a[200:203], a[232:235], v[104:107]
    ds_write_b128 v23, v[172:175] offset:7168
    v_mfma_f32_16x16x32_bf16 v[108:111], a[200:203], a[236:239], v[108:111]
    buffer_load_dwordx4 a[200:203], v31, s[24:27], s29 offen offset:2048
    v_exp_f32 v192, v208
    v_mfma_f32_16x16x32_bf16 v[112:115], a[204:207], a[224:227], v[112:115]
    v_exp_f32 v193, v209
    v_exp_f32 v194, v210
    v_mfma_f32_16x16x32_bf16 v[116:119], a[204:207], a[228:231], v[116:119]
    v_exp_f32 v195, v211
    v_add_f32 v192, 1.0, v192
    v_mfma_f32_16x16x32_bf16 v[120:123], a[204:207], a[232:235], v[120:123]
    v_add_f32 v193, 1.0, v193
    v_add_f32 v194, 1.0, v194
    v_add_f32 v195, 1.0, v195
    v_mfma_f32_16x16x32_bf16 v[124:127], a[204:207], a[236:239], v[124:127]
    buffer_load_dwordx4 a[204:207], v31, s[24:27], s29 offen offset:3072
    v_rcp_f32 v192, v192
    s_waitcnt vmcnt(20) lgkmcnt(4)
    v_mfma_f32_16x16x32_bf16 v[64:67], a[208:211], a[240:243], v[64:67]
    s_add_u32 s29, s31, 1060864
    v_rcp_f32 v193, v193
    s_waitcnt lgkmcnt(3)
    v_mfma_f32_16x16x32_bf16 v[68:71], a[208:211], a[244:247], v[68:71]
    s_waitcnt lgkmcnt(2)
    v_rcp_f32 v194, v194
    v_mfma_f32_16x16x32_bf16 v[72:75], a[208:211], a[248:251], v[72:75]
    s_waitcnt lgkmcnt(1)
    v_rcp_f32 v195, v195
    v_mul_f32 v192, v208, v192
    v_mul_f32 v193, v209, v193
    v_mfma_f32_16x16x32_bf16 v[76:79], a[208:211], a[252:255], v[76:79]
    buffer_load_dwordx4 a[208:211], v31, s[24:27], s29 offen offset:0
    v_mul_f32 v194, v210, v194
    v_mul_f32 v195, v211, v195
    v_mfma_f32_16x16x32_bf16 v[80:83], a[212:215], a[240:243], v[80:83]
    v_cvt_pk_bf16_f32 v208, v192, v193
    v_cvt_pk_bf16_f32 v209, v194, v195
    v_mfma_f32_16x16x32_bf16 v[84:87], a[212:215], a[244:247], v[84:87]
    v_exp_f32 v196, v224
    v_exp_f32 v197, v225
    v_mfma_f32_16x16x32_bf16 v[88:91], a[212:215], a[248:251], v[88:91]
    v_exp_f32 v198, v226
    v_mfma_f32_16x16x32_bf16 v[92:95], a[212:215], a[252:255], v[92:95]
    buffer_load_dwordx4 a[212:215], v31, s[24:27], s29 offen offset:1024
    v_exp_f32 v199, v227
    v_add_f32 v196, 1.0, v196
    v_mfma_f32_16x16x32_bf16 v[96:99], a[216:219], a[240:243], v[96:99]
    v_add_f32 v197, 1.0, v197
    v_add_f32 v198, 1.0, v198
    v_mfma_f32_16x16x32_bf16 v[100:103], a[216:219], a[244:247], v[100:103]
    v_add_f32 v199, 1.0, v199
    v_rcp_f32 v196, v196
    v_mfma_f32_16x16x32_bf16 v[104:107], a[216:219], a[248:251], v[104:107]
    v_rcp_f32 v197, v197
    v_rcp_f32 v198, v198
    v_mfma_f32_16x16x32_bf16 v[108:111], a[216:219], a[252:255], v[108:111]
    buffer_load_dwordx4 a[216:219], v31, s[24:27], s29 offen offset:2048
    v_rcp_f32 v199, v199
    v_mfma_f32_16x16x32_bf16 v[112:115], a[220:223], a[240:243], v[112:115]
    v_mul_f32 v196, v224, v196
    v_mul_f32 v197, v225, v197
    v_mfma_f32_16x16x32_bf16 v[116:119], a[220:223], a[244:247], v[116:119]
    v_mul_f32 v198, v226, v198
    v_mul_f32 v199, v227, v199
    v_cvt_pk_bf16_f32 v210, v196, v197
    v_mfma_f32_16x16x32_bf16 v[120:123], a[220:223], a[248:251], v[120:123]
    v_cvt_pk_bf16_f32 v211, v198, v199
    v_mfma_f32_16x16x32_bf16 v[124:127], a[220:223], a[252:255], v[124:127]
    ds_write_b128 v23, v[208:211] offset:32768
    buffer_load_dwordx4 a[220:223], v31, s[24:27], s29 offen offset:3072
    s_waitcnt vmcnt(20)
    v_mfma_f32_16x16x32_bf16 v[128:131], a[128:131], a[0:3], 0
    s_add_u32 s29, s31, 1069056
    v_exp_f32 v192, v212
    v_mfma_f32_16x16x32_bf16 v[132:135], a[128:131], a[4:7], 0
    v_exp_f32 v193, v213
    v_mfma_f32_16x16x32_bf16 v[136:139], a[128:131], a[8:11], 0
    v_exp_f32 v194, v214
    v_exp_f32 v195, v215
    v_mfma_f32_16x16x32_bf16 v[140:143], a[128:131], a[12:15], 0
    buffer_load_dwordx4 a[128:131], v31, s[24:27], s29 offen offset:0
    v_add_f32 v192, 1.0, v192
    v_add_f32 v193, 1.0, v193
    v_mfma_f32_16x16x32_bf16 v[144:147], a[132:135], a[0:3], 0
    v_add_f32 v194, 1.0, v194
    v_add_f32 v195, 1.0, v195
    v_mfma_f32_16x16x32_bf16 v[148:151], a[132:135], a[4:7], 0
    v_rcp_f32 v192, v192
    v_rcp_f32 v193, v193
    v_mfma_f32_16x16x32_bf16 v[152:155], a[132:135], a[8:11], 0
    v_rcp_f32 v194, v194
    v_mfma_f32_16x16x32_bf16 v[156:159], a[132:135], a[12:15], 0
    buffer_load_dwordx4 a[132:135], v31, s[24:27], s29 offen offset:1024
    v_rcp_f32 v195, v195
    v_mul_f32 v192, v212, v192
    v_mfma_f32_16x16x32_bf16 v[128:131], a[136:139], a[16:19], v[128:131]
    v_mul_f32 v193, v213, v193
    v_mul_f32 v194, v214, v194
    v_mfma_f32_16x16x32_bf16 v[132:135], a[136:139], a[20:23], v[132:135]
    v_mul_f32 v195, v215, v195
    v_cvt_pk_bf16_f32 v212, v192, v193
    v_cvt_pk_bf16_f32 v213, v194, v195
    v_mfma_f32_16x16x32_bf16 v[136:139], a[136:139], a[24:27], v[136:139]
    v_exp_f32 v196, v228
    v_exp_f32 v197, v229
    v_mfma_f32_16x16x32_bf16 v[140:143], a[136:139], a[28:31], v[140:143]
    buffer_load_dwordx4 a[136:139], v31, s[24:27], s29 offen offset:2048
    v_exp_f32 v198, v230
    v_mfma_f32_16x16x32_bf16 v[144:147], a[140:143], a[16:19], v[144:147]
    v_exp_f32 v199, v231
    v_mfma_f32_16x16x32_bf16 v[148:151], a[140:143], a[20:23], v[148:151]
    v_add_f32 v196, 1.0, v196
    v_add_f32 v197, 1.0, v197
    v_add_f32 v198, 1.0, v198
    v_mfma_f32_16x16x32_bf16 v[152:155], a[140:143], a[24:27], v[152:155]
    v_add_f32 v199, 1.0, v199
    v_rcp_f32 v196, v196
    v_mfma_f32_16x16x32_bf16 v[156:159], a[140:143], a[28:31], v[156:159]
    buffer_load_dwordx4 a[140:143], v31, s[24:27], s29 offen offset:3072
    v_rcp_f32 v197, v197
    s_waitcnt vmcnt(20)
    v_mfma_f32_16x16x32_bf16 v[128:131], a[144:147], a[32:35], v[128:131]
    s_add_u32 s29, s31, 1077248
    v_rcp_f32 v198, v198
    v_mfma_f32_16x16x32_bf16 v[132:135], a[144:147], a[36:39], v[132:135]
    v_rcp_f32 v199, v199
    v_mul_f32 v196, v228, v196
    v_mfma_f32_16x16x32_bf16 v[136:139], a[144:147], a[40:43], v[136:139]
    v_mul_f32 v197, v229, v197
    v_mul_f32 v198, v230, v198
    v_mul_f32 v199, v231, v199
    v_mfma_f32_16x16x32_bf16 v[140:143], a[144:147], a[44:47], v[140:143]
    buffer_load_dwordx4 a[144:147], v31, s[24:27], s29 offen offset:0
    v_cvt_pk_bf16_f32 v214, v196, v197
    v_cvt_pk_bf16_f32 v215, v198, v199
    v_mfma_f32_16x16x32_bf16 v[144:147], a[148:151], a[32:35], v[144:147]
    ds_write_b128 v23, v[212:215] offset:33792
    v_mfma_f32_16x16x32_bf16 v[148:151], a[148:151], a[36:39], v[148:151]
    v_exp_f32 v192, v216
    v_mfma_f32_16x16x32_bf16 v[152:155], a[148:151], a[40:43], v[152:155]
    v_exp_f32 v193, v217
    v_mfma_f32_16x16x32_bf16 v[156:159], a[148:151], a[44:47], v[156:159]
    buffer_load_dwordx4 a[148:151], v31, s[24:27], s29 offen offset:1024
    v_exp_f32 v194, v218
    v_mfma_f32_16x16x32_bf16 v[128:131], a[152:155], a[48:51], v[128:131]
    v_exp_f32 v195, v219
    v_add_f32 v192, 1.0, v192
    v_mfma_f32_16x16x32_bf16 v[132:135], a[152:155], a[52:55], v[132:135]
    v_add_f32 v193, 1.0, v193
    v_add_f32 v194, 1.0, v194
    v_add_f32 v195, 1.0, v195
    v_mfma_f32_16x16x32_bf16 v[136:139], a[152:155], a[56:59], v[136:139]
    v_rcp_f32 v192, v192
    v_rcp_f32 v193, v193
    v_mfma_f32_16x16x32_bf16 v[140:143], a[152:155], a[60:63], v[140:143]
    buffer_load_dwordx4 a[152:155], v31, s[24:27], s29 offen offset:2048
    v_rcp_f32 v194, v194
    v_mfma_f32_16x16x32_bf16 v[144:147], a[156:159], a[48:51], v[144:147]
    v_rcp_f32 v195, v195
    v_mfma_f32_16x16x32_bf16 v[148:151], a[156:159], a[52:55], v[148:151]
    v_mul_f32 v192, v216, v192
    v_mul_f32 v193, v217, v193
    v_mul_f32 v194, v218, v194
    v_mfma_f32_16x16x32_bf16 v[152:155], a[156:159], a[56:59], v[152:155]
    v_mul_f32 v195, v219, v195
    v_cvt_pk_bf16_f32 v216, v192, v193
    v_cvt_pk_bf16_f32 v217, v194, v195
    v_mfma_f32_16x16x32_bf16 v[156:159], a[156:159], a[60:63], v[156:159]
    buffer_load_dwordx4 a[156:159], v31, s[24:27], s29 offen offset:3072
    v_exp_f32 v196, v232
    s_waitcnt vmcnt(20)
    v_mfma_f32_16x16x32_bf16 v[128:131], a[160:163], a[64:67], v[128:131]
    s_add_u32 s29, s31, 1179648
    v_exp_f32 v197, v233
    v_mfma_f32_16x16x32_bf16 v[132:135], a[160:163], a[68:71], v[132:135]
    v_exp_f32 v198, v234
    v_mfma_f32_16x16x32_bf16 v[136:139], a[160:163], a[72:75], v[136:139]
    v_exp_f32 v199, v235
    v_add_f32 v196, 1.0, v196
    v_add_f32 v197, 1.0, v197
    v_mfma_f32_16x16x32_bf16 v[140:143], a[160:163], a[76:79], v[140:143]
    buffer_load_dwordx4 a[160:163], v31, s[24:27], s29 offen offset:0
    v_add_f32 v198, 1.0, v198
    v_add_f32 v199, 1.0, v199
    v_mfma_f32_16x16x32_bf16 v[144:147], a[164:167], a[64:67], v[144:147]
    v_rcp_f32 v196, v196
    v_mfma_f32_16x16x32_bf16 v[148:151], a[164:167], a[68:71], v[148:151]
    v_rcp_f32 v197, v197
    v_rcp_f32 v198, v198
    v_mfma_f32_16x16x32_bf16 v[152:155], a[164:167], a[72:75], v[152:155]
    v_rcp_f32 v199, v199
    v_mul_f32 v196, v232, v196
    v_mfma_f32_16x16x32_bf16 v[156:159], a[164:167], a[76:79], v[156:159]
    buffer_load_dwordx4 a[164:167], v31, s[24:27], s29 offen offset:1024
    v_mul_f32 v197, v233, v197
    v_mul_f32 v198, v234, v198
    v_mfma_f32_16x16x32_bf16 v[128:131], a[168:171], a[80:83], v[128:131]
    v_mul_f32 v199, v235, v199
    v_cvt_pk_bf16_f32 v218, v196, v197
    v_mfma_f32_16x16x32_bf16 v[132:135], a[168:171], a[84:87], v[132:135]
    v_cvt_pk_bf16_f32 v219, v198, v199
    v_mfma_f32_16x16x32_bf16 v[136:139], a[168:171], a[88:91], v[136:139]
    ds_write_b128 v23, v[216:219] offset:34816
    v_exp_f32 v192, v220
    v_mfma_f32_16x16x32_bf16 v[140:143], a[168:171], a[92:95], v[140:143]
    buffer_load_dwordx4 a[168:171], v31, s[24:27], s29 offen offset:2048
    v_exp_f32 v193, v221
    v_mfma_f32_16x16x32_bf16 v[144:147], a[172:175], a[80:83], v[144:147]
    v_exp_f32 v194, v222
    v_mfma_f32_16x16x32_bf16 v[148:151], a[172:175], a[84:87], v[148:151]
    v_exp_f32 v195, v223
    v_add_f32 v192, 1.0, v192
    v_mfma_f32_16x16x32_bf16 v[152:155], a[172:175], a[88:91], v[152:155]
    v_add_f32 v193, 1.0, v193
    v_add_f32 v194, 1.0, v194
    v_add_f32 v195, 1.0, v195
    v_mfma_f32_16x16x32_bf16 v[156:159], a[172:175], a[92:95], v[156:159]
    buffer_load_dwordx4 a[172:175], v31, s[24:27], s29 offen offset:3072
    v_rcp_f32 v192, v192
    s_waitcnt lgkmcnt(3)
    s_barrier
    s_waitcnt vmcnt(20)
    v_mfma_f32_16x16x32_bf16 v[128:131], a[176:179], a[96:99], v[128:131]
    s_add_u32 s29, s31, 1187840
    ds_read_b128 a[224:227], v31 offset:4096
    v_rcp_f32 v193, v193
    v_mfma_f32_16x16x32_bf16 v[132:135], a[176:179], a[100:103], v[132:135]
    v_rcp_f32 v194, v194
    v_mfma_f32_16x16x32_bf16 v[136:139], a[176:179], a[104:107], v[136:139]
    v_rcp_f32 v195, v195
    v_mul_f32 v192, v220, v192
    v_mul_f32 v193, v221, v193
    v_mfma_f32_16x16x32_bf16 v[140:143], a[176:179], a[108:111], v[140:143]
    buffer_load_dwordx4 a[176:179], v31, s[24:27], s29 offen offset:0
    ds_read_b128 a[228:231], v31 offset:5120
    v_mul_f32 v194, v222, v194
    v_mfma_f32_16x16x32_bf16 v[144:147], a[180:183], a[96:99], v[144:147]
    v_mul_f32 v195, v223, v195
    v_cvt_pk_bf16_f32 v220, v192, v193
    v_cvt_pk_bf16_f32 v221, v194, v195
    v_mfma_f32_16x16x32_bf16 v[148:151], a[180:183], a[100:103], v[148:151]
    v_exp_f32 v196, v236
    v_exp_f32 v197, v237
    v_mfma_f32_16x16x32_bf16 v[152:155], a[180:183], a[104:107], v[152:155]
    ds_read_b128 a[232:235], v31 offset:6144
    v_exp_f32 v198, v238
    v_mfma_f32_16x16x32_bf16 v[156:159], a[180:183], a[108:111], v[156:159]
    buffer_load_dwordx4 a[180:183], v31, s[24:27], s29 offen offset:1024
    v_exp_f32 v199, v239
    v_mfma_f32_16x16x32_bf16 v[128:131], a[184:187], a[112:115], v[128:131]
    v_add_f32 v196, 1.0, v196
    v_add_f32 v197, 1.0, v197
    v_add_f32 v198, 1.0, v198
    v_mfma_f32_16x16x32_bf16 v[132:135], a[184:187], a[116:119], v[132:135]
    ds_read_b128 a[236:239], v31 offset:7168
    v_add_f32 v199, 1.0, v199
    v_mfma_f32_16x16x32_bf16 v[136:139], a[184:187], a[120:123], v[136:139]
    v_rcp_f32 v196, v196
    v_rcp_f32 v197, v197
    v_mfma_f32_16x16x32_bf16 v[140:143], a[184:187], a[124:127], v[140:143]
    buffer_load_dwordx4 a[184:187], v31, s[24:27], s29 offen offset:2048
    v_rcp_f32 v198, v198
    v_mfma_f32_16x16x32_bf16 v[144:147], a[188:191], a[112:115], v[144:147]
    v_rcp_f32 v199, v199
    v_mul_f32 v196, v236, v196
    v_mfma_f32_16x16x32_bf16 v[148:151], a[188:191], a[116:119], v[148:151]
    v_mul_f32 v197, v237, v197
    v_mul_f32 v198, v238, v198
    v_mul_f32 v199, v239, v199
    v_cvt_pk_bf16_f32 v222, v196, v197
    v_mfma_f32_16x16x32_bf16 v[152:155], a[188:191], a[120:123], v[152:155]
    v_cvt_pk_bf16_f32 v223, v198, v199
    v_mfma_f32_16x16x32_bf16 v[156:159], a[188:191], a[124:127], v[156:159]
    ds_write_b128 v23, v[220:223] offset:35840
    buffer_load_dwordx4 a[188:191], v31, s[24:27], s29 offen offset:3072
    s_waitcnt vmcnt(20) lgkmcnt(4)
    v_mfma_f32_16x16x32_bf16 v[64:67], a[192:195], a[224:227], v[64:67]
    s_add_u32 s29, s31, 1196032
    ds_read_b128 a[240:243], v31 offset:12288
    s_waitcnt lgkmcnt(4)
    v_mfma_f32_16x16x32_bf16 v[68:71], a[192:195], a[228:231], v[68:71]
    s_waitcnt lgkmcnt(3)
    v_exp_f32 v192, v128
    v_exp_f32 v193, v129
    v_mfma_f32_16x16x32_bf16 v[72:75], a[192:195], a[232:235], v[72:75]
    s_waitcnt lgkmcnt(2)
    v_exp_f32 v194, v130
    v_mfma_f32_16x16x32_bf16 v[76:79], a[192:195], a[236:239], v[76:79]
    buffer_load_dwordx4 a[192:195], v31, s[24:27], s29 offen offset:0
    ds_read_b128 a[244:247], v31 offset:13312
    v_mfma_f32_16x16x32_bf16 v[80:83], a[196:199], a[224:227], v[80:83]
    v_exp_f32 v195, v131
    v_add_f32 v192, 1.0, v192
    v_mfma_f32_16x16x32_bf16 v[84:87], a[196:199], a[228:231], v[84:87]
    v_add_f32 v193, 1.0, v193
    v_add_f32 v194, 1.0, v194
    v_mfma_f32_16x16x32_bf16 v[88:91], a[196:199], a[232:235], v[88:91]
    ds_read_b128 a[248:251], v31 offset:14336
    v_add_f32 v195, 1.0, v195
    v_mfma_f32_16x16x32_bf16 v[92:95], a[196:199], a[236:239], v[92:95]
    buffer_load_dwordx4 a[196:199], v31, s[24:27], s29 offen offset:1024
    v_rcp_f32 v192, v192
    v_mfma_f32_16x16x32_bf16 v[96:99], a[200:203], a[224:227], v[96:99]
    v_rcp_f32 v193, v193
    v_rcp_f32 v194, v194
    v_mfma_f32_16x16x32_bf16 v[100:103], a[200:203], a[228:231], v[100:103]
    ds_read_b128 a[252:255], v31 offset:15360
    v_mfma_f32_16x16x32_bf16 v[104:107], a[200:203], a[232:235], v[104:107]
    v_rcp_f32 v195, v195
    v_mul_f32 v192, v128, v192
    v_mfma_f32_16x16x32_bf16 v[108:111], a[200:203], a[236:239], v[108:111]
    buffer_load_dwordx4 a[200:203], v31, s[24:27], s29 offen offset:2048
    v_mul_f32 v193, v129, v193
    v_mul_f32 v194, v130, v194
    v_mfma_f32_16x16x32_bf16 v[112:115], a[204:207], a[224:227], v[112:115]
    v_mul_f32 v195, v131, v195
    v_cvt_pk_bf16_f32 v128, v192, v193
    v_mfma_f32_16x16x32_bf16 v[116:119], a[204:207], a[228:231], v[116:119]
    v_cvt_pk_bf16_f32 v129, v194, v195
    v_exp_f32 v196, v144
    v_mfma_f32_16x16x32_bf16 v[120:123], a[204:207], a[232:235], v[120:123]
    v_exp_f32 v197, v145
    v_mfma_f32_16x16x32_bf16 v[124:127], a[204:207], a[236:239], v[124:127]
    buffer_load_dwordx4 a[204:207], v31, s[24:27], s29 offen offset:3072
    v_exp_f32 v198, v146
    s_waitcnt vmcnt(20) lgkmcnt(3)
    v_mfma_f32_16x16x32_bf16 v[64:67], a[208:211], a[240:243], v[64:67]
    s_add_u32 s29, s31, 1204224
    ds_read_b128 a[224:227], v31 offset:20480
    s_waitcnt lgkmcnt(3)
    v_mfma_f32_16x16x32_bf16 v[68:71], a[208:211], a[244:247], v[68:71]
    s_waitcnt lgkmcnt(2)
    v_exp_f32 v199, v147
    v_add_f32 v196, 1.0, v196
    v_mfma_f32_16x16x32_bf16 v[72:75], a[208:211], a[248:251], v[72:75]
    s_waitcnt lgkmcnt(1)
    v_add_f32 v197, 1.0, v197
    v_add_f32 v198, 1.0, v198
    v_add_f32 v199, 1.0, v199
    v_mfma_f32_16x16x32_bf16 v[76:79], a[208:211], a[252:255], v[76:79]
    buffer_load_dwordx4 a[208:211], v31, s[24:27], s29 offen offset:0
    ds_read_b128 a[228:231], v31 offset:21504
    v_mfma_f32_16x16x32_bf16 v[80:83], a[212:215], a[240:243], v[80:83]
    v_rcp_f32 v196, v196
    v_mfma_f32_16x16x32_bf16 v[84:87], a[212:215], a[244:247], v[84:87]
    v_rcp_f32 v197, v197
    v_rcp_f32 v198, v198
    v_mfma_f32_16x16x32_bf16 v[88:91], a[212:215], a[248:251], v[88:91]
    ds_read_b128 a[232:235], v31 offset:22528
    v_mfma_f32_16x16x32_bf16 v[92:95], a[212:215], a[252:255], v[92:95]
    buffer_load_dwordx4 a[212:215], v31, s[24:27], s29 offen offset:1024
    v_rcp_f32 v199, v199
    v_mul_f32 v196, v144, v196
    v_mfma_f32_16x16x32_bf16 v[96:99], a[216:219], a[240:243], v[96:99]
    v_mul_f32 v197, v145, v197
    v_mul_f32 v198, v146, v198
    v_mfma_f32_16x16x32_bf16 v[100:103], a[216:219], a[244:247], v[100:103]
    ds_read_b128 a[236:239], v31 offset:23552
    v_mul_f32 v199, v147, v199
    v_cvt_pk_bf16_f32 v130, v196, v197
    v_mfma_f32_16x16x32_bf16 v[104:107], a[216:219], a[248:251], v[104:107]
    v_cvt_pk_bf16_f32 v131, v198, v199
    v_mfma_f32_16x16x32_bf16 v[108:111], a[216:219], a[252:255], v[108:111]
    ds_write_b128 v23, v[128:131] offset:36864
    buffer_load_dwordx4 a[216:219], v31, s[24:27], s29 offen offset:2048
    v_mfma_f32_16x16x32_bf16 v[112:115], a[220:223], a[240:243], v[112:115]
    v_exp_f32 v192, v132
    v_mfma_f32_16x16x32_bf16 v[116:119], a[220:223], a[244:247], v[116:119]
    v_exp_f32 v193, v133
    v_mfma_f32_16x16x32_bf16 v[120:123], a[220:223], a[248:251], v[120:123]
    v_exp_f32 v194, v134
    v_mfma_f32_16x16x32_bf16 v[124:127], a[220:223], a[252:255], v[124:127]
    buffer_load_dwordx4 a[220:223], v31, s[24:27], s29 offen offset:3072
    v_exp_f32 v195, v135
    s_waitcnt vmcnt(20) lgkmcnt(4)
    v_mfma_f32_16x16x32_bf16 v[64:67], a[128:131], a[224:227], v[64:67]
    s_add_u32 s29, s31, 1183744
    ds_read_b128 a[240:243], v31 offset:28672
    v_add_f32 v192, 1.0, v192
    s_waitcnt lgkmcnt(4)
    v_mfma_f32_16x16x32_bf16 v[68:71], a[128:131], a[228:231], v[68:71]
    s_waitcnt lgkmcnt(3)
    v_add_f32 v193, 1.0, v193
    v_add_f32 v194, 1.0, v194
    v_mfma_f32_16x16x32_bf16 v[72:75], a[128:131], a[232:235], v[72:75]
    s_waitcnt lgkmcnt(2)
    v_add_f32 v195, 1.0, v195
    v_rcp_f32 v192, v192
    v_mfma_f32_16x16x32_bf16 v[76:79], a[128:131], a[236:239], v[76:79]
    buffer_load_dwordx4 a[128:131], v31, s[24:27], s29 offen offset:0
    ds_read_b128 a[244:247], v31 offset:29696
    v_mfma_f32_16x16x32_bf16 v[80:83], a[132:135], a[224:227], v[80:83]
    v_rcp_f32 v193, v193
    v_mfma_f32_16x16x32_bf16 v[84:87], a[132:135], a[228:231], v[84:87]
    v_rcp_f32 v194, v194
    v_rcp_f32 v195, v195
    v_mfma_f32_16x16x32_bf16 v[88:91], a[132:135], a[232:235], v[88:91]
    ds_read_b128 a[248:251], v31 offset:30720
    v_mul_f32 v192, v132, v192
    v_mfma_f32_16x16x32_bf16 v[92:95], a[132:135], a[236:239], v[92:95]
    buffer_load_dwordx4 a[132:135], v31, s[24:27], s29 offen offset:1024
    v_mul_f32 v193, v133, v193
    v_mul_f32 v194, v134, v194
    v_mfma_f32_16x16x32_bf16 v[96:99], a[136:139], a[224:227], v[96:99]
    v_mul_f32 v195, v135, v195
    v_cvt_pk_bf16_f32 v132, v192, v193
    v_mfma_f32_16x16x32_bf16 v[100:103], a[136:139], a[228:231], v[100:103]
    ds_read_b128 a[252:255], v31 offset:31744
    v_cvt_pk_bf16_f32 v133, v194, v195
    v_mfma_f32_16x16x32_bf16 v[104:107], a[136:139], a[232:235], v[104:107]
    v_exp_f32 v196, v148
    v_exp_f32 v197, v149
    v_mfma_f32_16x16x32_bf16 v[108:111], a[136:139], a[236:239], v[108:111]
    buffer_load_dwordx4 a[136:139], v31, s[24:27], s29 offen offset:2048
    v_mfma_f32_16x16x32_bf16 v[112:115], a[140:143], a[224:227], v[112:115]
    v_exp_f32 v198, v150
    v_exp_f32 v199, v151
    v_mfma_f32_16x16x32_bf16 v[116:119], a[140:143], a[228:231], v[116:119]
    v_add_f32 v196, 1.0, v196
    v_add_f32 v197, 1.0, v197
    v_mfma_f32_16x16x32_bf16 v[120:123], a[140:143], a[232:235], v[120:123]
    v_add_f32 v198, 1.0, v198
    v_add_f32 v199, 1.0, v199
    v_mfma_f32_16x16x32_bf16 v[124:127], a[140:143], a[236:239], v[124:127]
    buffer_load_dwordx4 a[140:143], v31, s[24:27], s29 offen offset:3072
    v_rcp_f32 v196, v196
    s_barrier
    s_waitcnt vmcnt(20) lgkmcnt(3)
    v_mfma_f32_16x16x32_bf16 v[64:67], a[144:147], a[240:243], v[64:67]
    s_add_u32 s29, s31, 1191936
    ds_read_b128 a[224:227], v31 offset:32768
    s_waitcnt lgkmcnt(3)
    v_mfma_f32_16x16x32_bf16 v[68:71], a[144:147], a[244:247], v[68:71]
    s_waitcnt lgkmcnt(2)
    v_rcp_f32 v197, v197
    v_rcp_f32 v198, v198
    v_mfma_f32_16x16x32_bf16 v[72:75], a[144:147], a[248:251], v[72:75]
    s_waitcnt lgkmcnt(1)
    v_rcp_f32 v199, v199
    v_mfma_f32_16x16x32_bf16 v[76:79], a[144:147], a[252:255], v[76:79]
    buffer_load_dwordx4 a[144:147], v31, s[24:27], s29 offen offset:0
    ds_read_b128 a[228:231], v31 offset:33792
    v_mfma_f32_16x16x32_bf16 v[80:83], a[148:151], a[240:243], v[80:83]
    v_mul_f32 v196, v148, v196
    v_mul_f32 v197, v149, v197
    v_mul_f32 v198, v150, v198
    v_mfma_f32_16x16x32_bf16 v[84:87], a[148:151], a[244:247], v[84:87]
    v_mul_f32 v199, v151, v199
    v_cvt_pk_bf16_f32 v134, v196, v197
    v_mfma_f32_16x16x32_bf16 v[88:91], a[148:151], a[248:251], v[88:91]
    ds_read_b128 a[232:235], v31 offset:34816
    v_cvt_pk_bf16_f32 v135, v198, v199
    v_mfma_f32_16x16x32_bf16 v[92:95], a[148:151], a[252:255], v[92:95]
    ds_write_b128 v23, v[132:135] offset:37888
    buffer_load_dwordx4 a[148:151], v31, s[24:27], s29 offen offset:1024
    v_mfma_f32_16x16x32_bf16 v[96:99], a[152:155], a[240:243], v[96:99]
    v_exp_f32 v192, v136
    v_mfma_f32_16x16x32_bf16 v[100:103], a[152:155], a[244:247], v[100:103]
    ds_read_b128 a[236:239], v31 offset:35840
    v_mfma_f32_16x16x32_bf16 v[104:107], a[152:155], a[248:251], v[104:107]
    v_exp_f32 v193, v137
    v_exp_f32 v194, v138
    v_mfma_f32_16x16x32_bf16 v[108:111], a[152:155], a[252:255], v[108:111]
    buffer_load_dwordx4 a[152:155], v31, s[24:27], s29 offen offset:2048
    v_mfma_f32_16x16x32_bf16 v[112:115], a[156:159], a[240:243], v[112:115]
    v_exp_f32 v195, v139
    v_add_f32 v192, 1.0, v192
    v_mfma_f32_16x16x32_bf16 v[116:119], a[156:159], a[244:247], v[116:119]
    v_add_f32 v193, 1.0, v193
    v_add_f32 v194, 1.0, v194
    v_add_f32 v195, 1.0, v195
    v_mfma_f32_16x16x32_bf16 v[120:123], a[156:159], a[248:251], v[120:123]
    v_rcp_f32 v192, v192
    v_mfma_f32_16x16x32_bf16 v[124:127], a[156:159], a[252:255], v[124:127]
    buffer_load_dwordx4 a[156:159], v31, s[24:27], s29 offen offset:3072
    v_rcp_f32 v193, v193
    s_waitcnt vmcnt(20) lgkmcnt(4)
    v_mfma_f32_16x16x32_bf16 v[64:67], a[160:163], a[224:227], v[64:67]
    s_add_u32 s29, s31, 1200128
    ds_read_b128 a[240:243], v31 offset:40960
    s_waitcnt lgkmcnt(4)
    v_mfma_f32_16x16x32_bf16 v[68:71], a[160:163], a[228:231], v[68:71]
    s_waitcnt lgkmcnt(3)
    v_rcp_f32 v194, v194
    v_rcp_f32 v195, v195
    v_mfma_f32_16x16x32_bf16 v[72:75], a[160:163], a[232:235], v[72:75]
    s_waitcnt lgkmcnt(1)
    v_mul_f32 v192, v136, v192
    v_mul_f32 v193, v137, v193
    v_mfma_f32_16x16x32_bf16 v[76:79], a[160:163], a[236:239], v[76:79]
    buffer_load_dwordx4 a[160:163], v31, s[24:27], s29 offen offset:0
    ds_read_b128 a[244:247], v31 offset:41984
    v_mfma_f32_16x16x32_bf16 v[80:83], a[164:167], a[224:227], v[80:83]
    v_mul_f32 v194, v138, v194
    v_mul_f32 v195, v139, v195
    v_cvt_pk_bf16_f32 v136, v192, v193
    v_mfma_f32_16x16x32_bf16 v[84:87], a[164:167], a[228:231], v[84:87]
    v_cvt_pk_bf16_f32 v137, v194, v195
    v_exp_f32 v196, v152
    v_mfma_f32_16x16x32_bf16 v[88:91], a[164:167], a[232:235], v[88:91]
    ds_read_b128 a[248:251], v31 offset:43008
    v_mfma_f32_16x16x32_bf16 v[92:95], a[164:167], a[236:239], v[92:95]
    buffer_load_dwordx4 a[164:167], v31, s[24:27], s29 offen offset:1024
    v_exp_f32 v197, v153
    v_mfma_f32_16x16x32_bf16 v[96:99], a[168:171], a[224:227], v[96:99]
    v_exp_f32 v198, v154
    v_exp_f32 v199, v155
    v_mfma_f32_16x16x32_bf16 v[100:103], a[168:171], a[228:231], v[100:103]
    ds_read_b128 a[252:255], v31 offset:44032
    v_add_f32 v196, 1.0, v196
    v_mfma_f32_16x16x32_bf16 v[104:107], a[168:171], a[232:235], v[104:107]
    v_add_f32 v197, 1.0, v197
    v_add_f32 v198, 1.0, v198
    v_mfma_f32_16x16x32_bf16 v[108:111], a[168:171], a[236:239], v[108:111]
    buffer_load_dwordx4 a[168:171], v31, s[24:27], s29 offen offset:2048
    v_add_f32 v199, 1.0, v199
    v_mfma_f32_16x16x32_bf16 v[112:115], a[172:175], a[224:227], v[112:115]
    v_rcp_f32 v196, v196
    v_rcp_f32 v197, v197
    v_mfma_f32_16x16x32_bf16 v[116:119], a[172:175], a[228:231], v[116:119]
    v_rcp_f32 v198, v198
    v_mfma_f32_16x16x32_bf16 v[120:123], a[172:175], a[232:235], v[120:123]
    v_rcp_f32 v199, v199
    v_mfma_f32_16x16x32_bf16 v[124:127], a[172:175], a[236:239], v[124:127]
    buffer_load_dwordx4 a[172:175], v31, s[24:27], s29 offen offset:3072
    v_mul_f32 v196, v152, v196
    v_mul_f32 v197, v153, v197
    s_waitcnt vmcnt(20) lgkmcnt(3)
    v_mfma_f32_16x16x32_bf16 v[64:67], a[176:179], a[240:243], v[64:67]
    s_add_u32 s29, s31, 1208320
    ds_read_b128 a[224:227], v31 offset:49152
    buffer_load_dword v22, v21, s[24:27], s80 offen sc1
    s_waitcnt lgkmcnt(3)
    v_mfma_f32_16x16x32_bf16 v[68:71], a[176:179], a[244:247], v[68:71]
    s_waitcnt lgkmcnt(2)
    v_mul_f32 v198, v154, v198
    v_mul_f32 v199, v155, v199
    v_mfma_f32_16x16x32_bf16 v[72:75], a[176:179], a[248:251], v[72:75]
    s_waitcnt lgkmcnt(1)
    v_cvt_pk_bf16_f32 v138, v196, v197
    v_cvt_pk_bf16_f32 v139, v198, v199
    v_mfma_f32_16x16x32_bf16 v[76:79], a[176:179], a[252:255], v[76:79]
    ds_write_b128 v23, v[136:139] offset:38912
    buffer_load_dwordx4 a[176:179], v31, s[24:27], s29 offen offset:0
    ds_read_b128 a[228:231], v31 offset:50176
    v_mfma_f32_16x16x32_bf16 v[80:83], a[180:183], a[240:243], v[80:83]
    v_mfma_f32_16x16x32_bf16 v[84:87], a[180:183], a[244:247], v[84:87]
    v_exp_f32 v192, v140
    v_mfma_f32_16x16x32_bf16 v[88:91], a[180:183], a[248:251], v[88:91]
    ds_read_b128 a[232:235], v31 offset:51200
    v_exp_f32 v193, v141
    v_mfma_f32_16x16x32_bf16 v[92:95], a[180:183], a[252:255], v[92:95]
    buffer_load_dwordx4 a[180:183], v31, s[24:27], s29 offen offset:1024
    v_exp_f32 v194, v142
    v_mfma_f32_16x16x32_bf16 v[96:99], a[184:187], a[240:243], v[96:99]
    v_exp_f32 v195, v143
    v_add_f32 v192, 1.0, v192
    v_mfma_f32_16x16x32_bf16 v[100:103], a[184:187], a[244:247], v[100:103]
    ds_read_b128 a[236:239], v31 offset:52224
    v_add_f32 v193, 1.0, v193
    v_mfma_f32_16x16x32_bf16 v[104:107], a[184:187], a[248:251], v[104:107]
    v_add_f32 v194, 1.0, v194
    v_add_f32 v195, 1.0, v195
    v_mfma_f32_16x16x32_bf16 v[108:111], a[184:187], a[252:255], v[108:111]
    buffer_load_dwordx4 a[184:187], v31, s[24:27], s29 offen offset:2048
    v_rcp_f32 v192, v192
    v_mfma_f32_16x16x32_bf16 v[112:115], a[188:191], a[240:243], v[112:115]
    v_rcp_f32 v193, v193
    v_rcp_f32 v194, v194
    v_mfma_f32_16x16x32_bf16 v[116:119], a[188:191], a[244:247], v[116:119]
    v_rcp_f32 v195, v195
    v_mfma_f32_16x16x32_bf16 v[120:123], a[188:191], a[248:251], v[120:123]
    v_mul_f32 v192, v140, v192
    v_mul_f32 v193, v141, v193
    v_mfma_f32_16x16x32_bf16 v[124:127], a[188:191], a[252:255], v[124:127]
    buffer_load_dwordx4 a[188:191], v31, s[24:27], s29 offen offset:3072
    v_mul_f32 v194, v142, v194
    v_mul_f32 v195, v143, v195
    s_waitcnt vmcnt(21) lgkmcnt(4)
    v_mfma_f32_16x16x32_bf16 v[64:67], a[192:195], a[224:227], v[64:67]
    ds_read_b128 a[240:243], v31 offset:57344
    v_cvt_pk_bf16_f32 v140, v192, v193
    s_waitcnt lgkmcnt(3)
    v_mfma_f32_16x16x32_bf16 v[68:71], a[192:195], a[228:231], v[68:71]
    s_waitcnt lgkmcnt(2)
    v_cvt_pk_bf16_f32 v141, v194, v195
    v_exp_f32 v196, v156
    v_mfma_f32_16x16x32_bf16 v[72:75], a[192:195], a[232:235], v[72:75]
    s_waitcnt lgkmcnt(1)
    v_exp_f32 v197, v157
    v_mfma_f32_16x16x32_bf16 v[76:79], a[192:195], a[236:239], v[76:79]
    ds_read_b128 a[244:247], v31 offset:58368
    v_exp_f32 v198, v158
    v_mfma_f32_16x16x32_bf16 v[80:83], a[196:199], a[224:227], v[80:83]
    v_exp_f32 v199, v159
    v_mfma_f32_16x16x32_bf16 v[84:87], a[196:199], a[228:231], v[84:87]
    v_add_f32 v196, 1.0, v196
    v_add_f32 v197, 1.0, v197
    v_mfma_f32_16x16x32_bf16 v[88:91], a[196:199], a[232:235], v[88:91]
    ds_read_b128 a[248:251], v31 offset:59392
    v_add_f32 v198, 1.0, v198
    v_mfma_f32_16x16x32_bf16 v[92:95], a[196:199], a[236:239], v[92:95]
    v_add_f32 v199, 1.0, v199
    v_rcp_f32 v196, v196
    v_mfma_f32_16x16x32_bf16 v[96:99], a[200:203], a[224:227], v[96:99]
    v_rcp_f32 v197, v197
    v_mfma_f32_16x16x32_bf16 v[100:103], a[200:203], a[228:231], v[100:103]
    ds_read_b128 a[252:255], v31 offset:60416
    v_mfma_f32_16x16x32_bf16 v[104:107], a[200:203], a[232:235], v[104:107]
    v_rcp_f32 v198, v198
    v_mfma_f32_16x16x32_bf16 v[108:111], a[200:203], a[236:239], v[108:111]
    v_rcp_f32 v199, v199
    v_mul_f32 v196, v156, v196
    v_mfma_f32_16x16x32_bf16 v[112:115], a[204:207], a[224:227], v[112:115]
    v_mul_f32 v197, v157, v197
    v_mul_f32 v198, v158, v198
    v_mfma_f32_16x16x32_bf16 v[116:119], a[204:207], a[228:231], v[116:119]
    v_mul_f32 v199, v159, v199
    v_cvt_pk_bf16_f32 v142, v196, v197
    v_cvt_pk_bf16_f32 v143, v198, v199
    v_mfma_f32_16x16x32_bf16 v[120:123], a[204:207], a[232:235], v[120:123]
    ds_write_b128 v23, v[140:143] offset:39936
    v_mfma_f32_16x16x32_bf16 v[124:127], a[204:207], a[236:239], v[124:127]
    s_waitcnt lgkmcnt(0)
    s_barrier
    s_waitcnt vmcnt(17)
    v_mfma_f32_16x16x32_bf16 v[64:67], a[208:211], a[240:243], v[64:67]
    ds_read_b128 a[232:235], v31 offset:38912
    v_mfma_f32_16x16x32_bf16 v[68:71], a[208:211], a[244:247], v[68:71]
    v_mfma_f32_16x16x32_bf16 v[72:75], a[208:211], a[248:251], v[72:75]
    v_mfma_f32_16x16x32_bf16 v[76:79], a[208:211], a[252:255], v[76:79]
    v_mfma_f32_16x16x32_bf16 v[80:83], a[212:215], a[240:243], v[80:83]
    v_mfma_f32_16x16x32_bf16 v[84:87], a[212:215], a[244:247], v[84:87]
    v_mfma_f32_16x16x32_bf16 v[88:91], a[212:215], a[248:251], v[88:91]
    ds_read_b128 a[236:239], v31 offset:39936
    v_mfma_f32_16x16x32_bf16 v[92:95], a[212:215], a[252:255], v[92:95]
    v_mfma_f32_16x16x32_bf16 v[96:99], a[216:219], a[240:243], v[96:99]
    v_mfma_f32_16x16x32_bf16 v[100:103], a[216:219], a[244:247], v[100:103]
    v_mfma_f32_16x16x32_bf16 v[104:107], a[216:219], a[248:251], v[104:107]
    v_mfma_f32_16x16x32_bf16 v[108:111], a[216:219], a[252:255], v[108:111]
    v_mfma_f32_16x16x32_bf16 v[112:115], a[220:223], a[240:243], v[112:115]
    v_mfma_f32_16x16x32_bf16 v[116:119], a[220:223], a[244:247], v[116:119]
    v_mfma_f32_16x16x32_bf16 v[120:123], a[220:223], a[248:251], v[120:123]
    v_mfma_f32_16x16x32_bf16 v[124:127], a[220:223], a[252:255], v[124:127]
    s_waitcnt vmcnt(13) lgkmcnt(1)
    v_mfma_f32_16x16x32_bf16 v[72:75], a[128:131], a[232:235], v[72:75]
    ds_read_b128 a[248:251], v31 offset:47104
    s_waitcnt lgkmcnt(1)
    v_mfma_f32_16x16x32_bf16 v[76:79], a[128:131], a[236:239], v[76:79]
    v_mfma_f32_16x16x32_bf16 v[88:91], a[132:135], a[232:235], v[88:91]
    v_mfma_f32_16x16x32_bf16 v[92:95], a[132:135], a[236:239], v[92:95]
    ds_read_b128 a[252:255], v31 offset:48128
    v_mfma_f32_16x16x32_bf16 v[104:107], a[136:139], a[232:235], v[104:107]
    v_mfma_f32_16x16x32_bf16 v[108:111], a[136:139], a[236:239], v[108:111]
    v_mfma_f32_16x16x32_bf16 v[120:123], a[140:143], a[232:235], v[120:123]
    v_mfma_f32_16x16x32_bf16 v[124:127], a[140:143], a[236:239], v[124:127]
    s_waitcnt vmcnt(9) lgkmcnt(1)
    v_mfma_f32_16x16x32_bf16 v[72:75], a[144:147], a[248:251], v[72:75]
    ds_read_b128 a[232:235], v31 offset:55296
    s_waitcnt lgkmcnt(1)
    v_mfma_f32_16x16x32_bf16 v[76:79], a[144:147], a[252:255], v[76:79]
    v_mfma_f32_16x16x32_bf16 v[88:91], a[148:151], a[248:251], v[88:91]
    v_mfma_f32_16x16x32_bf16 v[92:95], a[148:151], a[252:255], v[92:95]
    ds_read_b128 a[236:239], v31 offset:56320
    v_mfma_f32_16x16x32_bf16 v[104:107], a[152:155], a[248:251], v[104:107]
    v_mfma_f32_16x16x32_bf16 v[108:111], a[152:155], a[252:255], v[108:111]
    v_mfma_f32_16x16x32_bf16 v[120:123], a[156:159], a[248:251], v[120:123]
    v_mfma_f32_16x16x32_bf16 v[124:127], a[156:159], a[252:255], v[124:127]
    s_waitcnt vmcnt(5) lgkmcnt(1)
    v_mfma_f32_16x16x32_bf16 v[72:75], a[160:163], a[232:235], v[72:75]
    ds_read_b128 a[248:251], v31 offset:63488
    s_waitcnt lgkmcnt(1)
    v_mfma_f32_16x16x32_bf16 v[76:79], a[160:163], a[236:239], v[76:79]
    v_mfma_f32_16x16x32_bf16 v[88:91], a[164:167], a[232:235], v[88:91]
    v_mfma_f32_16x16x32_bf16 v[92:95], a[164:167], a[236:239], v[92:95]
    ds_read_b128 a[252:255], v31 offset:64512
    v_mfma_f32_16x16x32_bf16 v[104:107], a[168:171], a[232:235], v[104:107]
    v_mfma_f32_16x16x32_bf16 v[108:111], a[168:171], a[236:239], v[108:111]
    v_mfma_f32_16x16x32_bf16 v[120:123], a[172:175], a[232:235], v[120:123]
    v_mfma_f32_16x16x32_bf16 v[124:127], a[172:175], a[236:239], v[124:127]
    s_waitcnt vmcnt(0) lgkmcnt(1)
    v_mfma_f32_16x16x32_bf16 v[72:75], a[176:179], a[248:251], v[72:75]
    ds_read_b128 a[224:227], v31 offset:36864
    s_waitcnt lgkmcnt(1)
    v_mfma_f32_16x16x32_bf16 v[76:79], a[176:179], a[252:255], v[76:79]
    v_mfma_f32_16x16x32_bf16 v[88:91], a[180:183], a[248:251], v[88:91]
    v_mfma_f32_16x16x32_bf16 v[92:95], a[180:183], a[252:255], v[92:95]
    ds_read_b128 a[228:231], v31 offset:37888
    v_mfma_f32_16x16x32_bf16 v[104:107], a[184:187], a[248:251], v[104:107]
    v_mfma_f32_16x16x32_bf16 v[108:111], a[184:187], a[252:255], v[108:111]
    v_mfma_f32_16x16x32_bf16 v[120:123], a[188:191], a[248:251], v[120:123]
    v_mfma_f32_16x16x32_bf16 v[124:127], a[188:191], a[252:255], v[124:127]
    s_mov_b32 s85, 0x40000
    v_readfirstlane_b32 s84, v22
    s_nop 0
    s_cmp_ge_u32 s84, 4
    s_cbranch_scc1 standalone__conformer_family_zipformer__speech_kernel_spinv21_11x
standalone__conformer_family_zipformer__speech_kernel_spinv21_11:
    buffer_load_dword v22, v21, s[24:27], s80 offen sc1
    s_waitcnt vmcnt(0)
    s_sub_u32 s85, s85, 1
    s_cbranch_scc1 standalone__conformer_family_zipformer__speech_kernel_spinv21_11x
    v_readfirstlane_b32 s84, v22
    s_nop 0
    s_cmp_ge_u32 s84, 4
    s_cbranch_scc0 standalone__conformer_family_zipformer__speech_kernel_spinv21_11
standalone__conformer_family_zipformer__speech_kernel_spinv21_11x:
    s_nop 3
    v_cvt_pk_bf16_f32 v128, v72, v73
    v_cvt_pk_bf16_f32 v129, v74, v75
    v_cvt_pk_bf16_f32 v130, v88, v89
    v_cvt_pk_bf16_f32 v131, v90, v91
    v_cvt_pk_bf16_f32 v132, v104, v105
    v_cvt_pk_bf16_f32 v133, v106, v107
    v_cvt_pk_bf16_f32 v134, v120, v121
    v_cvt_pk_bf16_f32 v135, v122, v123
    v_cvt_pk_bf16_f32 v136, v76, v77
    v_cvt_pk_bf16_f32 v137, v78, v79
    v_cvt_pk_bf16_f32 v138, v92, v93
    v_cvt_pk_bf16_f32 v139, v94, v95
    v_cvt_pk_bf16_f32 v140, v108, v109
    v_cvt_pk_bf16_f32 v141, v110, v111
    v_cvt_pk_bf16_f32 v142, v124, v125
    v_cvt_pk_bf16_f32 v143, v126, v127
    s_cmp_eq_u32 s83, 0
    s_cbranch_scc1 standalone__conformer_family_zipformer__speech_kernel_sndv21_12s
    buffer_store_dwordx4 v[128:131], v31, s[52:55], s13 offen offset:0
    buffer_store_dwordx4 v[132:135], v31, s[52:55], s13 offen offset:1024
    buffer_store_dwordx4 v[136:139], v31, s[52:55], s13 offen offset:2048
    buffer_store_dwordx4 v[140:143], v31, s[52:55], s13 offen offset:3072
    s_branch standalone__conformer_family_zipformer__speech_kernel_sndv21_12e
standalone__conformer_family_zipformer__speech_kernel_sndv21_12s:
    buffer_store_dwordx4 v[128:131], v31, s[52:55], s13 offen offset:0 sc1
    buffer_store_dwordx4 v[132:135], v31, s[52:55], s13 offen offset:1024 sc1
    buffer_store_dwordx4 v[136:139], v31, s[52:55], s13 offen offset:2048 sc1
    buffer_store_dwordx4 v[140:143], v31, s[52:55], s13 offen offset:3072 sc1
standalone__conformer_family_zipformer__speech_kernel_sndv21_12e:
    s_waitcnt lgkmcnt(1)
    v_mfma_f32_16x16x32_bf16 v[64:67], a[128:131], a[224:227], v[64:67]
    ds_read_b128 a[240:243], v31 offset:45056
    s_waitcnt lgkmcnt(1)
    v_mfma_f32_16x16x32_bf16 v[68:71], a[128:131], a[228:231], v[68:71]
    v_mfma_f32_16x16x32_bf16 v[80:83], a[132:135], a[224:227], v[80:83]
    v_mfma_f32_16x16x32_bf16 v[84:87], a[132:135], a[228:231], v[84:87]
    ds_read_b128 a[244:247], v31 offset:46080
    v_mfma_f32_16x16x32_bf16 v[96:99], a[136:139], a[224:227], v[96:99]
    v_mfma_f32_16x16x32_bf16 v[100:103], a[136:139], a[228:231], v[100:103]
    v_mfma_f32_16x16x32_bf16 v[112:115], a[140:143], a[224:227], v[112:115]
    v_mfma_f32_16x16x32_bf16 v[116:119], a[140:143], a[228:231], v[116:119]
    s_waitcnt lgkmcnt(1)
    v_mfma_f32_16x16x32_bf16 v[64:67], a[144:147], a[240:243], v[64:67]
    ds_read_b128 a[224:227], v31 offset:53248
    s_waitcnt lgkmcnt(1)
    v_mfma_f32_16x16x32_bf16 v[68:71], a[144:147], a[244:247], v[68:71]
    v_mfma_f32_16x16x32_bf16 v[80:83], a[148:151], a[240:243], v[80:83]
    v_mfma_f32_16x16x32_bf16 v[84:87], a[148:151], a[244:247], v[84:87]
    ds_read_b128 a[228:231], v31 offset:54272
    v_mfma_f32_16x16x32_bf16 v[96:99], a[152:155], a[240:243], v[96:99]
    v_mfma_f32_16x16x32_bf16 v[100:103], a[152:155], a[244:247], v[100:103]
    v_mfma_f32_16x16x32_bf16 v[112:115], a[156:159], a[240:243], v[112:115]
    v_mfma_f32_16x16x32_bf16 v[116:119], a[156:159], a[244:247], v[116:119]
    s_waitcnt lgkmcnt(1)
    v_mfma_f32_16x16x32_bf16 v[64:67], a[160:163], a[224:227], v[64:67]
    ds_read_b128 a[240:243], v31 offset:61440
    s_waitcnt lgkmcnt(1)
    v_mfma_f32_16x16x32_bf16 v[68:71], a[160:163], a[228:231], v[68:71]
    v_mfma_f32_16x16x32_bf16 v[80:83], a[164:167], a[224:227], v[80:83]
    v_mfma_f32_16x16x32_bf16 v[84:87], a[164:167], a[228:231], v[84:87]
    ds_read_b128 a[244:247], v31 offset:62464
    v_mfma_f32_16x16x32_bf16 v[96:99], a[168:171], a[224:227], v[96:99]
    v_mfma_f32_16x16x32_bf16 v[100:103], a[168:171], a[228:231], v[100:103]
    v_mfma_f32_16x16x32_bf16 v[112:115], a[172:175], a[224:227], v[112:115]
    v_mfma_f32_16x16x32_bf16 v[116:119], a[172:175], a[228:231], v[116:119]
    s_waitcnt lgkmcnt(1)
    v_mfma_f32_16x16x32_bf16 v[64:67], a[176:179], a[240:243], v[64:67]
    buffer_load_dwordx4 v[144:147], v31, s[52:55], s12 offen offset:0 sc1
    s_waitcnt lgkmcnt(0)
    v_mfma_f32_16x16x32_bf16 v[68:71], a[176:179], a[244:247], v[68:71]
    buffer_load_dwordx4 v[148:151], v31, s[52:55], s12 offen offset:1024 sc1
    v_mfma_f32_16x16x32_bf16 v[80:83], a[180:183], a[240:243], v[80:83]
    v_mfma_f32_16x16x32_bf16 v[84:87], a[180:183], a[244:247], v[84:87]
    buffer_load_dwordx4 v[152:155], v31, s[52:55], s12 offen offset:2048 sc1
    v_mfma_f32_16x16x32_bf16 v[96:99], a[184:187], a[240:243], v[96:99]
    v_mfma_f32_16x16x32_bf16 v[100:103], a[184:187], a[244:247], v[100:103]
    buffer_load_dwordx4 v[156:159], v31, s[52:55], s12 offen offset:3072 sc1
    v_mfma_f32_16x16x32_bf16 v[112:115], a[188:191], a[240:243], v[112:115]
    v_mfma_f32_16x16x32_bf16 v[116:119], a[188:191], a[244:247], v[116:119]
    s_mov_b32 s42, 0xbeb17218
    s_mov_b32 s43, 0xffff0000
    v_pk_fma_f32 v[32:33], v[64:65], s[42:43], v[32:33] op_sel_hi:[1,0,1]
    v_pk_fma_f32 v[34:35], v[66:67], s[42:43], v[34:35] op_sel_hi:[1,0,1]
    v_pk_fma_f32 v[36:37], v[68:69], s[42:43], v[36:37] op_sel_hi:[1,0,1]
    v_pk_fma_f32 v[38:39], v[70:71], s[42:43], v[38:39] op_sel_hi:[1,0,1]
    v_pk_fma_f32 v[40:41], v[80:81], s[42:43], v[40:41] op_sel_hi:[1,0,1]
    v_pk_fma_f32 v[42:43], v[82:83], s[42:43], v[42:43] op_sel_hi:[1,0,1]
    v_pk_fma_f32 v[44:45], v[84:85], s[42:43], v[44:45] op_sel_hi:[1,0,1]
    v_pk_fma_f32 v[46:47], v[86:87], s[42:43], v[46:47] op_sel_hi:[1,0,1]
    v_pk_fma_f32 v[48:49], v[96:97], s[42:43], v[48:49] op_sel_hi:[1,0,1]
    v_pk_fma_f32 v[50:51], v[98:99], s[42:43], v[50:51] op_sel_hi:[1,0,1]
    v_pk_fma_f32 v[52:53], v[100:101], s[42:43], v[52:53] op_sel_hi:[1,0,1]
    v_pk_fma_f32 v[54:55], v[102:103], s[42:43], v[54:55] op_sel_hi:[1,0,1]
    v_pk_fma_f32 v[56:57], v[112:113], s[42:43], v[56:57] op_sel_hi:[1,0,1]
    v_pk_fma_f32 v[58:59], v[114:115], s[42:43], v[58:59] op_sel_hi:[1,0,1]
    v_pk_fma_f32 v[60:61], v[116:117], s[42:43], v[60:61] op_sel_hi:[1,0,1]
    v_pk_fma_f32 v[62:63], v[118:119], s[42:43], v[62:63] op_sel_hi:[1,0,1]
    v_and_b32 v7, 15, v1
    v_lshlrev_b32 v7, 9, v7
    v_bfe_u32 v8, v1, 4, 1
    v_lshl_add_u32 v7, v8, 5, v7
    v_lshrrev_b32 v8, 5, v1
    v_lshl_add_u32 v7, v8, 4, v7
    s_lshl_b32 s5, s66, 14
    s_add_u32 s4, s44, s5
    s_lshl_b32 s5, s65, 13
    s_add_u32 s4, s4, s5
    s_xor_b32 s5, s4, 8192
    s_mov_b32 s85, 0x40000
    s_waitcnt vmcnt(0)
    s_branch standalone__conformer_family_zipformer__speech_kernel_rcvv21_13c
standalone__conformer_family_zipformer__speech_kernel_rcvv21_13:
    buffer_load_dwordx4 v[144:147], v31, s[52:55], s12 offen offset:0 sc1
    buffer_load_dwordx4 v[148:151], v31, s[52:55], s12 offen offset:1024 sc1
    buffer_load_dwordx4 v[152:155], v31, s[52:55], s12 offen offset:2048 sc1
    buffer_load_dwordx4 v[156:159], v31, s[52:55], s12 offen offset:3072 sc1
standalone__conformer_family_zipformer__speech_kernel_rcvv21_13c:
    s_waitcnt vmcnt(3)
    v_max3_u32 v192, v144, v145, v146
    s_waitcnt vmcnt(2)
    v_max3_u32 v192, v192, v147, v148
    v_max3_u32 v192, v192, v149, v150
    s_waitcnt vmcnt(1)
    v_max3_u32 v192, v192, v151, v152
    v_max3_u32 v192, v192, v153, v154
    s_waitcnt vmcnt(0)
    v_max3_u32 v192, v192, v155, v156
    v_max3_u32 v192, v192, v157, v158
    v_max_u32 v192, v192, v159
    s_sub_u32 s85, s85, 1
    s_cbranch_scc1 standalone__conformer_family_zipformer__speech_kernel_rcvv21_13x
    v_cmp_eq_u32 vcc, -1, v192
    s_nop 0
    s_cmp_lg_u64 vcc, 0
    s_cbranch_scc1 standalone__conformer_family_zipformer__speech_kernel_rcvv21_13
standalone__conformer_family_zipformer__speech_kernel_rcvv21_13x:
    v_lshlrev_b32 v192, 16, v144
    v_and_b32 v193, s43, v144
    v_lshlrev_b32 v194, 16, v145
    v_and_b32 v195, s43, v145
    v_lshlrev_b32 v196, 16, v146
    v_and_b32 v197, s43, v146
    v_lshlrev_b32 v198, 16, v147
    v_and_b32 v199, s43, v147
    v_pk_fma_f32 v[32:33], v[192:193], s[42:43], v[32:33] op_sel_hi:[1,0,1]
    v_pk_fma_f32 v[34:35], v[194:195], s[42:43], v[34:35] op_sel_hi:[1,0,1]
    v_pk_fma_f32 v[40:41], v[196:197], s[42:43], v[40:41] op_sel_hi:[1,0,1]
    v_pk_fma_f32 v[42:43], v[198:199], s[42:43], v[42:43] op_sel_hi:[1,0,1]
    v_lshlrev_b32 v200, 16, v148
    v_and_b32 v201, s43, v148
    v_lshlrev_b32 v202, 16, v149
    v_and_b32 v203, s43, v149
    v_lshlrev_b32 v204, 16, v150
    v_and_b32 v205, s43, v150
    v_lshlrev_b32 v206, 16, v151
    v_and_b32 v207, s43, v151
    v_pk_fma_f32 v[48:49], v[200:201], s[42:43], v[48:49] op_sel_hi:[1,0,1]
    v_pk_fma_f32 v[50:51], v[202:203], s[42:43], v[50:51] op_sel_hi:[1,0,1]
    v_pk_fma_f32 v[56:57], v[204:205], s[42:43], v[56:57] op_sel_hi:[1,0,1]
    v_pk_fma_f32 v[58:59], v[206:207], s[42:43], v[58:59] op_sel_hi:[1,0,1]
    v_lshlrev_b32 v192, 16, v152
    v_and_b32 v193, s43, v152
    v_lshlrev_b32 v194, 16, v153
    v_and_b32 v195, s43, v153
    v_lshlrev_b32 v196, 16, v154
    v_and_b32 v197, s43, v154
    v_lshlrev_b32 v198, 16, v155
    v_and_b32 v199, s43, v155
    v_pk_fma_f32 v[36:37], v[192:193], s[42:43], v[36:37] op_sel_hi:[1,0,1]
    v_pk_fma_f32 v[38:39], v[194:195], s[42:43], v[38:39] op_sel_hi:[1,0,1]
    v_pk_fma_f32 v[44:45], v[196:197], s[42:43], v[44:45] op_sel_hi:[1,0,1]
    v_pk_fma_f32 v[46:47], v[198:199], s[42:43], v[46:47] op_sel_hi:[1,0,1]
    v_lshlrev_b32 v200, 16, v156
    v_and_b32 v201, s43, v156
    v_lshlrev_b32 v202, 16, v157
    v_and_b32 v203, s43, v157
    v_lshlrev_b32 v204, 16, v158
    v_and_b32 v205, s43, v158
    v_lshlrev_b32 v206, 16, v159
    v_and_b32 v207, s43, v159
    v_pk_fma_f32 v[52:53], v[200:201], s[42:43], v[52:53] op_sel_hi:[1,0,1]
    v_pk_fma_f32 v[54:55], v[202:203], s[42:43], v[54:55] op_sel_hi:[1,0,1]
    v_pk_fma_f32 v[60:61], v[204:205], s[42:43], v[60:61] op_sel_hi:[1,0,1]
    v_pk_fma_f32 v[62:63], v[206:207], s[42:43], v[62:63] op_sel_hi:[1,0,1]
    v_pk_add_f32 v[192:193], v[32:33], v[34:35]
    v_pk_mul_f32 v[194:195], v[32:33], v[32:33]
    v_pk_fma_f32 v[194:195], v[34:35], v[34:35], v[194:195]
    v_pk_add_f32 v[192:193], v[192:193], v[40:41]
    v_pk_fma_f32 v[194:195], v[40:41], v[40:41], v[194:195]
    v_pk_add_f32 v[192:193], v[192:193], v[42:43]
    v_pk_fma_f32 v[194:195], v[42:43], v[42:43], v[194:195]
    v_pk_add_f32 v[192:193], v[192:193], v[48:49]
    v_pk_fma_f32 v[194:195], v[48:49], v[48:49], v[194:195]
    v_pk_add_f32 v[192:193], v[192:193], v[50:51]
    v_pk_fma_f32 v[194:195], v[50:51], v[50:51], v[194:195]
    v_pk_add_f32 v[192:193], v[192:193], v[56:57]
    v_pk_fma_f32 v[194:195], v[56:57], v[56:57], v[194:195]
    v_pk_add_f32 v[192:193], v[192:193], v[58:59]
    v_pk_fma_f32 v[194:195], v[58:59], v[58:59], v[194:195]
    v_pk_add_f32 v[196:197], v[36:37], v[38:39]
    v_pk_mul_f32 v[198:199], v[36:37], v[36:37]
    v_pk_fma_f32 v[198:199], v[38:39], v[38:39], v[198:199]
    v_pk_add_f32 v[196:197], v[196:197], v[44:45]
    v_pk_fma_f32 v[198:199], v[44:45], v[44:45], v[198:199]
    v_pk_add_f32 v[196:197], v[196:197], v[46:47]
    v_pk_fma_f32 v[198:199], v[46:47], v[46:47], v[198:199]
    v_pk_add_f32 v[196:197], v[196:197], v[52:53]
    v_pk_fma_f32 v[198:199], v[52:53], v[52:53], v[198:199]
    v_pk_add_f32 v[196:197], v[196:197], v[54:55]
    v_pk_fma_f32 v[198:199], v[54:55], v[54:55], v[198:199]
    v_pk_add_f32 v[196:197], v[196:197], v[60:61]
    v_pk_fma_f32 v[198:199], v[60:61], v[60:61], v[198:199]
    v_pk_add_f32 v[196:197], v[196:197], v[62:63]
    v_pk_fma_f32 v[198:199], v[62:63], v[62:63], v[198:199]
    v_add_f32 v192, v192, v193
    v_add_f32 v194, v194, v195
    v_add_f32 v196, v196, v197
    v_add_f32 v198, v198, v199
    v_permlane32_swap_b32 v192, v194
    s_nop 0
    v_permlane32_swap_b32 v196, v198
    v_add_f32 v192, v192, v194
    v_add_f32 v196, v196, v198
    s_nop 1
    v_permlane16_swap_b32 v192, v196
    v_add_f32 v192, v192, v196
    ds_write_b32 v29, v192 offset:0
    s_waitcnt lgkmcnt(0)
    s_barrier
    ds_read_b128 v[208:211], v30 offset:0
    ds_read_b128 v[216:219], v30 offset:512
    ds_read_b128 v[212:215], v30 offset:256
    ds_read_b128 v[220:223], v30 offset:768
    s_waitcnt lgkmcnt(3)
    v_pk_add_f32 v[208:209], v[208:209], v[210:211]
    s_waitcnt lgkmcnt(2)
    v_pk_add_f32 v[216:217], v[216:217], v[218:219]
    s_waitcnt lgkmcnt(1)
    v_pk_add_f32 v[212:213], v[212:213], v[214:215]
    s_waitcnt lgkmcnt(0)
    v_pk_add_f32 v[220:221], v[220:221], v[222:223]
    v_add_f32 v208, v208, v209
    v_add_f32 v216, v216, v217
    v_add_f32 v212, v212, v213
    v_add_f32 v220, v220, v221
    v_mul_f32 v208, 0x3b800000, v208
    v_mul_f32 v216, 0x3b800000, v216
    v_mul_f32 v212, 0x3b800000, v212
    v_mul_f32 v220, 0x3b800000, v220
    v_fma_f32 v216, -v208, v208, v216
    v_fma_f32 v220, -v212, v212, v220
    v_max_f32 v216, 0, v216
    v_max_f32 v220, 0, v220
    v_add_f32 v216, 0x3727c5ac, v216
    v_add_f32 v220, 0x3727c5ac, v220
    v_rsq_f32 v192, v216
    v_rsq_f32 v196, v220
    v_mul_f32 v194, -v208, v192
    v_mul_f32 v198, -v212, v196
    v_pk_fma_f32 v[64:65], v[32:33], v[192:193], v[194:195] op_sel_hi:[1,0,0]
    v_pk_fma_f32 v[66:67], v[34:35], v[192:193], v[194:195] op_sel_hi:[1,0,0]
    v_pk_fma_f32 v[68:69], v[40:41], v[192:193], v[194:195] op_sel_hi:[1,0,0]
    v_pk_fma_f32 v[70:71], v[42:43], v[192:193], v[194:195] op_sel_hi:[1,0,0]
    v_cvt_pk_bf16_f32 v72, v64, v65
    v_cvt_pk_bf16_f32 v73, v66, v67
    v_cvt_pk_bf16_f32 v74, v68, v69
    v_cvt_pk_bf16_f32 v75, v70, v71
    s_nop 0
    v_permlane16_swap_b32 v72, v74
    v_permlane16_swap_b32 v73, v75
    buffer_store_dwordx4 v[72:75], v7, s[52:55], s4 offen offset:0
    v_pk_fma_f32 v[76:77], v[48:49], v[192:193], v[194:195] op_sel_hi:[1,0,0]
    v_pk_fma_f32 v[78:79], v[50:51], v[192:193], v[194:195] op_sel_hi:[1,0,0]
    v_pk_fma_f32 v[80:81], v[56:57], v[192:193], v[194:195] op_sel_hi:[1,0,0]
    v_pk_fma_f32 v[82:83], v[58:59], v[192:193], v[194:195] op_sel_hi:[1,0,0]
    v_cvt_pk_bf16_f32 v84, v76, v77
    v_cvt_pk_bf16_f32 v85, v78, v79
    v_cvt_pk_bf16_f32 v86, v80, v81
    v_cvt_pk_bf16_f32 v87, v82, v83
    s_nop 0
    v_permlane16_swap_b32 v84, v86
    v_permlane16_swap_b32 v85, v87
    buffer_store_dwordx4 v[84:87], v7, s[52:55], s4 offen offset:64
    v_pk_fma_f32 v[88:89], v[36:37], v[196:197], v[198:199] op_sel_hi:[1,0,0]
    v_pk_fma_f32 v[90:91], v[38:39], v[196:197], v[198:199] op_sel_hi:[1,0,0]
    v_pk_fma_f32 v[92:93], v[44:45], v[196:197], v[198:199] op_sel_hi:[1,0,0]
    v_pk_fma_f32 v[94:95], v[46:47], v[196:197], v[198:199] op_sel_hi:[1,0,0]
    v_cvt_pk_bf16_f32 v96, v88, v89
    v_cvt_pk_bf16_f32 v97, v90, v91
    v_cvt_pk_bf16_f32 v98, v92, v93
    v_cvt_pk_bf16_f32 v99, v94, v95
    s_nop 0
    v_permlane16_swap_b32 v96, v98
    v_permlane16_swap_b32 v97, v99
    buffer_store_dwordx4 v[96:99], v7, s[52:55], s5 offen offset:0
    v_pk_fma_f32 v[100:101], v[52:53], v[196:197], v[198:199] op_sel_hi:[1,0,0]
    v_pk_fma_f32 v[102:103], v[54:55], v[196:197], v[198:199] op_sel_hi:[1,0,0]
    v_pk_fma_f32 v[104:105], v[60:61], v[196:197], v[198:199] op_sel_hi:[1,0,0]
    v_pk_fma_f32 v[106:107], v[62:63], v[196:197], v[198:199] op_sel_hi:[1,0,0]
    v_cvt_pk_bf16_f32 v108, v100, v101
    v_cvt_pk_bf16_f32 v109, v102, v103
    v_cvt_pk_bf16_f32 v110, v104, v105
    v_cvt_pk_bf16_f32 v111, v106, v107
    s_nop 0
    v_permlane16_swap_b32 v108, v110
    v_permlane16_swap_b32 v109, v111
    buffer_store_dwordx4 v[108:111], v7, s[52:55], s5 offen offset:64
standalone__conformer_family_zipformer__speech_kernel_end:
    s_endpgm
standalone__conformer_family_zipformer__speech_kernel_short:
    s_waitcnt vmcnt(0) lgkmcnt(0)
    s_nop 7
    s_nop 7
    s_cmp_eq_u32 s3, 0
    s_cselect_b32 s31, s28, s29
    s_cselect_b32 s32, 32, 31
    buffer_load_dwordx4 a[160:163], v2, s[8:11], s22 offen offset:0
    buffer_load_dwordx4 a[164:167], v2, s[8:11], s22 offen offset:1024
    buffer_load_dwordx4 a[168:171], v2, s[8:11], s22 offen offset:2048
    buffer_load_dwordx4 a[172:175], v2, s[8:11], s22 offen offset:3072
    buffer_load_dwordx4 a[176:179], v2, s[8:11], s23 offen offset:0
    buffer_load_dwordx4 a[180:183], v2, s[8:11], s23 offen offset:1024
    buffer_load_dwordx4 a[184:187], v2, s[8:11], s23 offen offset:2048
    buffer_load_dwordx4 a[188:191], v2, s[8:11], s23 offen offset:3072
    buffer_load_dwordx4 v[16:19], v2, s[8:11], s31 offen offset:0
    buffer_load_dwordx4 v[20:23], v2, s[8:11], s31 offen offset:1024
    buffer_load_dwordx4 v[24:27], v2, s[8:11], s31 offen offset:2048
    buffer_load_dwordx4 v[28:31], v2, s[8:11], s31 offen offset:3072
    buffer_load_dwordx4 v[32:35], v13, s[8:11], s31 offen offset:0
    buffer_load_dwordx4 v[36:39], v13, s[8:11], s31 offen offset:1024
    buffer_load_dwordx4 v[40:43], v13, s[8:11], s31 offen offset:2048
    buffer_load_dwordx4 v[44:47], v13, s[8:11], s31 offen offset:3072
    s_add_u32 s14, s31, 8192
    s_cmp_eq_u32 s31, s28
    s_cselect_b32 s31, s29, s14
standalone__conformer_family_zipformer__speech_kernel_sloop:
    buffer_load_dwordx4 v[48:51], v2, s[8:11], s31 offen offset:0
    buffer_load_dwordx4 v[52:55], v2, s[8:11], s31 offen offset:1024
    buffer_load_dwordx4 v[56:59], v2, s[8:11], s31 offen offset:2048
    buffer_load_dwordx4 v[60:63], v2, s[8:11], s31 offen offset:3072
    buffer_load_dwordx4 v[64:67], v13, s[8:11], s31 offen offset:0
    buffer_load_dwordx4 v[68:71], v13, s[8:11], s31 offen offset:1024
    buffer_load_dwordx4 v[72:75], v13, s[8:11], s31 offen offset:2048
    buffer_load_dwordx4 v[76:79], v13, s[8:11], s31 offen offset:3072
    s_add_u32 s14, s31, 8192
    s_cmp_eq_u32 s31, s28
    s_cselect_b32 s31, s29, s14
    s_waitcnt vmcnt(12)
    v_mfma_f32_16x16x32_bf16 v[112:115], v[16:19], a[128:131], v[80:83]
    v_mfma_f32_16x16x32_bf16 v[120:123], v[16:19], a[136:139], v[84:87]
    v_mfma_f32_16x16x32_bf16 v[116:119], v[24:27], a[128:131], v[80:83]
    v_mfma_f32_16x16x32_bf16 v[124:127], v[24:27], a[136:139], v[84:87]
    v_mfma_f32_16x16x32_bf16 v[112:115], v[20:23], a[132:135], v[112:115]
    v_mfma_f32_16x16x32_bf16 v[120:123], v[20:23], a[140:143], v[120:123]
    v_mfma_f32_16x16x32_bf16 v[116:119], v[28:31], a[132:135], v[116:119]
    v_mfma_f32_16x16x32_bf16 v[124:127], v[28:31], a[140:143], v[124:127]
    s_waitcnt vmcnt(8)
    s_nop 3
    v_exp_f32 v144, v112
    v_exp_f32 v145, v113
    v_exp_f32 v146, v114
    v_exp_f32 v147, v115
    v_exp_f32 v148, v116
    v_exp_f32 v149, v117
    v_exp_f32 v150, v118
    v_exp_f32 v151, v119
    v_exp_f32 v152, v120
    v_exp_f32 v153, v121
    v_exp_f32 v154, v122
    v_exp_f32 v155, v123
    v_exp_f32 v156, v124
    v_exp_f32 v157, v125
    v_exp_f32 v158, v126
    v_exp_f32 v159, v127
    v_cvt_pk_bf16_f32 v160, v144, v145
    v_cvt_pk_bf16_f32 v161, v146, v147
    v_cvt_pk_bf16_f32 v162, v148, v149
    v_cvt_pk_bf16_f32 v163, v150, v151
    v_cvt_pk_bf16_f32 v164, v152, v153
    v_cvt_pk_bf16_f32 v165, v154, v155
    v_cvt_pk_bf16_f32 v166, v156, v157
    v_cvt_pk_bf16_f32 v167, v158, v159
    v_mfma_f32_16x16x32_bf16 a[0:3], v[32:35], v[160:163], a[0:3]
    s_nop 0
    v_mfma_f32_16x16x32_bf16 a[4:7], v[32:35], v[164:167], a[4:7]
    v_mfma_f32_16x16x32_bf16 a[8:11], v[36:39], v[160:163], a[8:11]
    v_mfma_f32_16x16x32_bf16 a[12:15], v[36:39], v[164:167], a[12:15]
    v_mfma_f32_16x16x32_bf16 a[16:19], v[40:43], v[160:163], a[16:19]
    v_mfma_f32_16x16x32_bf16 a[20:23], v[40:43], v[164:167], a[20:23]
    v_mfma_f32_16x16x32_bf16 a[24:27], v[44:47], v[160:163], a[24:27]
    v_mfma_f32_16x16x32_bf16 a[28:31], v[44:47], v[164:167], a[28:31]
    v_smfmac_f32_16x16x64_bf16 a[192:195], v[176:179], v[160:167], v180
    s_sub_u32 s32, s32, 1
    s_cmp_eq_u32 s32, 0
    s_cbranch_scc1 standalone__conformer_family_zipformer__speech_kernel_sdone
    buffer_load_dwordx4 v[16:19], v2, s[8:11], s31 offen offset:0
    buffer_load_dwordx4 v[20:23], v2, s[8:11], s31 offen offset:1024
    buffer_load_dwordx4 v[24:27], v2, s[8:11], s31 offen offset:2048
    buffer_load_dwordx4 v[28:31], v2, s[8:11], s31 offen offset:3072
    buffer_load_dwordx4 v[32:35], v13, s[8:11], s31 offen offset:0
    buffer_load_dwordx4 v[36:39], v13, s[8:11], s31 offen offset:1024
    buffer_load_dwordx4 v[40:43], v13, s[8:11], s31 offen offset:2048
    buffer_load_dwordx4 v[44:47], v13, s[8:11], s31 offen offset:3072
    s_add_u32 s14, s31, 8192
    s_cmp_eq_u32 s31, s28
    s_cselect_b32 s31, s29, s14
    s_waitcnt vmcnt(12)
    v_mfma_f32_16x16x32_bf16 v[112:115], v[48:51], a[128:131], v[80:83]
    v_mfma_f32_16x16x32_bf16 v[120:123], v[48:51], a[136:139], v[84:87]
    v_mfma_f32_16x16x32_bf16 v[116:119], v[56:59], a[128:131], v[80:83]
    v_mfma_f32_16x16x32_bf16 v[124:127], v[56:59], a[136:139], v[84:87]
    v_mfma_f32_16x16x32_bf16 v[112:115], v[52:55], a[132:135], v[112:115]
    v_mfma_f32_16x16x32_bf16 v[120:123], v[52:55], a[140:143], v[120:123]
    v_mfma_f32_16x16x32_bf16 v[116:119], v[60:63], a[132:135], v[116:119]
    v_mfma_f32_16x16x32_bf16 v[124:127], v[60:63], a[140:143], v[124:127]
    s_waitcnt vmcnt(8)
    s_nop 3
    v_exp_f32 v144, v112
    v_exp_f32 v145, v113
    v_exp_f32 v146, v114
    v_exp_f32 v147, v115
    v_exp_f32 v148, v116
    v_exp_f32 v149, v117
    v_exp_f32 v150, v118
    v_exp_f32 v151, v119
    v_exp_f32 v152, v120
    v_exp_f32 v153, v121
    v_exp_f32 v154, v122
    v_exp_f32 v155, v123
    v_exp_f32 v156, v124
    v_exp_f32 v157, v125
    v_exp_f32 v158, v126
    v_exp_f32 v159, v127
    v_cvt_pk_bf16_f32 v160, v144, v145
    v_cvt_pk_bf16_f32 v161, v146, v147
    v_cvt_pk_bf16_f32 v162, v148, v149
    v_cvt_pk_bf16_f32 v163, v150, v151
    v_cvt_pk_bf16_f32 v164, v152, v153
    v_cvt_pk_bf16_f32 v165, v154, v155
    v_cvt_pk_bf16_f32 v166, v156, v157
    v_cvt_pk_bf16_f32 v167, v158, v159
    v_mfma_f32_16x16x32_bf16 a[0:3], v[64:67], v[160:163], a[0:3]
    s_nop 0
    v_mfma_f32_16x16x32_bf16 a[4:7], v[64:67], v[164:167], a[4:7]
    v_mfma_f32_16x16x32_bf16 a[8:11], v[68:71], v[160:163], a[8:11]
    v_mfma_f32_16x16x32_bf16 a[12:15], v[68:71], v[164:167], a[12:15]
    v_mfma_f32_16x16x32_bf16 a[16:19], v[72:75], v[160:163], a[16:19]
    v_mfma_f32_16x16x32_bf16 a[20:23], v[72:75], v[164:167], a[20:23]
    v_mfma_f32_16x16x32_bf16 a[24:27], v[76:79], v[160:163], a[24:27]
    v_mfma_f32_16x16x32_bf16 a[28:31], v[76:79], v[164:167], a[28:31]
    v_smfmac_f32_16x16x64_bf16 a[192:195], v[176:179], v[160:167], v180
    s_sub_u32 s32, s32, 1
    s_cmp_eq_u32 s32, 0
    s_cbranch_scc0 standalone__conformer_family_zipformer__speech_kernel_sloop
standalone__conformer_family_zipformer__speech_kernel_sdone:
    s_waitcnt vmcnt(0) lgkmcnt(0)
    s_nop 7
    s_nop 7
    s_mul_i32 s40, s3, 10240
    s_add_u32 m0, s40, 122880
    s_add_u32 s41, s40, 25165824
    buffer_load_dwordx4 v2, s[8:11], s41 offen offset:0 lds
    buffer_load_dwordx4 v2, s[8:11], s41 offen offset:1024 lds
    buffer_load_dwordx4 v2, s[8:11], s41 offen offset:2048 lds
    buffer_load_dwordx4 v2, s[8:11], s41 offen offset:3072 lds
    s_add_u32 m0, s40, 126976
    s_add_u32 s41, s40, 25169920
    buffer_load_dwordx4 v2, s[8:11], s41 offen offset:0 lds
    buffer_load_dwordx4 v2, s[8:11], s41 offen offset:1024 lds
    buffer_load_dwordx4 v2, s[8:11], s41 offen offset:2048 lds
    buffer_load_dwordx4 v2, s[8:11], s41 offen offset:3072 lds
    s_add_u32 m0, s40, 131072
    s_add_u32 s41, s40, 25174016
    buffer_load_dwordx4 v2, s[8:11], s41 offen offset:0 lds
    buffer_load_dwordx4 v2, s[8:11], s41 offen offset:1024 lds
    s_waitcnt vmcnt(0)
    buffer_load_dword v181, v14, s[8:11], s38 offen sc1
    buffer_load_dword v181, v15, s[8:11], s39 offen sc1
    buffer_store_dwordx4 a[232:235], v2, s[8:11], s91 offen offset:0 sc1
    buffer_store_dwordx4 a[236:239], v2, s[8:11], s91 offen offset:1024 sc1
    buffer_load_dwordx4 a[208:211], v2, s[8:11], s93 offen offset:0
    buffer_load_dwordx4 a[212:215], v2, s[8:11], s93 offen offset:1024
    buffer_load_dwordx4 a[216:219], v2, s[8:11], s93 offen offset:2048
    buffer_load_dwordx4 a[220:223], v2, s[8:11], s93 offen offset:3072
    s_sub_u32 s14, s3, 1
    s_mul_i32 s14, s14, 9216
    v_add_u32 v4, s14, v2
    v_accvgpr_read_b32 v80, a0
    v_accvgpr_read_b32 v81, a1
    v_accvgpr_read_b32 v82, a2
    v_accvgpr_read_b32 v83, a3
    v_accvgpr_read_b32 v84, a4
    v_accvgpr_read_b32 v85, a5
    v_accvgpr_read_b32 v86, a6
    v_accvgpr_read_b32 v87, a7
    v_accvgpr_read_b32 v88, a8
    v_accvgpr_read_b32 v89, a9
    v_accvgpr_read_b32 v90, a10
    v_accvgpr_read_b32 v91, a11
    v_accvgpr_read_b32 v92, a12
    v_accvgpr_read_b32 v93, a13
    v_accvgpr_read_b32 v94, a14
    v_accvgpr_read_b32 v95, a15
    v_accvgpr_read_b32 v96, a16
    v_accvgpr_read_b32 v97, a17
    v_accvgpr_read_b32 v98, a18
    v_accvgpr_read_b32 v99, a19
    v_accvgpr_read_b32 v100, a20
    v_accvgpr_read_b32 v101, a21
    v_accvgpr_read_b32 v102, a22
    v_accvgpr_read_b32 v103, a23
    v_accvgpr_read_b32 v104, a24
    v_accvgpr_read_b32 v105, a25
    v_accvgpr_read_b32 v106, a26
    v_accvgpr_read_b32 v107, a27
    v_accvgpr_read_b32 v108, a28
    v_accvgpr_read_b32 v109, a29
    v_accvgpr_read_b32 v110, a30
    v_accvgpr_read_b32 v111, a31
    v_mov_b32 v188, 0
    v_mov_b32 v189, 0
    v_mov_b32 v190, 0
    v_mov_b32 v191, 0
    v_mov_b32 v192, 0
    v_mov_b32 v193, 0
    v_mov_b32 v194, 0
    v_mov_b32 v195, 0
    v_mov_b32 v196, 0
    v_mov_b32 v197, 0
    v_mov_b32 v198, 0
    v_mov_b32 v199, 0
    s_cmp_eq_u32 s3, 0
    s_cbranch_scc1 standalone__conformer_family_zipformer__speech_kernel_join
    ds_write_b128 v4, a[0:3] offset:0
    ds_write_b128 v4, a[4:7] offset:1024
    ds_write_b128 v4, a[8:11] offset:2048
    ds_write_b128 v4, a[12:15] offset:3072
    ds_write_b128 v4, a[16:19] offset:4096
    ds_write_b128 v4, a[20:23] offset:5120
    ds_write_b128 v4, a[24:27] offset:6144
    ds_write_b128 v4, a[28:31] offset:7168
    ds_write_b128 v4, a[192:195] offset:8192
    s_nop 7
    s_branch standalone__conformer_family_zipformer__speech_kernel_join
standalone__conformer_family_zipformer__speech_kernel_slow:
    s_waitcnt vmcnt(0) lgkmcnt(0)
    s_nop 7
    s_nop 7
    s_barrier
    v_mov_b32 v184, 0xff800000
    v_mov_b32 v185, 0xff800000
    v_mov_b32 v186, 0xff800000
    v_mov_b32 v187, 0xff800000
    v_mov_b32 v188, 0xff800000
    v_mov_b32 v189, 0xff800000
    v_mov_b32 v190, 0xff800000
    v_mov_b32 v191, 0xff800000
    s_mov_b32 s31, s28
    s_mov_b32 s32, 0
standalone__conformer_family_zipformer__speech_kernel_mloop:
    buffer_load_dwordx4 v[16:19], v2, s[8:11], s31 offen offset:0
    buffer_load_dwordx4 v[20:23], v2, s[8:11], s31 offen offset:1024
    buffer_load_dwordx4 v[24:27], v2, s[8:11], s31 offen offset:2048
    buffer_load_dwordx4 v[28:31], v2, s[8:11], s31 offen offset:3072
    s_waitcnt vmcnt(3)
    v_mfma_f32_16x16x32_bf16 v[112:115], v[16:19], a[128:131], 0
    v_mfma_f32_16x16x32_bf16 v[120:123], v[16:19], a[136:139], 0
    s_waitcnt vmcnt(1)
    v_mfma_f32_16x16x32_bf16 v[116:119], v[24:27], a[128:131], 0
    v_mfma_f32_16x16x32_bf16 v[124:127], v[24:27], a[136:139], 0
    v_mfma_f32_16x16x32_bf16 v[112:115], v[20:23], a[132:135], v[112:115]
    v_mfma_f32_16x16x32_bf16 v[120:123], v[20:23], a[140:143], v[120:123]
    s_waitcnt vmcnt(0)
    v_mfma_f32_16x16x32_bf16 v[116:119], v[28:31], a[132:135], v[116:119]
    v_mfma_f32_16x16x32_bf16 v[124:127], v[28:31], a[140:143], v[124:127]
    s_nop 3
    v_max3_f32 v184, v184, v112, v113
    v_max3_f32 v184, v184, v114, v115
    s_nop 0
    v_max3_f32 v184, v184, v116, v117
    v_max3_f32 v184, v184, v118, v119
    v_max3_f32 v185, v185, v120, v121
    v_max3_f32 v185, v185, v122, v123
    v_max3_f32 v185, v185, v124, v125
    v_max3_f32 v185, v185, v126, v127
    v_mfma_f32_16x16x32_bf16 v[112:115], v[16:19], a[144:147], 0
    v_mfma_f32_16x16x32_bf16 v[120:123], v[16:19], a[152:155], 0
    v_mfma_f32_16x16x32_bf16 v[116:119], v[24:27], a[144:147], 0
    v_mfma_f32_16x16x32_bf16 v[124:127], v[24:27], a[152:155], 0
    v_mfma_f32_16x16x32_bf16 v[112:115], v[20:23], a[148:151], v[112:115]
    v_mfma_f32_16x16x32_bf16 v[120:123], v[20:23], a[156:159], v[120:123]
    v_mfma_f32_16x16x32_bf16 v[116:119], v[28:31], a[148:151], v[116:119]
    v_mfma_f32_16x16x32_bf16 v[124:127], v[28:31], a[156:159], v[124:127]
    s_nop 4
    v_max3_f32 v186, v186, v112, v113
    v_max3_f32 v186, v186, v114, v115
    v_max3_f32 v186, v186, v116, v117
    v_max3_f32 v186, v186, v118, v119
    v_max3_f32 v187, v187, v120, v121
    v_max3_f32 v187, v187, v122, v123
    v_max3_f32 v187, v187, v124, v125
    v_max3_f32 v187, v187, v126, v127
    v_mfma_f32_16x16x32_bf16 v[112:115], v[16:19], a[160:163], 0
    v_mfma_f32_16x16x32_bf16 v[120:123], v[16:19], a[168:171], 0
    v_mfma_f32_16x16x32_bf16 v[116:119], v[24:27], a[160:163], 0
    v_mfma_f32_16x16x32_bf16 v[124:127], v[24:27], a[168:171], 0
    v_mfma_f32_16x16x32_bf16 v[112:115], v[20:23], a[164:167], v[112:115]
    v_mfma_f32_16x16x32_bf16 v[120:123], v[20:23], a[172:175], v[120:123]
    v_mfma_f32_16x16x32_bf16 v[116:119], v[28:31], a[164:167], v[116:119]
    v_mfma_f32_16x16x32_bf16 v[124:127], v[28:31], a[172:175], v[124:127]
    s_nop 4
    v_max3_f32 v188, v188, v112, v113
    v_max3_f32 v188, v188, v114, v115
    v_max3_f32 v188, v188, v116, v117
    v_max3_f32 v188, v188, v118, v119
    v_max3_f32 v189, v189, v120, v121
    v_max3_f32 v189, v189, v122, v123
    v_max3_f32 v189, v189, v124, v125
    v_max3_f32 v189, v189, v126, v127
    v_mfma_f32_16x16x32_bf16 v[112:115], v[16:19], a[176:179], 0
    v_mfma_f32_16x16x32_bf16 v[120:123], v[16:19], a[184:187], 0
    v_mfma_f32_16x16x32_bf16 v[116:119], v[24:27], a[176:179], 0
    v_mfma_f32_16x16x32_bf16 v[124:127], v[24:27], a[184:187], 0
    v_mfma_f32_16x16x32_bf16 v[112:115], v[20:23], a[180:183], v[112:115]
    v_mfma_f32_16x16x32_bf16 v[120:123], v[20:23], a[188:191], v[120:123]
    v_mfma_f32_16x16x32_bf16 v[116:119], v[28:31], a[180:183], v[116:119]
    v_mfma_f32_16x16x32_bf16 v[124:127], v[28:31], a[188:191], v[124:127]
    s_lshl_b32 s14, s32, 13
    s_nop 3
    v_max3_f32 v190, v190, v112, v113
    v_max3_f32 v190, v190, v114, v115
    v_max3_f32 v190, v190, v116, v117
    v_max3_f32 v190, v190, v118, v119
    v_max3_f32 v191, v191, v120, v121
    v_max3_f32 v191, v191, v122, v123
    v_max3_f32 v191, v191, v124, v125
    v_max3_f32 v191, v191, v126, v127
    s_add_u32 s31, s29, s14
    s_add_u32 s32, s32, 1
    s_cmp_le_u32 s32, 31
    s_cbranch_scc1 standalone__conformer_family_zipformer__speech_kernel_mloop
    v_mov_b32 v192, v184
    s_nop 1
    v_permlane32_swap_b32 v184, v192
    v_max_f32 v184, v184, v192
    v_mov_b32 v192, v184
    s_nop 1
    v_permlane16_swap_b32 v184, v192
    v_max_f32 v184, v184, v192
    v_mov_b32 v192, v185
    s_nop 1
    v_permlane32_swap_b32 v185, v192
    v_max_f32 v185, v185, v192
    v_mov_b32 v192, v185
    s_nop 1
    v_permlane16_swap_b32 v185, v192
    v_max_f32 v185, v185, v192
    v_mov_b32 v192, v186
    s_nop 1
    v_permlane32_swap_b32 v186, v192
    v_max_f32 v186, v186, v192
    v_mov_b32 v192, v186
    s_nop 1
    v_permlane16_swap_b32 v186, v192
    v_max_f32 v186, v186, v192
    v_mov_b32 v192, v187
    s_nop 1
    v_permlane32_swap_b32 v187, v192
    v_max_f32 v187, v187, v192
    v_mov_b32 v192, v187
    s_nop 1
    v_permlane16_swap_b32 v187, v192
    v_max_f32 v187, v187, v192
    v_mov_b32 v192, v188
    s_nop 1
    v_permlane32_swap_b32 v188, v192
    v_max_f32 v188, v188, v192
    v_mov_b32 v192, v188
    s_nop 1
    v_permlane16_swap_b32 v188, v192
    v_max_f32 v188, v188, v192
    v_mov_b32 v192, v189
    s_nop 1
    v_permlane32_swap_b32 v189, v192
    v_max_f32 v189, v189, v192
    v_mov_b32 v192, v189
    s_nop 1
    v_permlane16_swap_b32 v189, v192
    v_max_f32 v189, v189, v192
    v_mov_b32 v192, v190
    s_nop 1
    v_permlane32_swap_b32 v190, v192
    v_max_f32 v190, v190, v192
    v_mov_b32 v192, v190
    s_nop 1
    v_permlane16_swap_b32 v190, v192
    v_max_f32 v190, v190, v192
    v_mov_b32 v192, v191
    s_nop 1
    v_permlane32_swap_b32 v191, v192
    v_max_f32 v191, v191, v192
    v_mov_b32 v192, v191
    s_nop 1
    v_permlane16_swap_b32 v191, v192
    v_max_f32 v191, v191, v192
    s_add_u32 s14, s3, 0
    s_and_b32 s14, s14, 3
    s_lshl_b32 s14, s14, 11
    v_add_u32 v194, s14, v2
    s_lshl_b32 s14, s3, 2
    v_add_u32 v193, s14, v194
    ds_write_b32 v193, v184 offset:0
    ds_write_b32 v193, v185 offset:1024
    s_add_u32 s14, s3, 1
    s_and_b32 s14, s14, 3
    s_lshl_b32 s14, s14, 11
    v_add_u32 v195, s14, v2
    s_lshl_b32 s14, s3, 2
    v_add_u32 v193, s14, v195
    ds_write_b32 v193, v186 offset:0
    ds_write_b32 v193, v187 offset:1024
    s_add_u32 s14, s3, 2
    s_and_b32 s14, s14, 3
    s_lshl_b32 s14, s14, 11
    v_add_u32 v196, s14, v2
    s_lshl_b32 s14, s3, 2
    v_add_u32 v193, s14, v196
    ds_write_b32 v193, v188 offset:0
    ds_write_b32 v193, v189 offset:1024
    s_add_u32 s14, s3, 3
    s_and_b32 s14, s14, 3
    s_lshl_b32 s14, s14, 11
    v_add_u32 v197, s14, v2
    s_lshl_b32 s14, s3, 2
    v_add_u32 v193, s14, v197
    ds_write_b32 v193, v190 offset:0
    ds_write_b32 v193, v191 offset:1024
    s_waitcnt lgkmcnt(0)
    s_barrier
    ds_read_b128 v[80:83], v194 offset:0
    s_waitcnt lgkmcnt(0)
    v_max3_f32 v80, v80, v81, v82
    v_max_f32 v80, v80, v83
    v_sub_f32 v80, 0, v80
    v_mov_b32 v81, v80
    v_mov_b32 v82, v80
    v_mov_b32 v83, v80
    v_mov_b32 v184, v80
    ds_read_b128 v[84:87], v194 offset:1024
    s_waitcnt lgkmcnt(0)
    v_max3_f32 v84, v84, v85, v86
    v_max_f32 v84, v84, v87
    v_sub_f32 v84, 0, v84
    v_mov_b32 v85, v84
    v_mov_b32 v86, v84
    v_mov_b32 v87, v84
    v_mov_b32 v185, v84
    ds_read_b128 v[88:91], v195 offset:0
    s_waitcnt lgkmcnt(0)
    v_max3_f32 v88, v88, v89, v90
    v_max_f32 v88, v88, v91
    v_sub_f32 v88, 0, v88
    v_mov_b32 v89, v88
    v_mov_b32 v90, v88
    v_mov_b32 v91, v88
    v_mov_b32 v186, v88
    ds_read_b128 v[92:95], v195 offset:1024
    s_waitcnt lgkmcnt(0)
    v_max3_f32 v92, v92, v93, v94
    v_max_f32 v92, v92, v95
    v_sub_f32 v92, 0, v92
    v_mov_b32 v93, v92
    v_mov_b32 v94, v92
    v_mov_b32 v95, v92
    v_mov_b32 v187, v92
    ds_read_b128 v[96:99], v196 offset:0
    s_waitcnt lgkmcnt(0)
    v_max3_f32 v96, v96, v97, v98
    v_max_f32 v96, v96, v99
    v_sub_f32 v96, 0, v96
    v_mov_b32 v97, v96
    v_mov_b32 v98, v96
    v_mov_b32 v99, v96
    v_mov_b32 v188, v96
    ds_read_b128 v[100:103], v196 offset:1024
    s_waitcnt lgkmcnt(0)
    v_max3_f32 v100, v100, v101, v102
    v_max_f32 v100, v100, v103
    v_sub_f32 v100, 0, v100
    v_mov_b32 v101, v100
    v_mov_b32 v102, v100
    v_mov_b32 v103, v100
    v_mov_b32 v189, v100
    ds_read_b128 v[104:107], v197 offset:0
    s_waitcnt lgkmcnt(0)
    v_max3_f32 v104, v104, v105, v106
    v_max_f32 v104, v104, v107
    v_sub_f32 v104, 0, v104
    v_mov_b32 v105, v104
    v_mov_b32 v106, v104
    v_mov_b32 v107, v104
    v_mov_b32 v190, v104
    ds_read_b128 v[108:111], v197 offset:1024
    s_waitcnt lgkmcnt(0)
    v_max3_f32 v108, v108, v109, v110
    v_max_f32 v108, v108, v111
    v_sub_f32 v108, 0, v108
    v_mov_b32 v109, v108
    v_mov_b32 v110, v108
    v_mov_b32 v111, v108
    v_mov_b32 v191, v108
    s_mov_b32 s37, 1
    s_mov_b32 s31, s34
    buffer_load_dwordx4 v[16:19], v2, s[8:11], s31 offen offset:0
    buffer_load_dwordx4 v[20:23], v2, s[8:11], s31 offen offset:1024
    buffer_load_dwordx4 v[24:27], v2, s[8:11], s31 offen offset:2048
    buffer_load_dwordx4 v[28:31], v2, s[8:11], s31 offen offset:3072
    buffer_load_dwordx4 v[32:35], v13, s[8:11], s31 offen offset:0
    buffer_load_dwordx4 v[36:39], v13, s[8:11], s31 offen offset:1024
    buffer_load_dwordx4 v[40:43], v13, s[8:11], s31 offen offset:2048
    buffer_load_dwordx4 v[44:47], v13, s[8:11], s31 offen offset:3072
    v_accvgpr_write_b32 a0, 0
    v_accvgpr_write_b32 a1, 0
    v_accvgpr_write_b32 a2, 0
    v_accvgpr_write_b32 a3, 0
    v_accvgpr_write_b32 a4, 0
    v_accvgpr_write_b32 a5, 0
    v_accvgpr_write_b32 a6, 0
    v_accvgpr_write_b32 a7, 0
    v_accvgpr_write_b32 a8, 0
    v_accvgpr_write_b32 a9, 0
    v_accvgpr_write_b32 a10, 0
    v_accvgpr_write_b32 a11, 0
    v_accvgpr_write_b32 a12, 0
    v_accvgpr_write_b32 a13, 0
    v_accvgpr_write_b32 a14, 0
    v_accvgpr_write_b32 a15, 0
    v_accvgpr_write_b32 a16, 0
    v_accvgpr_write_b32 a17, 0
    v_accvgpr_write_b32 a18, 0
    v_accvgpr_write_b32 a19, 0
    v_accvgpr_write_b32 a20, 0
    v_accvgpr_write_b32 a21, 0
    v_accvgpr_write_b32 a22, 0
    v_accvgpr_write_b32 a23, 0
    v_accvgpr_write_b32 a24, 0
    v_accvgpr_write_b32 a25, 0
    v_accvgpr_write_b32 a26, 0
    v_accvgpr_write_b32 a27, 0
    v_accvgpr_write_b32 a28, 0
    v_accvgpr_write_b32 a29, 0
    v_accvgpr_write_b32 a30, 0
    v_accvgpr_write_b32 a31, 0
    v_accvgpr_write_b32 a32, 0
    v_accvgpr_write_b32 a33, 0
    v_accvgpr_write_b32 a34, 0
    v_accvgpr_write_b32 a35, 0
    v_accvgpr_write_b32 a36, 0
    v_accvgpr_write_b32 a37, 0
    v_accvgpr_write_b32 a38, 0
    v_accvgpr_write_b32 a39, 0
    v_accvgpr_write_b32 a40, 0
    v_accvgpr_write_b32 a41, 0
    v_accvgpr_write_b32 a42, 0
    v_accvgpr_write_b32 a43, 0
    v_accvgpr_write_b32 a44, 0
    v_accvgpr_write_b32 a45, 0
    v_accvgpr_write_b32 a46, 0
    v_accvgpr_write_b32 a47, 0
    v_accvgpr_write_b32 a48, 0
    v_accvgpr_write_b32 a49, 0
    v_accvgpr_write_b32 a50, 0
    v_accvgpr_write_b32 a51, 0
    v_accvgpr_write_b32 a52, 0
    v_accvgpr_write_b32 a53, 0
    v_accvgpr_write_b32 a54, 0
    v_accvgpr_write_b32 a55, 0
    v_accvgpr_write_b32 a56, 0
    v_accvgpr_write_b32 a57, 0
    v_accvgpr_write_b32 a58, 0
    v_accvgpr_write_b32 a59, 0
    v_accvgpr_write_b32 a60, 0
    v_accvgpr_write_b32 a61, 0
    v_accvgpr_write_b32 a62, 0
    v_accvgpr_write_b32 a63, 0
    v_accvgpr_write_b32 a64, 0
    v_accvgpr_write_b32 a65, 0
    v_accvgpr_write_b32 a66, 0
    v_accvgpr_write_b32 a67, 0
    v_accvgpr_write_b32 a68, 0
    v_accvgpr_write_b32 a69, 0
    v_accvgpr_write_b32 a70, 0
    v_accvgpr_write_b32 a71, 0
    v_accvgpr_write_b32 a72, 0
    v_accvgpr_write_b32 a73, 0
    v_accvgpr_write_b32 a74, 0
    v_accvgpr_write_b32 a75, 0
    v_accvgpr_write_b32 a76, 0
    v_accvgpr_write_b32 a77, 0
    v_accvgpr_write_b32 a78, 0
    v_accvgpr_write_b32 a79, 0
    v_accvgpr_write_b32 a80, 0
    v_accvgpr_write_b32 a81, 0
    v_accvgpr_write_b32 a82, 0
    v_accvgpr_write_b32 a83, 0
    v_accvgpr_write_b32 a84, 0
    v_accvgpr_write_b32 a85, 0
    v_accvgpr_write_b32 a86, 0
    v_accvgpr_write_b32 a87, 0
    v_accvgpr_write_b32 a88, 0
    v_accvgpr_write_b32 a89, 0
    v_accvgpr_write_b32 a90, 0
    v_accvgpr_write_b32 a91, 0
    v_accvgpr_write_b32 a92, 0
    v_accvgpr_write_b32 a93, 0
    v_accvgpr_write_b32 a94, 0
    v_accvgpr_write_b32 a95, 0
    v_accvgpr_write_b32 a96, 0
    v_accvgpr_write_b32 a97, 0
    v_accvgpr_write_b32 a98, 0
    v_accvgpr_write_b32 a99, 0
    v_accvgpr_write_b32 a100, 0
    v_accvgpr_write_b32 a101, 0
    v_accvgpr_write_b32 a102, 0
    v_accvgpr_write_b32 a103, 0
    v_accvgpr_write_b32 a104, 0
    v_accvgpr_write_b32 a105, 0
    v_accvgpr_write_b32 a106, 0
    v_accvgpr_write_b32 a107, 0
    v_accvgpr_write_b32 a108, 0
    v_accvgpr_write_b32 a109, 0
    v_accvgpr_write_b32 a110, 0
    v_accvgpr_write_b32 a111, 0
    v_accvgpr_write_b32 a112, 0
    v_accvgpr_write_b32 a113, 0
    v_accvgpr_write_b32 a114, 0
    v_accvgpr_write_b32 a115, 0
    v_accvgpr_write_b32 a116, 0
    v_accvgpr_write_b32 a117, 0
    v_accvgpr_write_b32 a118, 0
    v_accvgpr_write_b32 a119, 0
    v_accvgpr_write_b32 a120, 0
    v_accvgpr_write_b32 a121, 0
    v_accvgpr_write_b32 a122, 0
    v_accvgpr_write_b32 a123, 0
    v_accvgpr_write_b32 a124, 0
    v_accvgpr_write_b32 a125, 0
    v_accvgpr_write_b32 a126, 0
    v_accvgpr_write_b32 a127, 0
    v_accvgpr_write_b32 a192, 0
    v_accvgpr_write_b32 a193, 0
    v_accvgpr_write_b32 a194, 0
    v_accvgpr_write_b32 a195, 0
    v_accvgpr_write_b32 a196, 0
    v_accvgpr_write_b32 a197, 0
    v_accvgpr_write_b32 a198, 0
    v_accvgpr_write_b32 a199, 0
    v_accvgpr_write_b32 a200, 0
    v_accvgpr_write_b32 a201, 0
    v_accvgpr_write_b32 a202, 0
    v_accvgpr_write_b32 a203, 0
    v_accvgpr_write_b32 a204, 0
    v_accvgpr_write_b32 a205, 0
    v_accvgpr_write_b32 a206, 0
    v_accvgpr_write_b32 a207, 0
    s_waitcnt vmcnt(0) lgkmcnt(0)
    s_nop 7
    s_nop 7
    s_barrier
    s_branch standalone__conformer_family_zipformer__speech_kernel_main
standalone__conformer_family_zipformer__speech_kernel_swz:
    s_waitcnt vmcnt(0) lgkmcnt(0)
    s_nop 7
    s_nop 7
    s_load_dwordx8 s[72:79], s[0:1], 32
    s_load_dwordx4 s[8:11], s[0:1], 64
    s_sub_u32 s4, s66, 250
    s_lshl_b32 s4, s4, 2
    s_add_u32 s4, s4, s3
    s_lshr_b32 s5, s4, 1
    s_and_b32 s6, s4, 1
    s_waitcnt lgkmcnt(0)
    s_mov_b32 s24, s54
    s_and_b32 s25, s55, 0xffff
    s_mov_b32 s26, 0x10000000
    s_mov_b32 s27, 0x20000
    s_mov_b32 s40, s52
    s_and_b32 s41, s53, 0xffff
    s_mov_b32 s42, 0x100
    s_mov_b32 s43, 0x20000
    s_lshl_b32 s87, s4, 7
    s_add_u32 s87, s87, 28442624
    s_lshl_b32 s80, s2, 2
    s_add_u32 s80, s80, s3
    s_lshl_b32 s80, s80, 7
    s_xor_b32 s81, s80, 4096
    s_add_u32 s80, s80, 26214400
    s_add_u32 s81, s81, 26214400
    s_getreg_b32 s82, hwreg(HW_REG_XCC_ID, 0, 4)
    s_or_b32 s82, s82, 0x80
    v_mov_b32 v243, 0
    buffer_store_dword v243, v243, s[24:27], s87 offen sc1
    buffer_store_dword v243, v243, s[24:27], s94 offen sc1
    s_waitcnt vmcnt(0)
    s_barrier
    s_cmp_lg_u32 s3, 0
    s_cbranch_scc1 standalone__conformer_family_zipformer__speech_kernel_ann051
    s_and_b32 s84, s2, 3
    s_lshl_b32 s84, s84, 3
    s_lshl_b32 s84, s82, s84
    v_mov_b32 v244, s84
    s_and_b32 s85, s2, 0xfc
    s_mov_b64 exec, 1
    buffer_atomic_or v244, v243, s[40:43], s85 offen sc1
    s_mov_b64 exec, -1
standalone__conformer_family_zipformer__speech_kernel_ann051:
    s_sub_u32 s7, s5, 8
    s_lshl_b32 s7, s7, 17
    s_mov_b32 s12, s10
    s_mov_b32 s13, s11
    s_mov_b32 s14, 0x80000
    s_mov_b32 s16, 512
    s_cmp_ge_u32 s5, 8
    s_cbranch_scc1 standalone__conformer_family_zipformer__speech_kernel_swz_go
    s_sub_u32 s7, s5, 4
    s_lshl_b32 s7, s7, 9
    s_mov_b32 s12, s8
    s_mov_b32 s13, s9
    s_mov_b32 s16, 2048
    s_cmp_ge_u32 s5, 4
    s_cbranch_scc1 standalone__conformer_family_zipformer__speech_kernel_swz_go
    s_mov_b32 s7, 0
    s_mov_b32 s12, s78
    s_mov_b32 s13, s79
    s_mov_b32 s14, 0x20000
    s_mov_b32 s16, 512
    s_cmp_eq_u32 s5, 3
    s_cbranch_scc1 standalone__conformer_family_zipformer__speech_kernel_swz_go
    s_mov_b32 s12, s72
    s_mov_b32 s13, s73
    s_cmp_eq_u32 s5, 0
    s_cbranch_scc1 standalone__conformer_family_zipformer__speech_kernel_swz_go
    s_mov_b32 s12, s74
    s_mov_b32 s13, s75
    s_mov_b32 s14, 0x40000
    s_mov_b32 s16, 1024
    s_sub_u32 s7, 2, s5
    s_lshl_b32 s7, s7, 9
standalone__conformer_family_zipformer__speech_kernel_swz_go:
    s_and_b32 s13, s13, 0xffff
    s_mov_b32 s15, 0x20000
    s_lshl_b32 s17, s6, 8
    s_add_u32 s7, s7, s17
    s_lshl_b32 s17, s4, 16
    s_add_u32 s17, s17, 23068672
    s_mov_b32 s20, 8192
    s_mov_b32 s21, 4096
    s_mov_b32 s22, 2048
    s_sub_u32 s23, s5, 4
    s_cmp_lt_u32 s23, 4
    s_cselect_b32 s20, 4096, s20
    s_cselect_b32 s21, 2048, s21
    s_cselect_b32 s22, 16384, s22
    s_sub_u32 s23, s5, 1
    s_cmp_lt_u32 s23, 2
    s_cselect_b32 s22, 131072, s22
    s_cmp_eq_u32 s5, 2
    s_cselect_b32 s23, 129024, 0
    s_sub_u32 s17, s17, s23
    s_lshl_b32 s18, s16, 5
    v_lshrrev_b32 v2, 3, v1
    v_lshrrev_b32 v3, 4, v1
    v_lshlrev_b32 v3, 1, v3
    v_and_b32 v4, 7, v1
    v_xor_b32 v4, v4, v3
    v_lshlrev_b32 v4, 4, v4
    v_mul_u32_u24 v10, s16, v2
    v_add_u32 v10, v10, v4
    s_lshl_b32 s29, s16, 3
    s_sub_u32 s29, s29, 1024
    v_add_u32 v11, s29, v10
    v_add_u32 v12, s29, v11
    v_add_u32 v13, s29, v12
    s_mul_i32 s28, s3, 24576
    v_lshrrev_b32 v2, 2, v1
    v_lshrrev_b32 v3, 1, v2
    v_and_b32 v3, 3, v3
    v_and_b32 v4, 3, v1
    v_lshlrev_b32 v4, 3, v4
    v_lshlrev_b32 v5, 7, v2
    v_add_u32 v5, v5, v4
    v_add_u32 v5, s28, v5
    v_xor_b32 v6, 0, v3
    v_lshlrev_b32 v6, 5, v6
    v_add_u32 v22, v5, v6
    v_xor_b32 v6, 1, v3
    v_lshlrev_b32 v6, 5, v6
    v_add_u32 v23, v5, v6
    v_xor_b32 v6, 2, v3
    v_lshlrev_b32 v6, 5, v6
    v_add_u32 v24, v5, v6
    v_xor_b32 v6, 3, v3
    v_lshlrev_b32 v6, 5, v6
    v_add_u32 v25, v5, v6
    s_add_u32 m0, s28, 0
    s_mul_i32 s29, s18, 0
    s_add_u32 s29, s29, s7
    buffer_load_dwordx4 v10, s[12:15], s29 offen offset:0 lds
    buffer_load_dwordx4 v11, s[12:15], s29 offen offset:1024 lds
    buffer_load_dwordx4 v12, s[12:15], s29 offen offset:2048 lds
    buffer_load_dwordx4 v13, s[12:15], s29 offen offset:3072 lds
    s_add_u32 m0, s28, 4096
    s_mul_i32 s29, s18, 1
    s_add_u32 s29, s29, s7
    buffer_load_dwordx4 v10, s[12:15], s29 offen offset:0 lds
    buffer_load_dwordx4 v11, s[12:15], s29 offen offset:1024 lds
    buffer_load_dwordx4 v12, s[12:15], s29 offen offset:2048 lds
    buffer_load_dwordx4 v13, s[12:15], s29 offen offset:3072 lds
    s_add_u32 m0, s28, 8192
    s_mul_i32 s29, s18, 2
    s_add_u32 s29, s29, s7
    buffer_load_dwordx4 v10, s[12:15], s29 offen offset:0 lds
    buffer_load_dwordx4 v11, s[12:15], s29 offen offset:1024 lds
    buffer_load_dwordx4 v12, s[12:15], s29 offen offset:2048 lds
    buffer_load_dwordx4 v13, s[12:15], s29 offen offset:3072 lds
    s_add_u32 m0, s28, 12288
    s_mul_i32 s29, s18, 3
    s_add_u32 s29, s29, s7
    buffer_load_dwordx4 v10, s[12:15], s29 offen offset:0 lds
    buffer_load_dwordx4 v11, s[12:15], s29 offen offset:1024 lds
    buffer_load_dwordx4 v12, s[12:15], s29 offen offset:2048 lds
    buffer_load_dwordx4 v13, s[12:15], s29 offen offset:3072 lds
    s_add_u32 m0, s28, 16384
    s_mul_i32 s29, s18, 4
    s_add_u32 s29, s29, s7
    buffer_load_dwordx4 v10, s[12:15], s29 offen offset:0 lds
    buffer_load_dwordx4 v11, s[12:15], s29 offen offset:1024 lds
    buffer_load_dwordx4 v12, s[12:15], s29 offen offset:2048 lds
    buffer_load_dwordx4 v13, s[12:15], s29 offen offset:3072 lds
    s_add_u32 m0, s28, 20480
    s_mul_i32 s29, s18, 5
    s_add_u32 s29, s29, s7
    buffer_load_dwordx4 v10, s[12:15], s29 offen offset:0 lds
    buffer_load_dwordx4 v11, s[12:15], s29 offen offset:1024 lds
    buffer_load_dwordx4 v12, s[12:15], s29 offen offset:2048 lds
    buffer_load_dwordx4 v13, s[12:15], s29 offen offset:3072 lds
    s_waitcnt vmcnt(20)
    ds_read_b64_tr_b16 v[32:33], v22 offset:0
    ds_read_b64_tr_b16 v[34:35], v22 offset:2048
    ds_read_b64_tr_b16 v[36:37], v23 offset:0
    ds_read_b64_tr_b16 v[38:39], v23 offset:2048
    ds_read_b64_tr_b16 v[40:41], v24 offset:0
    ds_read_b64_tr_b16 v[42:43], v24 offset:2048
    ds_read_b64_tr_b16 v[44:45], v25 offset:0
    ds_read_b64_tr_b16 v[46:47], v25 offset:2048
    s_add_u32 m0, s28, 0
    s_mul_i32 s29, s18, 6
    s_add_u32 s29, s29, s7
    s_waitcnt lgkmcnt(0)
    buffer_load_dwordx4 v10, s[12:15], s29 offen offset:0 lds
    buffer_load_dwordx4 v11, s[12:15], s29 offen offset:1024 lds
    buffer_load_dwordx4 v12, s[12:15], s29 offen offset:2048 lds
    buffer_load_dwordx4 v13, s[12:15], s29 offen offset:3072 lds
    s_waitcnt vmcnt(20)
    ds_read_b64_tr_b16 v[48:49], v22 offset:4096
    ds_read_b64_tr_b16 v[50:51], v22 offset:6144
    ds_read_b64_tr_b16 v[52:53], v23 offset:4096
    ds_read_b64_tr_b16 v[54:55], v23 offset:6144
    ds_read_b64_tr_b16 v[56:57], v24 offset:4096
    ds_read_b64_tr_b16 v[58:59], v24 offset:6144
    ds_read_b64_tr_b16 v[60:61], v25 offset:4096
    ds_read_b64_tr_b16 v[62:63], v25 offset:6144
    s_add_u32 m0, s28, 4096
    s_mul_i32 s29, s18, 7
    s_add_u32 s29, s29, s7
    s_waitcnt lgkmcnt(0)
    buffer_load_dwordx4 v10, s[12:15], s29 offen offset:0 lds
    buffer_load_dwordx4 v11, s[12:15], s29 offen offset:1024 lds
    buffer_load_dwordx4 v12, s[12:15], s29 offen offset:2048 lds
    buffer_load_dwordx4 v13, s[12:15], s29 offen offset:3072 lds
    s_waitcnt vmcnt(20)
    ds_read_b64_tr_b16 v[64:65], v22 offset:8192
    ds_read_b64_tr_b16 v[66:67], v22 offset:10240
    ds_read_b64_tr_b16 v[68:69], v23 offset:8192
    ds_read_b64_tr_b16 v[70:71], v23 offset:10240
    ds_read_b64_tr_b16 v[72:73], v24 offset:8192
    ds_read_b64_tr_b16 v[74:75], v24 offset:10240
    ds_read_b64_tr_b16 v[76:77], v25 offset:8192
    ds_read_b64_tr_b16 v[78:79], v25 offset:10240
    s_add_u32 m0, s28, 8192
    s_mul_i32 s29, s18, 0
    s_add_u32 s29, s29, s7
    s_add_u32 s29, s29, 128
    s_waitcnt lgkmcnt(0)
    buffer_load_dwordx4 v10, s[12:15], s29 offen offset:0 lds
    buffer_load_dwordx4 v11, s[12:15], s29 offen offset:1024 lds
    buffer_load_dwordx4 v12, s[12:15], s29 offen offset:2048 lds
    buffer_load_dwordx4 v13, s[12:15], s29 offen offset:3072 lds
    s_waitcnt vmcnt(20)
    ds_read_b64_tr_b16 v[80:81], v22 offset:12288
    ds_read_b64_tr_b16 v[82:83], v22 offset:14336
    ds_read_b64_tr_b16 v[84:85], v23 offset:12288
    ds_read_b64_tr_b16 v[86:87], v23 offset:14336
    ds_read_b64_tr_b16 v[88:89], v24 offset:12288
    ds_read_b64_tr_b16 v[90:91], v24 offset:14336
    ds_read_b64_tr_b16 v[92:93], v25 offset:12288
    ds_read_b64_tr_b16 v[94:95], v25 offset:14336
    s_add_u32 m0, s28, 12288
    s_mul_i32 s29, s18, 1
    s_add_u32 s29, s29, s7
    s_add_u32 s29, s29, 128
    s_waitcnt lgkmcnt(0)
    buffer_load_dwordx4 v10, s[12:15], s29 offen offset:0 lds
    buffer_load_dwordx4 v11, s[12:15], s29 offen offset:1024 lds
    buffer_load_dwordx4 v12, s[12:15], s29 offen offset:2048 lds
    buffer_load_dwordx4 v13, s[12:15], s29 offen offset:3072 lds
    s_waitcnt vmcnt(20)
    ds_read_b64_tr_b16 v[96:97], v22 offset:16384
    ds_read_b64_tr_b16 v[98:99], v22 offset:18432
    ds_read_b64_tr_b16 v[100:101], v23 offset:16384
    ds_read_b64_tr_b16 v[102:103], v23 offset:18432
    ds_read_b64_tr_b16 v[104:105], v24 offset:16384
    ds_read_b64_tr_b16 v[106:107], v24 offset:18432
    ds_read_b64_tr_b16 v[108:109], v25 offset:16384
    ds_read_b64_tr_b16 v[110:111], v25 offset:18432
    s_add_u32 m0, s28, 16384
    s_mul_i32 s29, s18, 2
    s_add_u32 s29, s29, s7
    s_add_u32 s29, s29, 128
    s_waitcnt lgkmcnt(0)
    buffer_load_dwordx4 v10, s[12:15], s29 offen offset:0 lds
    buffer_load_dwordx4 v11, s[12:15], s29 offen offset:1024 lds
    buffer_load_dwordx4 v12, s[12:15], s29 offen offset:2048 lds
    buffer_load_dwordx4 v13, s[12:15], s29 offen offset:3072 lds
    s_waitcnt vmcnt(20)
    ds_read_b64_tr_b16 v[112:113], v22 offset:20480
    ds_read_b64_tr_b16 v[114:115], v22 offset:22528
    ds_read_b64_tr_b16 v[116:117], v23 offset:20480
    ds_read_b64_tr_b16 v[118:119], v23 offset:22528
    ds_read_b64_tr_b16 v[120:121], v24 offset:20480
    ds_read_b64_tr_b16 v[122:123], v24 offset:22528
    ds_read_b64_tr_b16 v[124:125], v25 offset:20480
    ds_read_b64_tr_b16 v[126:127], v25 offset:22528
    s_add_u32 m0, s28, 20480
    s_mul_i32 s29, s18, 3
    s_add_u32 s29, s29, s7
    s_add_u32 s29, s29, 128
    s_waitcnt lgkmcnt(0)
    buffer_load_dwordx4 v10, s[12:15], s29 offen offset:0 lds
    buffer_load_dwordx4 v11, s[12:15], s29 offen offset:1024 lds
    buffer_load_dwordx4 v12, s[12:15], s29 offen offset:2048 lds
    buffer_load_dwordx4 v13, s[12:15], s29 offen offset:3072 lds
    s_waitcnt vmcnt(20)
    ds_read_b64_tr_b16 v[128:129], v22 offset:0
    ds_read_b64_tr_b16 v[130:131], v22 offset:2048
    ds_read_b64_tr_b16 v[132:133], v23 offset:0
    ds_read_b64_tr_b16 v[134:135], v23 offset:2048
    ds_read_b64_tr_b16 v[136:137], v24 offset:0
    ds_read_b64_tr_b16 v[138:139], v24 offset:2048
    ds_read_b64_tr_b16 v[140:141], v25 offset:0
    ds_read_b64_tr_b16 v[142:143], v25 offset:2048
    s_add_u32 m0, s28, 0
    s_mul_i32 s29, s18, 4
    s_add_u32 s29, s29, s7
    s_add_u32 s29, s29, 128
    s_waitcnt lgkmcnt(0)
    buffer_load_dwordx4 v10, s[12:15], s29 offen offset:0 lds
    buffer_load_dwordx4 v11, s[12:15], s29 offen offset:1024 lds
    buffer_load_dwordx4 v12, s[12:15], s29 offen offset:2048 lds
    buffer_load_dwordx4 v13, s[12:15], s29 offen offset:3072 lds
    s_waitcnt vmcnt(20)
    ds_read_b64_tr_b16 v[144:145], v22 offset:4096
    ds_read_b64_tr_b16 v[146:147], v22 offset:6144
    ds_read_b64_tr_b16 v[148:149], v23 offset:4096
    ds_read_b64_tr_b16 v[150:151], v23 offset:6144
    ds_read_b64_tr_b16 v[152:153], v24 offset:4096
    ds_read_b64_tr_b16 v[154:155], v24 offset:6144
    ds_read_b64_tr_b16 v[156:157], v25 offset:4096
    ds_read_b64_tr_b16 v[158:159], v25 offset:6144
    s_add_u32 m0, s28, 4096
    s_mul_i32 s29, s18, 5
    s_add_u32 s29, s29, s7
    s_add_u32 s29, s29, 128
    s_waitcnt lgkmcnt(0)
    buffer_load_dwordx4 v10, s[12:15], s29 offen offset:0 lds
    buffer_load_dwordx4 v11, s[12:15], s29 offen offset:1024 lds
    buffer_load_dwordx4 v12, s[12:15], s29 offen offset:2048 lds
    buffer_load_dwordx4 v13, s[12:15], s29 offen offset:3072 lds
    s_waitcnt vmcnt(20)
    ds_read_b64_tr_b16 v[160:161], v22 offset:8192
    ds_read_b64_tr_b16 v[162:163], v22 offset:10240
    ds_read_b64_tr_b16 v[164:165], v23 offset:8192
    ds_read_b64_tr_b16 v[166:167], v23 offset:10240
    ds_read_b64_tr_b16 v[168:169], v24 offset:8192
    ds_read_b64_tr_b16 v[170:171], v24 offset:10240
    ds_read_b64_tr_b16 v[172:173], v25 offset:8192
    ds_read_b64_tr_b16 v[174:175], v25 offset:10240
    s_add_u32 m0, s28, 8192
    s_mul_i32 s29, s18, 6
    s_add_u32 s29, s29, s7
    s_add_u32 s29, s29, 128
    s_waitcnt lgkmcnt(0)
    buffer_load_dwordx4 v10, s[12:15], s29 offen offset:0 lds
    buffer_load_dwordx4 v11, s[12:15], s29 offen offset:1024 lds
    buffer_load_dwordx4 v12, s[12:15], s29 offen offset:2048 lds
    buffer_load_dwordx4 v13, s[12:15], s29 offen offset:3072 lds
    s_waitcnt vmcnt(20)
    ds_read_b64_tr_b16 v[176:177], v22 offset:12288
    ds_read_b64_tr_b16 v[178:179], v22 offset:14336
    ds_read_b64_tr_b16 v[180:181], v23 offset:12288
    ds_read_b64_tr_b16 v[182:183], v23 offset:14336
    ds_read_b64_tr_b16 v[184:185], v24 offset:12288
    ds_read_b64_tr_b16 v[186:187], v24 offset:14336
    ds_read_b64_tr_b16 v[188:189], v25 offset:12288
    ds_read_b64_tr_b16 v[190:191], v25 offset:14336
    s_add_u32 m0, s28, 12288
    s_mul_i32 s29, s18, 7
    s_add_u32 s29, s29, s7
    s_add_u32 s29, s29, 128
    s_waitcnt lgkmcnt(0)
    buffer_load_dwordx4 v10, s[12:15], s29 offen offset:0 lds
    buffer_load_dwordx4 v11, s[12:15], s29 offen offset:1024 lds
    buffer_load_dwordx4 v12, s[12:15], s29 offen offset:2048 lds
    buffer_load_dwordx4 v13, s[12:15], s29 offen offset:3072 lds
    s_mul_i32 s19, s20, 0
    s_add_u32 s19, s19, s17
    s_add_u32 s23, s19, s22
    buffer_store_dwordx4 v[32:35], v30, s[24:27], s19 offen offset:0 sc1
    buffer_store_dwordx4 v[36:39], v30, s[24:27], s19 offen offset:1024 sc1
    buffer_store_dwordx4 v[40:43], v30, s[24:27], s23 offen offset:0 sc1
    buffer_store_dwordx4 v[44:47], v30, s[24:27], s23 offen offset:1024 sc1
    s_mul_i32 s19, s20, 0
    s_add_u32 s19, s19, s17
    s_add_u32 s19, s19, s21
    s_add_u32 s23, s19, s22
    buffer_store_dwordx4 v[48:51], v30, s[24:27], s19 offen offset:0 sc1
    buffer_store_dwordx4 v[52:55], v30, s[24:27], s19 offen offset:1024 sc1
    buffer_store_dwordx4 v[56:59], v30, s[24:27], s23 offen offset:0 sc1
    buffer_store_dwordx4 v[60:63], v30, s[24:27], s23 offen offset:1024 sc1
    s_mul_i32 s19, s20, 1
    s_add_u32 s19, s19, s17
    s_add_u32 s23, s19, s22
    buffer_store_dwordx4 v[64:67], v30, s[24:27], s19 offen offset:0 sc1
    buffer_store_dwordx4 v[68:71], v30, s[24:27], s19 offen offset:1024 sc1
    buffer_store_dwordx4 v[72:75], v30, s[24:27], s23 offen offset:0 sc1
    buffer_store_dwordx4 v[76:79], v30, s[24:27], s23 offen offset:1024 sc1
    s_mul_i32 s19, s20, 1
    s_add_u32 s19, s19, s17
    s_add_u32 s19, s19, s21
    s_add_u32 s23, s19, s22
    buffer_store_dwordx4 v[80:83], v30, s[24:27], s19 offen offset:0 sc1
    buffer_store_dwordx4 v[84:87], v30, s[24:27], s19 offen offset:1024 sc1
    buffer_store_dwordx4 v[88:91], v30, s[24:27], s23 offen offset:0 sc1
    buffer_store_dwordx4 v[92:95], v30, s[24:27], s23 offen offset:1024 sc1
    s_mul_i32 s19, s20, 2
    s_add_u32 s19, s19, s17
    s_add_u32 s23, s19, s22
    buffer_store_dwordx4 v[96:99], v30, s[24:27], s19 offen offset:0 sc1
    buffer_store_dwordx4 v[100:103], v30, s[24:27], s19 offen offset:1024 sc1
    buffer_store_dwordx4 v[104:107], v30, s[24:27], s23 offen offset:0 sc1
    buffer_store_dwordx4 v[108:111], v30, s[24:27], s23 offen offset:1024 sc1
    s_mul_i32 s19, s20, 2
    s_add_u32 s19, s19, s17
    s_add_u32 s19, s19, s21
    s_add_u32 s23, s19, s22
    buffer_store_dwordx4 v[112:115], v30, s[24:27], s19 offen offset:0 sc1
    buffer_store_dwordx4 v[116:119], v30, s[24:27], s19 offen offset:1024 sc1
    buffer_store_dwordx4 v[120:123], v30, s[24:27], s23 offen offset:0 sc1
    buffer_store_dwordx4 v[124:127], v30, s[24:27], s23 offen offset:1024 sc1
    s_mul_i32 s19, s20, 3
    s_add_u32 s19, s19, s17
    s_add_u32 s23, s19, s22
    buffer_store_dwordx4 v[128:131], v30, s[24:27], s19 offen offset:0 sc1
    buffer_store_dwordx4 v[132:135], v30, s[24:27], s19 offen offset:1024 sc1
    buffer_store_dwordx4 v[136:139], v30, s[24:27], s23 offen offset:0 sc1
    buffer_store_dwordx4 v[140:143], v30, s[24:27], s23 offen offset:1024 sc1
    s_mul_i32 s19, s20, 3
    s_add_u32 s19, s19, s17
    s_add_u32 s19, s19, s21
    s_add_u32 s23, s19, s22
    buffer_store_dwordx4 v[144:147], v30, s[24:27], s19 offen offset:0 sc1
    buffer_store_dwordx4 v[148:151], v30, s[24:27], s19 offen offset:1024 sc1
    buffer_store_dwordx4 v[152:155], v30, s[24:27], s23 offen offset:0 sc1
    buffer_store_dwordx4 v[156:159], v30, s[24:27], s23 offen offset:1024 sc1
    s_mul_i32 s19, s20, 0
    s_add_u32 s19, s19, s17
    s_add_u32 s19, s19, 32768
    s_add_u32 s23, s19, s22
    buffer_store_dwordx4 v[160:163], v30, s[24:27], s19 offen offset:0 sc1
    buffer_store_dwordx4 v[164:167], v30, s[24:27], s19 offen offset:1024 sc1
    buffer_store_dwordx4 v[168:171], v30, s[24:27], s23 offen offset:0 sc1
    buffer_store_dwordx4 v[172:175], v30, s[24:27], s23 offen offset:1024 sc1
    s_mul_i32 s19, s20, 0
    s_add_u32 s19, s19, s17
    s_add_u32 s19, s19, s21
    s_add_u32 s19, s19, 32768
    s_add_u32 s23, s19, s22
    buffer_store_dwordx4 v[176:179], v30, s[24:27], s19 offen offset:0 sc1
    buffer_store_dwordx4 v[180:183], v30, s[24:27], s19 offen offset:1024 sc1
    buffer_store_dwordx4 v[184:187], v30, s[24:27], s23 offen offset:0 sc1
    buffer_store_dwordx4 v[188:191], v30, s[24:27], s23 offen offset:1024 sc1
    s_waitcnt vmcnt(60)
    ds_read_b64_tr_b16 v[192:193], v22 offset:16384
    ds_read_b64_tr_b16 v[194:195], v22 offset:18432
    ds_read_b64_tr_b16 v[196:197], v23 offset:16384
    ds_read_b64_tr_b16 v[198:199], v23 offset:18432
    ds_read_b64_tr_b16 v[200:201], v24 offset:16384
    ds_read_b64_tr_b16 v[202:203], v24 offset:18432
    ds_read_b64_tr_b16 v[204:205], v25 offset:16384
    ds_read_b64_tr_b16 v[206:207], v25 offset:18432
    s_mul_i32 s19, s20, 1
    s_add_u32 s19, s19, s17
    s_add_u32 s19, s19, 32768
    s_add_u32 s23, s19, s22
    s_waitcnt lgkmcnt(6)
    buffer_store_dwordx4 v[192:195], v30, s[24:27], s19 offen offset:0 sc1
    s_waitcnt lgkmcnt(4)
    buffer_store_dwordx4 v[196:199], v30, s[24:27], s19 offen offset:1024 sc1
    s_waitcnt lgkmcnt(2)
    buffer_store_dwordx4 v[200:203], v30, s[24:27], s23 offen offset:0 sc1
    s_waitcnt lgkmcnt(0)
    buffer_store_dwordx4 v[204:207], v30, s[24:27], s23 offen offset:1024 sc1
    s_waitcnt vmcnt(60)
    ds_read_b64_tr_b16 v[208:209], v22 offset:20480
    ds_read_b64_tr_b16 v[210:211], v22 offset:22528
    ds_read_b64_tr_b16 v[212:213], v23 offset:20480
    ds_read_b64_tr_b16 v[214:215], v23 offset:22528
    ds_read_b64_tr_b16 v[216:217], v24 offset:20480
    ds_read_b64_tr_b16 v[218:219], v24 offset:22528
    ds_read_b64_tr_b16 v[220:221], v25 offset:20480
    ds_read_b64_tr_b16 v[222:223], v25 offset:22528
    s_mul_i32 s19, s20, 1
    s_add_u32 s19, s19, s17
    s_add_u32 s19, s19, s21
    s_add_u32 s19, s19, 32768
    s_add_u32 s23, s19, s22
    s_waitcnt lgkmcnt(6)
    buffer_store_dwordx4 v[208:211], v30, s[24:27], s19 offen offset:0 sc1
    s_waitcnt lgkmcnt(4)
    buffer_store_dwordx4 v[212:215], v30, s[24:27], s19 offen offset:1024 sc1
    s_waitcnt lgkmcnt(2)
    buffer_store_dwordx4 v[216:219], v30, s[24:27], s23 offen offset:0 sc1
    s_waitcnt lgkmcnt(0)
    buffer_store_dwordx4 v[220:223], v30, s[24:27], s23 offen offset:1024 sc1
    s_waitcnt vmcnt(60)
    ds_read_b64_tr_b16 v[32:33], v22 offset:0
    ds_read_b64_tr_b16 v[34:35], v22 offset:2048
    ds_read_b64_tr_b16 v[36:37], v23 offset:0
    ds_read_b64_tr_b16 v[38:39], v23 offset:2048
    ds_read_b64_tr_b16 v[40:41], v24 offset:0
    ds_read_b64_tr_b16 v[42:43], v24 offset:2048
    ds_read_b64_tr_b16 v[44:45], v25 offset:0
    ds_read_b64_tr_b16 v[46:47], v25 offset:2048
    s_mul_i32 s19, s20, 2
    s_add_u32 s19, s19, s17
    s_add_u32 s19, s19, 32768
    s_add_u32 s23, s19, s22
    s_waitcnt lgkmcnt(6)
    buffer_store_dwordx4 v[32:35], v30, s[24:27], s19 offen offset:0 sc1
    s_waitcnt lgkmcnt(4)
    buffer_store_dwordx4 v[36:39], v30, s[24:27], s19 offen offset:1024 sc1
    s_waitcnt lgkmcnt(2)
    buffer_store_dwordx4 v[40:43], v30, s[24:27], s23 offen offset:0 sc1
    s_waitcnt lgkmcnt(0)
    buffer_store_dwordx4 v[44:47], v30, s[24:27], s23 offen offset:1024 sc1
    s_waitcnt vmcnt(60)
    ds_read_b64_tr_b16 v[48:49], v22 offset:4096
    ds_read_b64_tr_b16 v[50:51], v22 offset:6144
    ds_read_b64_tr_b16 v[52:53], v23 offset:4096
    ds_read_b64_tr_b16 v[54:55], v23 offset:6144
    ds_read_b64_tr_b16 v[56:57], v24 offset:4096
    ds_read_b64_tr_b16 v[58:59], v24 offset:6144
    ds_read_b64_tr_b16 v[60:61], v25 offset:4096
    ds_read_b64_tr_b16 v[62:63], v25 offset:6144
    s_mul_i32 s19, s20, 2
    s_add_u32 s19, s19, s17
    s_add_u32 s19, s19, s21
    s_add_u32 s19, s19, 32768
    s_add_u32 s23, s19, s22
    s_waitcnt lgkmcnt(6)
    buffer_store_dwordx4 v[48:51], v30, s[24:27], s19 offen offset:0 sc1
    s_waitcnt lgkmcnt(4)
    buffer_store_dwordx4 v[52:55], v30, s[24:27], s19 offen offset:1024 sc1
    s_waitcnt lgkmcnt(2)
    buffer_store_dwordx4 v[56:59], v30, s[24:27], s23 offen offset:0 sc1
    s_waitcnt lgkmcnt(0)
    buffer_store_dwordx4 v[60:63], v30, s[24:27], s23 offen offset:1024 sc1
    s_waitcnt vmcnt(60)
    ds_read_b64_tr_b16 v[64:65], v22 offset:8192
    ds_read_b64_tr_b16 v[66:67], v22 offset:10240
    ds_read_b64_tr_b16 v[68:69], v23 offset:8192
    ds_read_b64_tr_b16 v[70:71], v23 offset:10240
    ds_read_b64_tr_b16 v[72:73], v24 offset:8192
    ds_read_b64_tr_b16 v[74:75], v24 offset:10240
    ds_read_b64_tr_b16 v[76:77], v25 offset:8192
    ds_read_b64_tr_b16 v[78:79], v25 offset:10240
    s_mul_i32 s19, s20, 3
    s_add_u32 s19, s19, s17
    s_add_u32 s19, s19, 32768
    s_add_u32 s23, s19, s22
    s_waitcnt lgkmcnt(6)
    buffer_store_dwordx4 v[64:67], v30, s[24:27], s19 offen offset:0 sc1
    s_waitcnt lgkmcnt(4)
    buffer_store_dwordx4 v[68:71], v30, s[24:27], s19 offen offset:1024 sc1
    s_waitcnt lgkmcnt(2)
    buffer_store_dwordx4 v[72:75], v30, s[24:27], s23 offen offset:0 sc1
    s_waitcnt lgkmcnt(0)
    buffer_store_dwordx4 v[76:79], v30, s[24:27], s23 offen offset:1024 sc1
    s_waitcnt vmcnt(60)
    ds_read_b64_tr_b16 v[80:81], v22 offset:12288
    ds_read_b64_tr_b16 v[82:83], v22 offset:14336
    ds_read_b64_tr_b16 v[84:85], v23 offset:12288
    ds_read_b64_tr_b16 v[86:87], v23 offset:14336
    ds_read_b64_tr_b16 v[88:89], v24 offset:12288
    ds_read_b64_tr_b16 v[90:91], v24 offset:14336
    ds_read_b64_tr_b16 v[92:93], v25 offset:12288
    ds_read_b64_tr_b16 v[94:95], v25 offset:14336
    s_mul_i32 s19, s20, 3
    s_add_u32 s19, s19, s17
    s_add_u32 s19, s19, s21
    s_add_u32 s19, s19, 32768
    s_add_u32 s23, s19, s22
    s_waitcnt lgkmcnt(6)
    buffer_store_dwordx4 v[80:83], v30, s[24:27], s19 offen offset:0 sc1
    s_waitcnt lgkmcnt(4)
    buffer_store_dwordx4 v[84:87], v30, s[24:27], s19 offen offset:1024 sc1
    s_waitcnt lgkmcnt(2)
    buffer_store_dwordx4 v[88:91], v30, s[24:27], s23 offen offset:0 sc1
    s_waitcnt lgkmcnt(0)
    buffer_store_dwordx4 v[92:95], v30, s[24:27], s23 offen offset:1024 sc1
    s_cmp_ge_u32 s4, 4
    s_cbranch_scc1 standalone__conformer_family_zipformer__speech_kernel_swz_end
    s_waitcnt lgkmcnt(0)
    s_mov_b32 s12, s76
    s_and_b32 s13, s77, 0xffff
    s_mov_b32 s14, 0x3e00
    s_mov_b32 s15, 0x20000
    v_lshlrev_b32 v7, 1, v1
    s_lshl_b32 s5, s4, 7
    s_add_u32 s7, s5, 0
    buffer_load_ushort v64, v7, s[12:15], s7 offen offset:0
    buffer_load_ushort v65, v7, s[12:15], s7 offen offset:512
    buffer_load_ushort v66, v7, s[12:15], s7 offen offset:1024
    buffer_load_ushort v67, v7, s[12:15], s7 offen offset:1536
    buffer_load_ushort v68, v7, s[12:15], s7 offen offset:2048
    buffer_load_ushort v69, v7, s[12:15], s7 offen offset:2560
    buffer_load_ushort v70, v7, s[12:15], s7 offen offset:3072
    buffer_load_ushort v71, v7, s[12:15], s7 offen offset:3584
    s_add_u32 s7, s5, 4096
    buffer_load_ushort v72, v7, s[12:15], s7 offen offset:0
    buffer_load_ushort v73, v7, s[12:15], s7 offen offset:512
    buffer_load_ushort v74, v7, s[12:15], s7 offen offset:1024
    buffer_load_ushort v75, v7, s[12:15], s7 offen offset:1536
    buffer_load_ushort v76, v7, s[12:15], s7 offen offset:2048
    buffer_load_ushort v77, v7, s[12:15], s7 offen offset:2560
    buffer_load_ushort v78, v7, s[12:15], s7 offen offset:3072
    buffer_load_ushort v79, v7, s[12:15], s7 offen offset:3584
    s_add_u32 s7, s5, 8192
    buffer_load_ushort v80, v7, s[12:15], s7 offen offset:0
    buffer_load_ushort v81, v7, s[12:15], s7 offen offset:512
    buffer_load_ushort v82, v7, s[12:15], s7 offen offset:1024
    buffer_load_ushort v83, v7, s[12:15], s7 offen offset:1536
    buffer_load_ushort v84, v7, s[12:15], s7 offen offset:2048
    buffer_load_ushort v85, v7, s[12:15], s7 offen offset:2560
    buffer_load_ushort v86, v7, s[12:15], s7 offen offset:3072
    buffer_load_ushort v87, v7, s[12:15], s7 offen offset:3584
    s_add_u32 s7, s5, 12288
    buffer_load_ushort v88, v7, s[12:15], s7 offen offset:0
    buffer_load_ushort v89, v7, s[12:15], s7 offen offset:512
    buffer_load_ushort v90, v7, s[12:15], s7 offen offset:1024
    buffer_load_ushort v91, v7, s[12:15], s7 offen offset:1536
    buffer_load_ushort v92, v7, s[12:15], s7 offen offset:2048
    buffer_load_ushort v93, v7, s[12:15], s7 offen offset:2560
    buffer_load_ushort v94, v7, s[12:15], s7 offen offset:3072
    v_mov_b32 v96, 0
    v_mov_b32 v97, 0
    v_mov_b32 v114, 0
    v_mov_b32 v115, 0
    v_mov_b32 v116, 0
    v_mov_b32 v133, 0
    v_mov_b32 v134, 0
    v_mov_b32 v135, 0
    s_waitcnt vmcnt(29)
    v_lshl_or_b32 v98, v65, 16, v64
    s_waitcnt vmcnt(27)
    v_lshl_or_b32 v99, v67, 16, v66
    s_waitcnt vmcnt(25)
    v_lshl_or_b32 v100, v69, 16, v68
    s_waitcnt vmcnt(23)
    v_lshl_or_b32 v101, v71, 16, v70
    s_waitcnt vmcnt(21)
    v_lshl_or_b32 v102, v73, 16, v72
    s_waitcnt vmcnt(19)
    v_lshl_or_b32 v103, v75, 16, v74
    s_waitcnt vmcnt(17)
    v_lshl_or_b32 v104, v77, 16, v76
    s_waitcnt vmcnt(15)
    v_lshl_or_b32 v105, v79, 16, v78
    s_waitcnt vmcnt(13)
    v_lshl_or_b32 v106, v81, 16, v80
    s_waitcnt vmcnt(11)
    v_lshl_or_b32 v107, v83, 16, v82
    s_waitcnt vmcnt(9)
    v_lshl_or_b32 v108, v85, 16, v84
    s_waitcnt vmcnt(7)
    v_lshl_or_b32 v109, v87, 16, v86
    s_waitcnt vmcnt(5)
    v_lshl_or_b32 v110, v89, 16, v88
    s_waitcnt vmcnt(3)
    v_lshl_or_b32 v111, v91, 16, v90
    s_waitcnt vmcnt(1)
    v_lshl_or_b32 v112, v93, 16, v92
    s_waitcnt vmcnt(0)
    v_mov_b32 v113, v94
    v_alignbit_b32 v117, v98, v97, 16
    v_alignbit_b32 v118, v99, v98, 16
    v_alignbit_b32 v119, v100, v99, 16
    v_alignbit_b32 v120, v101, v100, 16
    v_alignbit_b32 v121, v102, v101, 16
    v_alignbit_b32 v122, v103, v102, 16
    v_alignbit_b32 v123, v104, v103, 16
    v_alignbit_b32 v124, v105, v104, 16
    v_alignbit_b32 v125, v106, v105, 16
    v_alignbit_b32 v126, v107, v106, 16
    v_alignbit_b32 v127, v108, v107, 16
    v_alignbit_b32 v128, v109, v108, 16
    v_alignbit_b32 v129, v110, v109, 16
    v_alignbit_b32 v130, v111, v110, 16
    v_alignbit_b32 v131, v112, v111, 16
    v_alignbit_b32 v132, v113, v112, 16
    s_mul_i32 s7, s4, 10240
    s_add_u32 s7, s7, 25165824
    v_mul_u32_u24 v2, 160, v1
    v_add_u32 v2, s28, v2
    v_add_u32 v3, s28, v30
    ds_write_b128 v2, v[96:99] offset:0
    ds_write_b128 v2, v[100:103] offset:16
    ds_write_b128 v2, v[104:107] offset:32
    ds_write_b128 v2, v[108:111] offset:48
    ds_write_b128 v2, v[112:115] offset:64
    ds_write_b128 v2, v[116:119] offset:80
    ds_write_b128 v2, v[120:123] offset:96
    ds_write_b128 v2, v[124:127] offset:112
    ds_write_b128 v2, v[128:131] offset:128
    ds_write_b128 v2, v[132:135] offset:144
    s_waitcnt lgkmcnt(0)
    ds_read_b128 v[160:163], v3 offset:0
    ds_read_b128 v[164:167], v3 offset:1024
    ds_read_b128 v[168:171], v3 offset:2048
    ds_read_b128 v[172:175], v3 offset:3072
    ds_read_b128 v[176:179], v3 offset:4096
    ds_read_b128 v[180:183], v3 offset:5120
    ds_read_b128 v[184:187], v3 offset:6144
    ds_read_b128 v[188:191], v3 offset:7168
    ds_read_b128 v[192:195], v3 offset:8192
    ds_read_b128 v[196:199], v3 offset:9216
    s_waitcnt lgkmcnt(9)
    buffer_store_dwordx4 v[160:163], v30, s[24:27], s7 offen offset:0 sc1
    s_waitcnt lgkmcnt(8)
    buffer_store_dwordx4 v[164:167], v30, s[24:27], s7 offen offset:1024 sc1
    s_waitcnt lgkmcnt(7)
    buffer_store_dwordx4 v[168:171], v30, s[24:27], s7 offen offset:2048 sc1
    s_waitcnt lgkmcnt(6)
    buffer_store_dwordx4 v[172:175], v30, s[24:27], s7 offen offset:3072 sc1
    s_add_u32 s7, s7, 4096
    s_waitcnt lgkmcnt(5)
    buffer_store_dwordx4 v[176:179], v30, s[24:27], s7 offen offset:0 sc1
    s_waitcnt lgkmcnt(4)
    buffer_store_dwordx4 v[180:183], v30, s[24:27], s7 offen offset:1024 sc1
    s_waitcnt lgkmcnt(3)
    buffer_store_dwordx4 v[184:187], v30, s[24:27], s7 offen offset:2048 sc1
    s_waitcnt lgkmcnt(2)
    buffer_store_dwordx4 v[188:191], v30, s[24:27], s7 offen offset:3072 sc1
    s_add_u32 s7, s7, 4096
    s_waitcnt lgkmcnt(1)
    buffer_store_dwordx4 v[192:195], v30, s[24:27], s7 offen offset:0 sc1
    s_waitcnt lgkmcnt(0)
    buffer_store_dwordx4 v[196:199], v30, s[24:27], s7 offen offset:1024 sc1
standalone__conformer_family_zipformer__speech_kernel_swz_end:
    s_waitcnt lgkmcnt(0)
    s_nop 7
    s_branch standalone__conformer_family_zipformer__speech_kernel_p2
.section .rodata,"a"
.p2align 6
.amdhsa_kernel standalone__conformer_family_zipformer__speech_kernel
  .amdhsa_next_free_vgpr 512
  .amdhsa_next_free_sgpr 102
  .amdhsa_accum_offset 256
  .amdhsa_group_segment_fixed_size 0
  .amdhsa_kernarg_size 104
  .amdhsa_user_sgpr_count 2
  .amdhsa_user_sgpr_kernarg_segment_ptr 1
  .amdhsa_system_sgpr_workgroup_id_x 1
.end_amdhsa_kernel
```
